```python
import torch

def _softmax(x, axis=-1):
    return torch.softmax(x, dim=axis)

def _gelu(x):
    return torch.nn.functional.gelu(x, approximate='tanh')

def _silu(x):
    return torch.nn.functional.silu(x)

def _sigmoid(x):
    return torch.sigmoid(x)

def _layernorm(x, axis=-1, eps=1e-05):
    m = x.mean(dim=axis, keepdim=True)
    v = x.var(dim=axis, keepdim=True, unbiased=False)
    return (x - m) / torch.sqrt(v + eps)

def _scatter_add(tgt, idx, src, axis=0):
    return tgt.clone().index_add_(axis, idx, src)

def _segment_sum(src, seg, n):
    out = torch.zeros((n,) + src.shape[1:], dtype=src.dtype)
    return out.index_add_(0, seg, src)

def _pad(x, pw):
    flat = tuple((v for pair in reversed(pw) for v in pair))
    return torch.nn.functional.pad(x, flat)
kernel_name = 'adaLN_cond__memory_aug_recurrent_mem_tr__swiglu_ffn__prompt'

def setup_inputs():

    _w = lambda a: (lambda t: t.to(torch.bfloat16) if t.is_floating_point() else t)(torch.as_tensor(a))

    def _A_setup():
        B, S, Dm = (1, 2048, 640)
        H, Dh = (32, 128)
        M, seg = (8, 32)
        seg = min(seg, S)
        S = S // seg * seg
        return {'x': _w((lambda *s: torch.randn(*s, dtype=torch.bfloat16) * 0.05)(B, S, Dm)), 'mem0': _w((lambda *s: torch.randn(*s, dtype=torch.bfloat16) * 0.4)(B, M, Dm)), 'Wq': _w((lambda *s: torch.randn(*s, dtype=torch.bfloat16) * 3.2)(Dm, H, Dh) * Dm ** (-0.5)), 'Wk': _w((lambda *s: torch.randn(*s, dtype=torch.bfloat16) * 3.2)(Dm, H, Dh) * Dm ** (-0.5)), 'Wv': _w((lambda *s: torch.randn(*s, dtype=torch.bfloat16) * 0.4)(Dm, H, Dh) * Dm ** (-0.5)), 'Wo': _w((lambda *s: torch.randn(*s, dtype=torch.bfloat16) * 0.4)(H, Dh, Dm) * (H * Dh) ** (-0.5)), 'seg_len': seg}
    _A_in = _A_setup()

    def _B_setup():
        B, S, D, F = (1, 2048, 640, 1728)
        return {'x': _w((lambda *s: torch.randn(*s, dtype=torch.bfloat16) * 0.05)(B, S, D)), 'w_gate': _w((lambda *s: torch.randn(*s, dtype=torch.bfloat16) * 0.05)(D, F)), 'w_up': _w((lambda *s: torch.randn(*s, dtype=torch.bfloat16) * 0.05)(D, F)), 'w_down': _w((lambda *s: torch.randn(*s, dtype=torch.bfloat16) * 0.05)(F, D))}
    _B_in = _B_setup()
    return {'A_x': _A_in['x'], 'A_mem0': _A_in['mem0'], 'A_Wq': _A_in['Wq'], 'A_Wk': _A_in['Wk'], 'A_Wv': _A_in['Wv'], 'A_Wo': _A_in['Wo'], 'A_seg_len': _A_in['seg_len'], 'B_x': _B_in['x'], 'B_w_gate': _B_in['w_gate'], 'B_w_up': _B_in['w_up'], 'B_w_down': _B_in['w_down'], 'c': _w((lambda *s: torch.randn(*s, dtype=torch.bfloat16) * 0.1)(1, 640) * 8.0), 'w_mod': _w((lambda *s: torch.randn(*s, dtype=torch.bfloat16) * 0.1)(640, 6 * 640) * 640 ** (-0.5) * 8.0)}

def reference(A_x, A_mem0, A_Wq, A_Wk, A_Wv, A_Wo, A_seg_len, B_x, B_w_gate, B_w_up, B_w_down, c, w_mod):

    def _A_ref(x, mem0, Wq, Wk, Wv, Wo, seg_len):
        B, S, Dm = x.shape
        H, Dh = (Wq.shape[1], Wq.shape[2])
        M = mem0.shape[1]
        scale = Dh ** (-0.5)
        n_seg = S // seg_len
        L = M + seg_len
        idx = torch.arange(L)
        mask = (idx[:, None] < M) | (idx[:, None] >= idx[None, :])
        mem = mem0
        outs = []
        for s in range(n_seg):
            xs = x[:, s * seg_len:(s + 1) * seg_len, :].clone()
            h = torch.concatenate([mem, xs], axis=1)
            q = torch.einsum('btd,dhe->bhte', h, Wq)
            k = torch.einsum('btd,dhe->bhte', h, Wk)
            v = torch.einsum('btd,dhe->bhte', h, Wv)
            scores = torch.einsum('bhqe,bhke->bhqk', q, k) * scale
            scores = torch.where(mask[None, None], scores, -1000000000.0)
            p = _softmax(scores, axis=-1)
            o = torch.einsum('bhqk,bhke->bhqe', p, v)
            o = torch.einsum('bhte,hed->btd', o, Wo)
            mem = o[:, :M, :].clone()
            outs.append(o[:, M:, :])
        return torch.concatenate(outs, axis=1)

    def _B_ref(x, w_gate, w_up, w_down):
        g = _silu(x @ w_gate)
        u = x @ w_up
        return g * u @ w_down
    x = A_x
    mod = (_silu(c) @ w_mod).reshape(c.shape[0], 6, 1, -1)
    sa, ca, ga, sb, cb, gb = (mod[:, 0].clone(), mod[:, 1].clone(), mod[:, 2].clone(), mod[:, 3].clone(), mod[:, 4].clone(), mod[:, 5].clone())
    h = _layernorm(x, axis=-1) * (1 + ca) + sa
    x = x + ga * _A_ref(h, A_mem0, A_Wq, A_Wk, A_Wv, A_Wo, A_seg_len)
    h = _layernorm(x, axis=-1) * (1 + cb) + sb
    x = x + gb * _B_ref(h, B_w_gate, B_w_up, B_w_down)
    return x
```

```asm
; @launch grid=(256,1,1) block=(256,1,1) lds=163840
.amdgcn_target "amdgcn-amd-amdhsa--gfx950"
.text
.globl adaLN_cond__memory_aug_recurrent_mem_tr__swiglu_ffn__prompt_kernel
.p2align 8
.type adaLN_cond__memory_aug_recurrent_mem_tr__swiglu_ffn__prompt_kernel,@function
adaLN_cond__memory_aug_recurrent_mem_tr__swiglu_ffn__prompt_kernel:

    s_cmp_ge_u32 s2, 256
    s_cbranch_scc1 L_end0
    s_load_dwordx2 s[4:5], s[0:1], 112
    s_getreg_b32 s98, hwreg(HW_REG_XCC_ID)
    s_and_b32 s98, s98, 7
    v_lshrrev_b32 v1, 6, v0
    s_nop 0
    v_readfirstlane_b32 s3, v1
    s_waitcnt lgkmcnt(0)
    s_mov_b32 s8, s4
    s_mov_b32 s9, s5
    s_mov_b32 s10, 0x100
    s_mov_b32 s11, 0x20000
    s_cmp_lg_u32 s3, 0
    s_cbranch_scc1 L_claimed
    s_mov_b32 s6, 0
    s_mov_b64 exec, 1
L_claim:
    s_lshl_b32 s7, s98, 2
    s_cmp_lt_u32 s98, 2
    s_cselect_b32 s12, 0xc0, 32
    s_add_u32 s7, s7, s12
    v_mov_b32 v1, 1
    buffer_atomic_add v1, off, s[8:11], s7 sc0 sc1
    s_waitcnt vmcnt(0)
    v_readfirstlane_b32 s99, v1
    s_cmp_lt_u32 s99, 32
    s_cbranch_scc1 L_claim_ok
    s_add_u32 s98, s98, 1
    s_and_b32 s98, s98, 7
    s_add_u32 s6, s6, 1
    s_cmp_lt_u32 s6, 8
    s_cbranch_scc1 L_claim
    s_mov_b32 s99, 255
L_claim_ok:
    s_lshl_b32 s7, s99, 3
    s_or_b32 s7, s7, s98
    v_mov_b32 v1, s7
    v_mov_b32 v2, 0
    ds_write_b32 v2, v1
    s_waitcnt lgkmcnt(0)
    s_mov_b64 exec, -1
L_claimed:
    s_barrier
    v_mov_b32 v2, 0
    ds_read_b32 v1, v2
    s_waitcnt lgkmcnt(0)
    v_readfirstlane_b32 s7, v1
    s_barrier
    s_and_b32 s98, s7, 7
    s_lshr_b32 s99, s7, 3
    s_mov_b32 s3, s7
    s_cmp_ge_u32 s99, 32
    s_cbranch_scc1 L_end0
    s_cmp_lt_u32 s98, 2
    s_cbranch_scc1 L_rec
    s_load_dwordx2 s[44:45], s[0:1], 120
    s_load_dwordx2 s[42:43], s[0:1], 112
    v_lshrrev_b32 v1, 6, v0
    s_nop 0
    v_readfirstlane_b32 s18, v1
    v_and_b32 v0, 63, v0
    s_waitcnt lgkmcnt(0)
    s_mov_b32 s4, s44
    s_mov_b32 s5, s45
    s_mov_b32 s6, 0x10000000
    s_mov_b32 s7, 0x20000
    s_mov_b32 s12, s42
    s_mov_b32 s13, s43
    s_mov_b32 s14, 0x100
    s_mov_b32 s15, 0x20000
    s_mov_b32 s46, 0
    v_lshrrev_b32 v1, 4, v0
    v_and_b32 v2, 15, v0
    v_lshlrev_b32 v3, 4, v0
    s_mul_i32 s47, s18, 40960
    s_cmp_lt_u32 s98, 4
    s_cbranch_scc1 L_kv
    s_sub_u32 s16, s98, 4
    s_lshl_b32 s16, s16, 5
    s_add_u32 s16, s16, s99
    s_lshl_b32 s41, s18, 6
    v_add_u32 v19, s41, v0
    v_lshlrev_b32 v6, 4, v19
    v_mov_b32 v20, -1
    v_mov_b32 v21, -1
    v_mov_b32 v22, -1
    v_mov_b32 v23, -1
    v_mov_b32 v24, 0
    v_mov_b32 v25, 0
    v_mov_b32 v26, 0
    v_mov_b32 v27, 0
    s_add_u32 s41, s16, 0
    s_cmp_ge_u32 s41, 48
    s_cbranch_scc1 L_fill_1
    s_lshl_b32 s41, s41, 12
    s_add_u32 s41, s41, 0x500000
    buffer_store_dwordx4 v[24:27], v6, s[4:7], s41 offen sc1
L_fill_1:
    s_cmp_ge_u32 s16, 120
    s_cbranch_scc1 L_nomod_2
    s_load_dwordx2 s[44:45], s[0:1], 88
    s_waitcnt lgkmcnt(0)
    s_mov_b32 s8, s44
    s_mov_b32 s9, s45
    s_mov_b32 s10, 0x500
    s_mov_b32 s11, 0x20000
    v_lshrrev_b32 v4, 2, v19
    v_lshlrev_b32 v5, 1, v4
    buffer_load_ushort v30, v5, s[8:11], 0 offen offset:0
    buffer_load_ushort v31, v5, s[8:11], 0 offen offset:128
    buffer_load_ushort v32, v5, s[8:11], 0 offen offset:256
    buffer_load_ushort v33, v5, s[8:11], 0 offen offset:384
    buffer_load_ushort v34, v5, s[8:11], 0 offen offset:512
    buffer_load_ushort v35, v5, s[8:11], 0 offen offset:640
    buffer_load_ushort v36, v5, s[8:11], 0 offen offset:768
    buffer_load_ushort v37, v5, s[8:11], 0 offen offset:896
    buffer_load_ushort v38, v5, s[8:11], 0 offen offset:1024
    buffer_load_ushort v39, v5, s[8:11], 0 offen offset:1152
    s_load_dwordx2 s[44:45], s[0:1], 96
    s_waitcnt lgkmcnt(0)
    s_mov_b32 s8, s44
    s_mov_b32 s9, s45
    s_mov_b32 s10, 0x4b0000
    s_mov_b32 s11, 0x20000
    v_mul_u32_u24 v5, 7680, v4
    v_and_b32 v4, 3, v19
    v_lshl_add_u32 v5, v4, 4, v5
    s_lshl_b32 s41, s16, 6
    buffer_load_dwordx4 v[40:43], v5, s[8:11], s41 offen
    s_add_u32 s41, s41, 491520
    buffer_load_dwordx4 v[44:47], v5, s[8:11], s41 offen
    s_add_u32 s41, s41, 491520
    buffer_load_dwordx4 v[48:51], v5, s[8:11], s41 offen
    s_add_u32 s41, s41, 491520
    buffer_load_dwordx4 v[52:55], v5, s[8:11], s41 offen
    s_add_u32 s41, s41, 491520
    buffer_load_dwordx4 v[56:59], v5, s[8:11], s41 offen
    s_add_u32 s41, s41, 491520
    buffer_load_dwordx4 v[60:63], v5, s[8:11], s41 offen
    s_add_u32 s41, s41, 491520
    buffer_load_dwordx4 v[64:67], v5, s[8:11], s41 offen
    s_add_u32 s41, s41, 491520
    buffer_load_dwordx4 v[68:71], v5, s[8:11], s41 offen
    s_add_u32 s41, s41, 491520
    buffer_load_dwordx4 v[72:75], v5, s[8:11], s41 offen
    s_add_u32 s41, s41, 491520
    buffer_load_dwordx4 v[76:79], v5, s[8:11], s41 offen
    s_add_u32 s41, s41, 491520
    s_mov_b32 s41, 0xbfb8aa3b
    s_waitcnt vmcnt(19)
    v_lshlrev_b32 v30, 16, v30
    v_mul_f32 v4, s41, v30
    v_exp_f32 v4, v4
    s_nop 0
    v_add_f32 v4, 1.0, v4
    v_rcp_f32 v4, v4
    s_nop 0
    v_mul_f32 v30, v30, v4
    v_cvt_pk_bf16_f32 v30, v30, v30
    v_and_b32 v30, 0xffff0000, v30
    s_waitcnt vmcnt(18)
    v_lshlrev_b32 v31, 16, v31
    v_mul_f32 v4, s41, v31
    v_exp_f32 v4, v4
    s_nop 0
    v_add_f32 v4, 1.0, v4
    v_rcp_f32 v4, v4
    s_nop 0
    v_mul_f32 v31, v31, v4
    v_cvt_pk_bf16_f32 v31, v31, v31
    v_and_b32 v31, 0xffff0000, v31
    s_waitcnt vmcnt(17)
    v_lshlrev_b32 v32, 16, v32
    v_mul_f32 v4, s41, v32
    v_exp_f32 v4, v4
    s_nop 0
    v_add_f32 v4, 1.0, v4
    v_rcp_f32 v4, v4
    s_nop 0
    v_mul_f32 v32, v32, v4
    v_cvt_pk_bf16_f32 v32, v32, v32
    v_and_b32 v32, 0xffff0000, v32
    s_waitcnt vmcnt(16)
    v_lshlrev_b32 v33, 16, v33
    v_mul_f32 v4, s41, v33
    v_exp_f32 v4, v4
    s_nop 0
    v_add_f32 v4, 1.0, v4
    v_rcp_f32 v4, v4
    s_nop 0
    v_mul_f32 v33, v33, v4
    v_cvt_pk_bf16_f32 v33, v33, v33
    v_and_b32 v33, 0xffff0000, v33
    s_waitcnt vmcnt(15)
    v_lshlrev_b32 v34, 16, v34
    v_mul_f32 v4, s41, v34
    v_exp_f32 v4, v4
    s_nop 0
    v_add_f32 v4, 1.0, v4
    v_rcp_f32 v4, v4
    s_nop 0
    v_mul_f32 v34, v34, v4
    v_cvt_pk_bf16_f32 v34, v34, v34
    v_and_b32 v34, 0xffff0000, v34
    s_waitcnt vmcnt(14)
    v_lshlrev_b32 v35, 16, v35
    v_mul_f32 v4, s41, v35
    v_exp_f32 v4, v4
    s_nop 0
    v_add_f32 v4, 1.0, v4
    v_rcp_f32 v4, v4
    s_nop 0
    v_mul_f32 v35, v35, v4
    v_cvt_pk_bf16_f32 v35, v35, v35
    v_and_b32 v35, 0xffff0000, v35
    s_waitcnt vmcnt(13)
    v_lshlrev_b32 v36, 16, v36
    v_mul_f32 v4, s41, v36
    v_exp_f32 v4, v4
    s_nop 0
    v_add_f32 v4, 1.0, v4
    v_rcp_f32 v4, v4
    s_nop 0
    v_mul_f32 v36, v36, v4
    v_cvt_pk_bf16_f32 v36, v36, v36
    v_and_b32 v36, 0xffff0000, v36
    s_waitcnt vmcnt(12)
    v_lshlrev_b32 v37, 16, v37
    v_mul_f32 v4, s41, v37
    v_exp_f32 v4, v4
    s_nop 0
    v_add_f32 v4, 1.0, v4
    v_rcp_f32 v4, v4
    s_nop 0
    v_mul_f32 v37, v37, v4
    v_cvt_pk_bf16_f32 v37, v37, v37
    v_and_b32 v37, 0xffff0000, v37
    s_waitcnt vmcnt(11)
    v_lshlrev_b32 v38, 16, v38
    v_mul_f32 v4, s41, v38
    v_exp_f32 v4, v4
    s_nop 0
    v_add_f32 v4, 1.0, v4
    v_rcp_f32 v4, v4
    s_nop 0
    v_mul_f32 v38, v38, v4
    v_cvt_pk_bf16_f32 v38, v38, v38
    v_and_b32 v38, 0xffff0000, v38
    s_waitcnt vmcnt(10)
    v_lshlrev_b32 v39, 16, v39
    v_mul_f32 v4, s41, v39
    v_exp_f32 v4, v4
    s_nop 0
    v_add_f32 v4, 1.0, v4
    v_rcp_f32 v4, v4
    s_nop 0
    v_mul_f32 v39, v39, v4
    v_cvt_pk_bf16_f32 v39, v39, v39
    v_and_b32 v39, 0xffff0000, v39
    v_mov_b32 v20, 0
    v_mov_b32 v21, 0
    v_mov_b32 v22, 0
    v_mov_b32 v23, 0
    v_mov_b32 v24, 0
    v_mov_b32 v25, 0
    v_mov_b32 v26, 0
    v_mov_b32 v27, 0
    s_waitcnt vmcnt(9)
    v_lshlrev_b32 v4, 16, v40
    v_and_b32 v5, 0xffff0000, v40
    v_fmac_f32 v20, v30, v4
    v_fmac_f32 v21, v30, v5
    v_lshlrev_b32 v4, 16, v41
    v_and_b32 v5, 0xffff0000, v41
    v_fmac_f32 v22, v30, v4
    v_fmac_f32 v23, v30, v5
    v_lshlrev_b32 v4, 16, v42
    v_and_b32 v5, 0xffff0000, v42
    v_fmac_f32 v24, v30, v4
    v_fmac_f32 v25, v30, v5
    v_lshlrev_b32 v4, 16, v43
    v_and_b32 v5, 0xffff0000, v43
    v_fmac_f32 v26, v30, v4
    v_fmac_f32 v27, v30, v5
    s_waitcnt vmcnt(8)
    v_lshlrev_b32 v4, 16, v44
    v_and_b32 v5, 0xffff0000, v44
    v_fmac_f32 v20, v31, v4
    v_fmac_f32 v21, v31, v5
    v_lshlrev_b32 v4, 16, v45
    v_and_b32 v5, 0xffff0000, v45
    v_fmac_f32 v22, v31, v4
    v_fmac_f32 v23, v31, v5
    v_lshlrev_b32 v4, 16, v46
    v_and_b32 v5, 0xffff0000, v46
    v_fmac_f32 v24, v31, v4
    v_fmac_f32 v25, v31, v5
    v_lshlrev_b32 v4, 16, v47
    v_and_b32 v5, 0xffff0000, v47
    v_fmac_f32 v26, v31, v4
    v_fmac_f32 v27, v31, v5
    s_waitcnt vmcnt(7)
    v_lshlrev_b32 v4, 16, v48
    v_and_b32 v5, 0xffff0000, v48
    v_fmac_f32 v20, v32, v4
    v_fmac_f32 v21, v32, v5
    v_lshlrev_b32 v4, 16, v49
    v_and_b32 v5, 0xffff0000, v49
    v_fmac_f32 v22, v32, v4
    v_fmac_f32 v23, v32, v5
    v_lshlrev_b32 v4, 16, v50
    v_and_b32 v5, 0xffff0000, v50
    v_fmac_f32 v24, v32, v4
    v_fmac_f32 v25, v32, v5
    v_lshlrev_b32 v4, 16, v51
    v_and_b32 v5, 0xffff0000, v51
    v_fmac_f32 v26, v32, v4
    v_fmac_f32 v27, v32, v5
    s_waitcnt vmcnt(6)
    v_lshlrev_b32 v4, 16, v52
    v_and_b32 v5, 0xffff0000, v52
    v_fmac_f32 v20, v33, v4
    v_fmac_f32 v21, v33, v5
    v_lshlrev_b32 v4, 16, v53
    v_and_b32 v5, 0xffff0000, v53
    v_fmac_f32 v22, v33, v4
    v_fmac_f32 v23, v33, v5
    v_lshlrev_b32 v4, 16, v54
    v_and_b32 v5, 0xffff0000, v54
    v_fmac_f32 v24, v33, v4
    v_fmac_f32 v25, v33, v5
    v_lshlrev_b32 v4, 16, v55
    v_and_b32 v5, 0xffff0000, v55
    v_fmac_f32 v26, v33, v4
    v_fmac_f32 v27, v33, v5
    s_waitcnt vmcnt(5)
    v_lshlrev_b32 v4, 16, v56
    v_and_b32 v5, 0xffff0000, v56
    v_fmac_f32 v20, v34, v4
    v_fmac_f32 v21, v34, v5
    v_lshlrev_b32 v4, 16, v57
    v_and_b32 v5, 0xffff0000, v57
    v_fmac_f32 v22, v34, v4
    v_fmac_f32 v23, v34, v5
    v_lshlrev_b32 v4, 16, v58
    v_and_b32 v5, 0xffff0000, v58
    v_fmac_f32 v24, v34, v4
    v_fmac_f32 v25, v34, v5
    v_lshlrev_b32 v4, 16, v59
    v_and_b32 v5, 0xffff0000, v59
    v_fmac_f32 v26, v34, v4
    v_fmac_f32 v27, v34, v5
    s_waitcnt vmcnt(4)
    v_lshlrev_b32 v4, 16, v60
    v_and_b32 v5, 0xffff0000, v60
    v_fmac_f32 v20, v35, v4
    v_fmac_f32 v21, v35, v5
    v_lshlrev_b32 v4, 16, v61
    v_and_b32 v5, 0xffff0000, v61
    v_fmac_f32 v22, v35, v4
    v_fmac_f32 v23, v35, v5
    v_lshlrev_b32 v4, 16, v62
    v_and_b32 v5, 0xffff0000, v62
    v_fmac_f32 v24, v35, v4
    v_fmac_f32 v25, v35, v5
    v_lshlrev_b32 v4, 16, v63
    v_and_b32 v5, 0xffff0000, v63
    v_fmac_f32 v26, v35, v4
    v_fmac_f32 v27, v35, v5
    s_waitcnt vmcnt(3)
    v_lshlrev_b32 v4, 16, v64
    v_and_b32 v5, 0xffff0000, v64
    v_fmac_f32 v20, v36, v4
    v_fmac_f32 v21, v36, v5
    v_lshlrev_b32 v4, 16, v65
    v_and_b32 v5, 0xffff0000, v65
    v_fmac_f32 v22, v36, v4
    v_fmac_f32 v23, v36, v5
    v_lshlrev_b32 v4, 16, v66
    v_and_b32 v5, 0xffff0000, v66
    v_fmac_f32 v24, v36, v4
    v_fmac_f32 v25, v36, v5
    v_lshlrev_b32 v4, 16, v67
    v_and_b32 v5, 0xffff0000, v67
    v_fmac_f32 v26, v36, v4
    v_fmac_f32 v27, v36, v5
    s_waitcnt vmcnt(2)
    v_lshlrev_b32 v4, 16, v68
    v_and_b32 v5, 0xffff0000, v68
    v_fmac_f32 v20, v37, v4
    v_fmac_f32 v21, v37, v5
    v_lshlrev_b32 v4, 16, v69
    v_and_b32 v5, 0xffff0000, v69
    v_fmac_f32 v22, v37, v4
    v_fmac_f32 v23, v37, v5
    v_lshlrev_b32 v4, 16, v70
    v_and_b32 v5, 0xffff0000, v70
    v_fmac_f32 v24, v37, v4
    v_fmac_f32 v25, v37, v5
    v_lshlrev_b32 v4, 16, v71
    v_and_b32 v5, 0xffff0000, v71
    v_fmac_f32 v26, v37, v4
    v_fmac_f32 v27, v37, v5
    s_waitcnt vmcnt(1)
    v_lshlrev_b32 v4, 16, v72
    v_and_b32 v5, 0xffff0000, v72
    v_fmac_f32 v20, v38, v4
    v_fmac_f32 v21, v38, v5
    v_lshlrev_b32 v4, 16, v73
    v_and_b32 v5, 0xffff0000, v73
    v_fmac_f32 v22, v38, v4
    v_fmac_f32 v23, v38, v5
    v_lshlrev_b32 v4, 16, v74
    v_and_b32 v5, 0xffff0000, v74
    v_fmac_f32 v24, v38, v4
    v_fmac_f32 v25, v38, v5
    v_lshlrev_b32 v4, 16, v75
    v_and_b32 v5, 0xffff0000, v75
    v_fmac_f32 v26, v38, v4
    v_fmac_f32 v27, v38, v5
    s_waitcnt vmcnt(0)
    v_lshlrev_b32 v4, 16, v76
    v_and_b32 v5, 0xffff0000, v76
    v_fmac_f32 v20, v39, v4
    v_fmac_f32 v21, v39, v5
    v_lshlrev_b32 v4, 16, v77
    v_and_b32 v5, 0xffff0000, v77
    v_fmac_f32 v22, v39, v4
    v_fmac_f32 v23, v39, v5
    v_lshlrev_b32 v4, 16, v78
    v_and_b32 v5, 0xffff0000, v78
    v_fmac_f32 v24, v39, v4
    v_fmac_f32 v25, v39, v5
    v_lshlrev_b32 v4, 16, v79
    v_and_b32 v5, 0xffff0000, v79
    v_fmac_f32 v26, v39, v4
    v_fmac_f32 v27, v39, v5
    v_lshlrev_b32 v4, 5, v19
    ds_write_b128 v4, v[20:23]
    ds_write_b128 v4, v[24:27] offset:16
    s_waitcnt lgkmcnt(0)
    s_barrier
    v_and_b32 v4, 31, v19
    v_lshlrev_b32 v4, 2, v4
    v_lshrrev_b32 v5, 5, v19
    v_lshl_add_u32 v4, v5, 10, v4
    ds_read_b32 v20, v4 offset:0
    ds_read_b32 v21, v4 offset:128
    ds_read_b32 v22, v4 offset:256
    ds_read_b32 v23, v4 offset:384
    ds_read_b32 v24, v4 offset:512
    ds_read_b32 v25, v4 offset:640
    ds_read_b32 v26, v4 offset:768
    ds_read_b32 v27, v4 offset:896
    s_waitcnt lgkmcnt(0)
    v_add_f32 v20, v20, v21
    v_add_f32 v20, v20, v22
    v_add_f32 v20, v20, v23
    v_add_f32 v20, v20, v24
    v_add_f32 v20, v20, v25
    v_add_f32 v20, v20, v26
    v_add_f32 v20, v20, v27
    v_lshlrev_b32 v4, 2, v19
    ds_write_b32 v4, v20 offset:8192
    s_waitcnt lgkmcnt(0)
    s_barrier
    v_and_b32 v4, 31, v19
    v_lshlrev_b32 v4, 2, v4
    ds_read_b32 v20, v4 offset:8192
    ds_read_b32 v21, v4 offset:8320
    ds_read_b32 v22, v4 offset:8448
    ds_read_b32 v23, v4 offset:8576
    ds_read_b32 v24, v4 offset:8704
    ds_read_b32 v25, v4 offset:8832
    ds_read_b32 v26, v4 offset:8960
    ds_read_b32 v27, v4 offset:9088
    s_waitcnt lgkmcnt(0)
    v_add_f32 v20, v20, v21
    v_add_f32 v20, v20, v22
    v_add_f32 v20, v20, v23
    v_add_f32 v20, v20, v24
    v_add_f32 v20, v20, v25
    v_add_f32 v20, v20, v26
    v_add_f32 v20, v20, v27
    v_cvt_pk_bf16_f32 v20, v20, v20
    v_and_b32 v20, 0xffff0000, v20
    s_lshl_b32 s41, s16, 7
    s_add_u32 s41, s41, 0x5f0000
    buffer_store_dword v20, v4, s[4:7], s41 offen sc1
L_nomod_2:
    s_waitcnt vmcnt(0) lgkmcnt(0)
    s_barrier
    s_cmp_lg_u32 s18, 0
    s_cbranch_scc1 L_arr_3
    v_mov_b32 v5, 1
    s_mov_b64 exec, 1
    buffer_atomic_add v5, off, s[12:15], 0 offset:16 sc1
    s_mov_b64 exec, -1
L_arr_3:
    s_load_dwordx2 s[44:45], s[0:1], 0
    s_waitcnt lgkmcnt(0)
    s_mov_b32 s8, s44
    s_mov_b32 s9, s45
    s_mov_b32 s10, 0x280000
    s_mov_b32 s11, 0x20000
    v_mul_u32_u24 v6, 1280, v2
    v_lshl_add_u32 v6, v1, 3, v6
    s_mul_i32 s41, s16, 20480
    s_mul_i32 s42, s18, 320
    s_add_u32 s41, s41, s42
    buffer_load_dwordx2 v[60:61], v6, s[8:11], s41 offen offset:0
    buffer_load_dwordx2 v[62:63], v6, s[8:11], s41 offen offset:32
    buffer_load_dwordx2 v[64:65], v6, s[8:11], s41 offen offset:64
    buffer_load_dwordx2 v[66:67], v6, s[8:11], s41 offen offset:96
    buffer_load_dwordx2 v[68:69], v6, s[8:11], s41 offen offset:128
    buffer_load_dwordx2 v[70:71], v6, s[8:11], s41 offen offset:160
    buffer_load_dwordx2 v[72:73], v6, s[8:11], s41 offen offset:192
    buffer_load_dwordx2 v[74:75], v6, s[8:11], s41 offen offset:224
    buffer_load_dwordx2 v[76:77], v6, s[8:11], s41 offen offset:256
    buffer_load_dwordx2 v[78:79], v6, s[8:11], s41 offen offset:288
    v_lshlrev_b32 v7, 4, v1
    s_mul_i32 s42, s18, 640
    s_waitcnt vmcnt(0)
    v_lshlrev_b32 v20, 16, v60
    v_and_b32 v21, 0xffff0000, v60
    v_lshlrev_b32 v22, 16, v61
    v_and_b32 v23, 0xffff0000, v61
    v_lshlrev_b32 v24, 16, v62
    v_and_b32 v25, 0xffff0000, v62
    v_lshlrev_b32 v26, 16, v63
    v_and_b32 v27, 0xffff0000, v63
    v_lshlrev_b32 v28, 16, v64
    v_and_b32 v29, 0xffff0000, v64
    v_lshlrev_b32 v30, 16, v65
    v_and_b32 v31, 0xffff0000, v65
    v_lshlrev_b32 v32, 16, v66
    v_and_b32 v33, 0xffff0000, v66
    v_lshlrev_b32 v34, 16, v67
    v_and_b32 v35, 0xffff0000, v67
    v_lshlrev_b32 v36, 16, v68
    v_and_b32 v37, 0xffff0000, v68
    v_lshlrev_b32 v38, 16, v69
    v_and_b32 v39, 0xffff0000, v69
    v_lshlrev_b32 v40, 16, v70
    v_and_b32 v41, 0xffff0000, v70
    v_lshlrev_b32 v42, 16, v71
    v_and_b32 v43, 0xffff0000, v71
    v_lshlrev_b32 v44, 16, v72
    v_and_b32 v45, 0xffff0000, v72
    v_lshlrev_b32 v46, 16, v73
    v_and_b32 v47, 0xffff0000, v73
    v_lshlrev_b32 v48, 16, v74
    v_and_b32 v49, 0xffff0000, v74
    v_lshlrev_b32 v50, 16, v75
    v_and_b32 v51, 0xffff0000, v75
    v_lshlrev_b32 v52, 16, v76
    v_and_b32 v53, 0xffff0000, v76
    v_lshlrev_b32 v54, 16, v77
    v_and_b32 v55, 0xffff0000, v77
    v_lshlrev_b32 v56, 16, v78
    v_and_b32 v57, 0xffff0000, v78
    v_lshlrev_b32 v58, 16, v79
    v_and_b32 v59, 0xffff0000, v79
    v_mov_b32 v4, 0
    v_mov_b32 v5, 0
    v_pk_add_f32 v[4:5], v[4:5], v[20:21]
    v_pk_add_f32 v[4:5], v[4:5], v[22:23]
    v_pk_add_f32 v[4:5], v[4:5], v[24:25]
    v_pk_add_f32 v[4:5], v[4:5], v[26:27]
    v_pk_add_f32 v[4:5], v[4:5], v[28:29]
    v_pk_add_f32 v[4:5], v[4:5], v[30:31]
    v_pk_add_f32 v[4:5], v[4:5], v[32:33]
    v_pk_add_f32 v[4:5], v[4:5], v[34:35]
    v_pk_add_f32 v[4:5], v[4:5], v[36:37]
    v_pk_add_f32 v[4:5], v[4:5], v[38:39]
    v_pk_add_f32 v[4:5], v[4:5], v[40:41]
    v_pk_add_f32 v[4:5], v[4:5], v[42:43]
    v_pk_add_f32 v[4:5], v[4:5], v[44:45]
    v_pk_add_f32 v[4:5], v[4:5], v[46:47]
    v_pk_add_f32 v[4:5], v[4:5], v[48:49]
    v_pk_add_f32 v[4:5], v[4:5], v[50:51]
    v_pk_add_f32 v[4:5], v[4:5], v[52:53]
    v_pk_add_f32 v[4:5], v[4:5], v[54:55]
    v_pk_add_f32 v[4:5], v[4:5], v[56:57]
    v_pk_add_f32 v[4:5], v[4:5], v[58:59]
    v_add_f32 v4, v4, v5
    v_mov_b32 v5, v4
    s_nop 1
    v_permlane16_swap_b32 v4, v5
    v_add_f32 v4, v4, v5
    v_mov_b32 v5, v4
    s_nop 1
    v_permlane32_swap_b32 v4, v5
    v_add_f32 v4, v4, v5
    s_lshl_b32 s41, s18, 6
    v_lshlrev_b32 v6, 2, v2
    v_add_u32 v7, s41, v6
    s_barrier
    ds_write_b32 v7, v4
    s_waitcnt lgkmcnt(0)
    s_barrier
    ds_read_b32 v8, v6 offset:0
    ds_read_b32 v9, v6 offset:64
    ds_read_b32 v10, v6 offset:128
    ds_read_b32 v11, v6 offset:192
    s_waitcnt lgkmcnt(0)
    v_add_f32 v8, v8, v9
    v_add_f32 v10, v10, v11
    v_add_f32 v8, v8, v10
    v_mul_f32 v8, 0x3acccccd, v8
    v_mov_b32 v4, 0
    v_sub_f32 v5, v20, v8
    v_fmac_f32 v4, v5, v5
    v_sub_f32 v5, v21, v8
    v_fmac_f32 v4, v5, v5
    v_sub_f32 v5, v22, v8
    v_fmac_f32 v4, v5, v5
    v_sub_f32 v5, v23, v8
    v_fmac_f32 v4, v5, v5
    v_sub_f32 v5, v24, v8
    v_fmac_f32 v4, v5, v5
    v_sub_f32 v5, v25, v8
    v_fmac_f32 v4, v5, v5
    v_sub_f32 v5, v26, v8
    v_fmac_f32 v4, v5, v5
    v_sub_f32 v5, v27, v8
    v_fmac_f32 v4, v5, v5
    v_sub_f32 v5, v28, v8
    v_fmac_f32 v4, v5, v5
    v_sub_f32 v5, v29, v8
    v_fmac_f32 v4, v5, v5
    v_sub_f32 v5, v30, v8
    v_fmac_f32 v4, v5, v5
    v_sub_f32 v5, v31, v8
    v_fmac_f32 v4, v5, v5
    v_sub_f32 v5, v32, v8
    v_fmac_f32 v4, v5, v5
    v_sub_f32 v5, v33, v8
    v_fmac_f32 v4, v5, v5
    v_sub_f32 v5, v34, v8
    v_fmac_f32 v4, v5, v5
    v_sub_f32 v5, v35, v8
    v_fmac_f32 v4, v5, v5
    v_sub_f32 v5, v36, v8
    v_fmac_f32 v4, v5, v5
    v_sub_f32 v5, v37, v8
    v_fmac_f32 v4, v5, v5
    v_sub_f32 v5, v38, v8
    v_fmac_f32 v4, v5, v5
    v_sub_f32 v5, v39, v8
    v_fmac_f32 v4, v5, v5
    v_sub_f32 v5, v40, v8
    v_fmac_f32 v4, v5, v5
    v_sub_f32 v5, v41, v8
    v_fmac_f32 v4, v5, v5
    v_sub_f32 v5, v42, v8
    v_fmac_f32 v4, v5, v5
    v_sub_f32 v5, v43, v8
    v_fmac_f32 v4, v5, v5
    v_sub_f32 v5, v44, v8
    v_fmac_f32 v4, v5, v5
    v_sub_f32 v5, v45, v8
    v_fmac_f32 v4, v5, v5
    v_sub_f32 v5, v46, v8
    v_fmac_f32 v4, v5, v5
    v_sub_f32 v5, v47, v8
    v_fmac_f32 v4, v5, v5
    v_sub_f32 v5, v48, v8
    v_fmac_f32 v4, v5, v5
    v_sub_f32 v5, v49, v8
    v_fmac_f32 v4, v5, v5
    v_sub_f32 v5, v50, v8
    v_fmac_f32 v4, v5, v5
    v_sub_f32 v5, v51, v8
    v_fmac_f32 v4, v5, v5
    v_sub_f32 v5, v52, v8
    v_fmac_f32 v4, v5, v5
    v_sub_f32 v5, v53, v8
    v_fmac_f32 v4, v5, v5
    v_sub_f32 v5, v54, v8
    v_fmac_f32 v4, v5, v5
    v_sub_f32 v5, v55, v8
    v_fmac_f32 v4, v5, v5
    v_sub_f32 v5, v56, v8
    v_fmac_f32 v4, v5, v5
    v_sub_f32 v5, v57, v8
    v_fmac_f32 v4, v5, v5
    v_sub_f32 v5, v58, v8
    v_fmac_f32 v4, v5, v5
    v_sub_f32 v5, v59, v8
    v_fmac_f32 v4, v5, v5
    v_mov_b32 v5, v4
    s_nop 1
    v_permlane16_swap_b32 v4, v5
    v_add_f32 v4, v4, v5
    v_mov_b32 v5, v4
    s_nop 1
    v_permlane32_swap_b32 v4, v5
    v_add_f32 v4, v4, v5
    ds_write_b32 v7, v4 offset:256
    s_waitcnt lgkmcnt(0)
    s_barrier
    ds_read_b32 v9, v6 offset:256
    ds_read_b32 v10, v6 offset:320
    ds_read_b32 v11, v6 offset:384
    ds_read_b32 v12, v6 offset:448
    s_waitcnt lgkmcnt(0)
    v_add_f32 v9, v9, v10
    v_add_f32 v11, v11, v12
    v_add_f32 v9, v9, v11
    v_mul_f32 v9, 0x3acccccd, v9
    v_cvt_pk_bf16_f32 v4, v8, v9
    v_lshlrev_b32 v8, 16, v4
    v_and_b32 v9, 0xffff0000, v4
    v_add_f32 v9, 0x3727c5ac, v9
    v_cvt_pk_bf16_f32 v9, v9, v9
    v_and_b32 v9, 0xffff0000, v9
    v_sqrt_f32 v9, v9
    s_nop 0
    v_cvt_pk_bf16_f32 v9, v9, v9
    v_and_b32 v9, 0xffff0000, v9
    v_rcp_f32 v10, v9
    v_sub_f32 v20, v20, v8
    v_sub_f32 v21, v21, v8
    v_cvt_pk_bf16_f32 v4, v20, v21
    v_lshlrev_b32 v20, 16, v4
    v_and_b32 v21, 0xffff0000, v4
    v_mul_f32 v5, v20, v10
    v_fma_f32 v20, -v5, v9, v20
    v_fma_f32 v20, v20, v10, v5
    v_mul_f32 v5, v21, v10
    v_fma_f32 v21, -v5, v9, v21
    v_fma_f32 v21, v21, v10, v5
    v_cvt_pk_bf16_f32 v4, v20, v21
    v_lshlrev_b32 v20, 16, v4
    v_and_b32 v21, 0xffff0000, v4
    v_sub_f32 v22, v22, v8
    v_sub_f32 v23, v23, v8
    v_cvt_pk_bf16_f32 v4, v22, v23
    v_lshlrev_b32 v22, 16, v4
    v_and_b32 v23, 0xffff0000, v4
    v_mul_f32 v5, v22, v10
    v_fma_f32 v22, -v5, v9, v22
    v_fma_f32 v22, v22, v10, v5
    v_mul_f32 v5, v23, v10
    v_fma_f32 v23, -v5, v9, v23
    v_fma_f32 v23, v23, v10, v5
    v_cvt_pk_bf16_f32 v4, v22, v23
    v_lshlrev_b32 v22, 16, v4
    v_and_b32 v23, 0xffff0000, v4
    v_sub_f32 v24, v24, v8
    v_sub_f32 v25, v25, v8
    v_cvt_pk_bf16_f32 v4, v24, v25
    v_lshlrev_b32 v24, 16, v4
    v_and_b32 v25, 0xffff0000, v4
    v_mul_f32 v5, v24, v10
    v_fma_f32 v24, -v5, v9, v24
    v_fma_f32 v24, v24, v10, v5
    v_mul_f32 v5, v25, v10
    v_fma_f32 v25, -v5, v9, v25
    v_fma_f32 v25, v25, v10, v5
    v_cvt_pk_bf16_f32 v4, v24, v25
    v_lshlrev_b32 v24, 16, v4
    v_and_b32 v25, 0xffff0000, v4
    v_sub_f32 v26, v26, v8
    v_sub_f32 v27, v27, v8
    v_cvt_pk_bf16_f32 v4, v26, v27
    v_lshlrev_b32 v26, 16, v4
    v_and_b32 v27, 0xffff0000, v4
    v_mul_f32 v5, v26, v10
    v_fma_f32 v26, -v5, v9, v26
    v_fma_f32 v26, v26, v10, v5
    v_mul_f32 v5, v27, v10
    v_fma_f32 v27, -v5, v9, v27
    v_fma_f32 v27, v27, v10, v5
    v_cvt_pk_bf16_f32 v4, v26, v27
    v_lshlrev_b32 v26, 16, v4
    v_and_b32 v27, 0xffff0000, v4
    v_sub_f32 v28, v28, v8
    v_sub_f32 v29, v29, v8
    v_cvt_pk_bf16_f32 v4, v28, v29
    v_lshlrev_b32 v28, 16, v4
    v_and_b32 v29, 0xffff0000, v4
    v_mul_f32 v5, v28, v10
    v_fma_f32 v28, -v5, v9, v28
    v_fma_f32 v28, v28, v10, v5
    v_mul_f32 v5, v29, v10
    v_fma_f32 v29, -v5, v9, v29
    v_fma_f32 v29, v29, v10, v5
    v_cvt_pk_bf16_f32 v4, v28, v29
    v_lshlrev_b32 v28, 16, v4
    v_and_b32 v29, 0xffff0000, v4
    v_sub_f32 v30, v30, v8
    v_sub_f32 v31, v31, v8
    v_cvt_pk_bf16_f32 v4, v30, v31
    v_lshlrev_b32 v30, 16, v4
    v_and_b32 v31, 0xffff0000, v4
    v_mul_f32 v5, v30, v10
    v_fma_f32 v30, -v5, v9, v30
    v_fma_f32 v30, v30, v10, v5
    v_mul_f32 v5, v31, v10
    v_fma_f32 v31, -v5, v9, v31
    v_fma_f32 v31, v31, v10, v5
    v_cvt_pk_bf16_f32 v4, v30, v31
    v_lshlrev_b32 v30, 16, v4
    v_and_b32 v31, 0xffff0000, v4
    v_sub_f32 v32, v32, v8
    v_sub_f32 v33, v33, v8
    v_cvt_pk_bf16_f32 v4, v32, v33
    v_lshlrev_b32 v32, 16, v4
    v_and_b32 v33, 0xffff0000, v4
    v_mul_f32 v5, v32, v10
    v_fma_f32 v32, -v5, v9, v32
    v_fma_f32 v32, v32, v10, v5
    v_mul_f32 v5, v33, v10
    v_fma_f32 v33, -v5, v9, v33
    v_fma_f32 v33, v33, v10, v5
    v_cvt_pk_bf16_f32 v4, v32, v33
    v_lshlrev_b32 v32, 16, v4
    v_and_b32 v33, 0xffff0000, v4
    v_sub_f32 v34, v34, v8
    v_sub_f32 v35, v35, v8
    v_cvt_pk_bf16_f32 v4, v34, v35
    v_lshlrev_b32 v34, 16, v4
    v_and_b32 v35, 0xffff0000, v4
    v_mul_f32 v5, v34, v10
    v_fma_f32 v34, -v5, v9, v34
    v_fma_f32 v34, v34, v10, v5
    v_mul_f32 v5, v35, v10
    v_fma_f32 v35, -v5, v9, v35
    v_fma_f32 v35, v35, v10, v5
    v_cvt_pk_bf16_f32 v4, v34, v35
    v_lshlrev_b32 v34, 16, v4
    v_and_b32 v35, 0xffff0000, v4
    v_sub_f32 v36, v36, v8
    v_sub_f32 v37, v37, v8
    v_cvt_pk_bf16_f32 v4, v36, v37
    v_lshlrev_b32 v36, 16, v4
    v_and_b32 v37, 0xffff0000, v4
    v_mul_f32 v5, v36, v10
    v_fma_f32 v36, -v5, v9, v36
    v_fma_f32 v36, v36, v10, v5
    v_mul_f32 v5, v37, v10
    v_fma_f32 v37, -v5, v9, v37
    v_fma_f32 v37, v37, v10, v5
    v_cvt_pk_bf16_f32 v4, v36, v37
    v_lshlrev_b32 v36, 16, v4
    v_and_b32 v37, 0xffff0000, v4
    v_sub_f32 v38, v38, v8
    v_sub_f32 v39, v39, v8
    v_cvt_pk_bf16_f32 v4, v38, v39
    v_lshlrev_b32 v38, 16, v4
    v_and_b32 v39, 0xffff0000, v4
    v_mul_f32 v5, v38, v10
    v_fma_f32 v38, -v5, v9, v38
    v_fma_f32 v38, v38, v10, v5
    v_mul_f32 v5, v39, v10
    v_fma_f32 v39, -v5, v9, v39
    v_fma_f32 v39, v39, v10, v5
    v_cvt_pk_bf16_f32 v4, v38, v39
    v_lshlrev_b32 v38, 16, v4
    v_and_b32 v39, 0xffff0000, v4
    v_sub_f32 v40, v40, v8
    v_sub_f32 v41, v41, v8
    v_cvt_pk_bf16_f32 v4, v40, v41
    v_lshlrev_b32 v40, 16, v4
    v_and_b32 v41, 0xffff0000, v4
    v_mul_f32 v5, v40, v10
    v_fma_f32 v40, -v5, v9, v40
    v_fma_f32 v40, v40, v10, v5
    v_mul_f32 v5, v41, v10
    v_fma_f32 v41, -v5, v9, v41
    v_fma_f32 v41, v41, v10, v5
    v_cvt_pk_bf16_f32 v4, v40, v41
    v_lshlrev_b32 v40, 16, v4
    v_and_b32 v41, 0xffff0000, v4
    v_sub_f32 v42, v42, v8
    v_sub_f32 v43, v43, v8
    v_cvt_pk_bf16_f32 v4, v42, v43
    v_lshlrev_b32 v42, 16, v4
    v_and_b32 v43, 0xffff0000, v4
    v_mul_f32 v5, v42, v10
    v_fma_f32 v42, -v5, v9, v42
    v_fma_f32 v42, v42, v10, v5
    v_mul_f32 v5, v43, v10
    v_fma_f32 v43, -v5, v9, v43
    v_fma_f32 v43, v43, v10, v5
    v_cvt_pk_bf16_f32 v4, v42, v43
    v_lshlrev_b32 v42, 16, v4
    v_and_b32 v43, 0xffff0000, v4
    v_sub_f32 v44, v44, v8
    v_sub_f32 v45, v45, v8
    v_cvt_pk_bf16_f32 v4, v44, v45
    v_lshlrev_b32 v44, 16, v4
    v_and_b32 v45, 0xffff0000, v4
    v_mul_f32 v5, v44, v10
    v_fma_f32 v44, -v5, v9, v44
    v_fma_f32 v44, v44, v10, v5
    v_mul_f32 v5, v45, v10
    v_fma_f32 v45, -v5, v9, v45
    v_fma_f32 v45, v45, v10, v5
    v_cvt_pk_bf16_f32 v4, v44, v45
    v_lshlrev_b32 v44, 16, v4
    v_and_b32 v45, 0xffff0000, v4
    v_sub_f32 v46, v46, v8
    v_sub_f32 v47, v47, v8
    v_cvt_pk_bf16_f32 v4, v46, v47
    v_lshlrev_b32 v46, 16, v4
    v_and_b32 v47, 0xffff0000, v4
    v_mul_f32 v5, v46, v10
    v_fma_f32 v46, -v5, v9, v46
    v_fma_f32 v46, v46, v10, v5
    v_mul_f32 v5, v47, v10
    v_fma_f32 v47, -v5, v9, v47
    v_fma_f32 v47, v47, v10, v5
    v_cvt_pk_bf16_f32 v4, v46, v47
    v_lshlrev_b32 v46, 16, v4
    v_and_b32 v47, 0xffff0000, v4
    v_sub_f32 v48, v48, v8
    v_sub_f32 v49, v49, v8
    v_cvt_pk_bf16_f32 v4, v48, v49
    v_lshlrev_b32 v48, 16, v4
    v_and_b32 v49, 0xffff0000, v4
    v_mul_f32 v5, v48, v10
    v_fma_f32 v48, -v5, v9, v48
    v_fma_f32 v48, v48, v10, v5
    v_mul_f32 v5, v49, v10
    v_fma_f32 v49, -v5, v9, v49
    v_fma_f32 v49, v49, v10, v5
    v_cvt_pk_bf16_f32 v4, v48, v49
    v_lshlrev_b32 v48, 16, v4
    v_and_b32 v49, 0xffff0000, v4
    v_sub_f32 v50, v50, v8
    v_sub_f32 v51, v51, v8
    v_cvt_pk_bf16_f32 v4, v50, v51
    v_lshlrev_b32 v50, 16, v4
    v_and_b32 v51, 0xffff0000, v4
    v_mul_f32 v5, v50, v10
    v_fma_f32 v50, -v5, v9, v50
    v_fma_f32 v50, v50, v10, v5
    v_mul_f32 v5, v51, v10
    v_fma_f32 v51, -v5, v9, v51
    v_fma_f32 v51, v51, v10, v5
    v_cvt_pk_bf16_f32 v4, v50, v51
    v_lshlrev_b32 v50, 16, v4
    v_and_b32 v51, 0xffff0000, v4
    v_sub_f32 v52, v52, v8
    v_sub_f32 v53, v53, v8
    v_cvt_pk_bf16_f32 v4, v52, v53
    v_lshlrev_b32 v52, 16, v4
    v_and_b32 v53, 0xffff0000, v4
    v_mul_f32 v5, v52, v10
    v_fma_f32 v52, -v5, v9, v52
    v_fma_f32 v52, v52, v10, v5
    v_mul_f32 v5, v53, v10
    v_fma_f32 v53, -v5, v9, v53
    v_fma_f32 v53, v53, v10, v5
    v_cvt_pk_bf16_f32 v4, v52, v53
    v_lshlrev_b32 v52, 16, v4
    v_and_b32 v53, 0xffff0000, v4
    v_sub_f32 v54, v54, v8
    v_sub_f32 v55, v55, v8
    v_cvt_pk_bf16_f32 v4, v54, v55
    v_lshlrev_b32 v54, 16, v4
    v_and_b32 v55, 0xffff0000, v4
    v_mul_f32 v5, v54, v10
    v_fma_f32 v54, -v5, v9, v54
    v_fma_f32 v54, v54, v10, v5
    v_mul_f32 v5, v55, v10
    v_fma_f32 v55, -v5, v9, v55
    v_fma_f32 v55, v55, v10, v5
    v_cvt_pk_bf16_f32 v4, v54, v55
    v_lshlrev_b32 v54, 16, v4
    v_and_b32 v55, 0xffff0000, v4
    v_sub_f32 v56, v56, v8
    v_sub_f32 v57, v57, v8
    v_cvt_pk_bf16_f32 v4, v56, v57
    v_lshlrev_b32 v56, 16, v4
    v_and_b32 v57, 0xffff0000, v4
    v_mul_f32 v5, v56, v10
    v_fma_f32 v56, -v5, v9, v56
    v_fma_f32 v56, v56, v10, v5
    v_mul_f32 v5, v57, v10
    v_fma_f32 v57, -v5, v9, v57
    v_fma_f32 v57, v57, v10, v5
    v_cvt_pk_bf16_f32 v4, v56, v57
    v_lshlrev_b32 v56, 16, v4
    v_and_b32 v57, 0xffff0000, v4
    v_sub_f32 v58, v58, v8
    v_sub_f32 v59, v59, v8
    v_cvt_pk_bf16_f32 v4, v58, v59
    v_lshlrev_b32 v58, 16, v4
    v_and_b32 v59, 0xffff0000, v4
    v_mul_f32 v5, v58, v10
    v_fma_f32 v58, -v5, v9, v58
    v_fma_f32 v58, v58, v10, v5
    v_mul_f32 v5, v59, v10
    v_fma_f32 v59, -v5, v9, v59
    v_fma_f32 v59, v59, v10, v5
    v_cvt_pk_bf16_f32 v4, v58, v59
    v_lshlrev_b32 v58, 16, v4
    v_and_b32 v59, 0xffff0000, v4
    s_cmp_lg_u32 s18, 0
    s_cbranch_scc1 L_wi_4
    s_mov_b32 s41, 16
    v_min_u32 v4, 0, v0
    v_lshlrev_b32 v4, 2, v4
L_wf_5:
    buffer_load_dword v5, v4, s[12:15], s41 offen sc1
    s_waitcnt vmcnt(0)
    v_cmp_gt_u32 vcc, 128, v5
    s_cbranch_vccz L_wfd_6
    s_sleep 6
    s_add_u32 s46, s46, 1
    s_cmp_lt_u32 s46, 131072
    s_cbranch_scc1 L_wf_5
    s_branch L_end
L_wfd_6:
L_wi_4:
    s_barrier
    v_lshlrev_b32 v7, 4, v1
    s_mul_i32 s42, s18, 640
    s_add_u32 s43, s42, 0x5f0a00
    buffer_load_dwordx4 v[80:83], v7, s[4:7], s43 offen offset:0 sc1
    buffer_load_dwordx4 v[84:87], v7, s[4:7], s43 offen offset:64 sc1
    buffer_load_dwordx4 v[88:91], v7, s[4:7], s43 offen offset:128 sc1
    buffer_load_dwordx4 v[92:95], v7, s[4:7], s43 offen offset:192 sc1
    buffer_load_dwordx4 v[96:99], v7, s[4:7], s43 offen offset:256 sc1
    buffer_load_dwordx4 v[100:103], v7, s[4:7], s43 offen offset:320 sc1
    buffer_load_dwordx4 v[104:107], v7, s[4:7], s43 offen offset:384 sc1
    buffer_load_dwordx4 v[108:111], v7, s[4:7], s43 offen offset:448 sc1
    buffer_load_dwordx4 v[112:115], v7, s[4:7], s43 offen offset:512 sc1
    buffer_load_dwordx4 v[116:119], v7, s[4:7], s43 offen offset:576 sc1
    s_add_u32 s43, s42, 0x5f0000
    buffer_load_dwordx4 v[120:123], v7, s[4:7], s43 offen offset:0 sc1
    buffer_load_dwordx4 v[124:127], v7, s[4:7], s43 offen offset:64 sc1
    buffer_load_dwordx4 v[128:131], v7, s[4:7], s43 offen offset:128 sc1
    buffer_load_dwordx4 v[132:135], v7, s[4:7], s43 offen offset:192 sc1
    buffer_load_dwordx4 v[136:139], v7, s[4:7], s43 offen offset:256 sc1
    buffer_load_dwordx4 v[140:143], v7, s[4:7], s43 offen offset:320 sc1
    buffer_load_dwordx4 v[144:147], v7, s[4:7], s43 offen offset:384 sc1
    buffer_load_dwordx4 v[148:151], v7, s[4:7], s43 offen offset:448 sc1
    buffer_load_dwordx4 v[152:155], v7, s[4:7], s43 offen offset:512 sc1
    buffer_load_dwordx4 v[156:159], v7, s[4:7], s43 offen offset:576 sc1
    s_waitcnt vmcnt(0)
    v_add_f32 v80, 1.0, v80
    v_add_f32 v81, 1.0, v81
    v_cvt_pk_bf16_f32 v4, v80, v81
    v_lshlrev_b32 v80, 16, v4
    v_and_b32 v81, 0xffff0000, v4
    v_pk_mul_f32 v[20:21], v[20:21], v[80:81]
    v_cvt_pk_bf16_f32 v4, v20, v21
    v_lshlrev_b32 v20, 16, v4
    v_and_b32 v21, 0xffff0000, v4
    v_pk_add_f32 v[20:21], v[20:21], v[120:121]
    v_cvt_pk_bf16_f32 v160, v20, v21
    v_add_f32 v82, 1.0, v82
    v_add_f32 v83, 1.0, v83
    v_cvt_pk_bf16_f32 v4, v82, v83
    v_lshlrev_b32 v82, 16, v4
    v_and_b32 v83, 0xffff0000, v4
    v_pk_mul_f32 v[22:23], v[22:23], v[82:83]
    v_cvt_pk_bf16_f32 v4, v22, v23
    v_lshlrev_b32 v22, 16, v4
    v_and_b32 v23, 0xffff0000, v4
    v_pk_add_f32 v[22:23], v[22:23], v[122:123]
    v_cvt_pk_bf16_f32 v161, v22, v23
    v_add_f32 v84, 1.0, v84
    v_add_f32 v85, 1.0, v85
    v_cvt_pk_bf16_f32 v4, v84, v85
    v_lshlrev_b32 v84, 16, v4
    v_and_b32 v85, 0xffff0000, v4
    v_pk_mul_f32 v[24:25], v[24:25], v[84:85]
    v_cvt_pk_bf16_f32 v4, v24, v25
    v_lshlrev_b32 v24, 16, v4
    v_and_b32 v25, 0xffff0000, v4
    v_pk_add_f32 v[24:25], v[24:25], v[124:125]
    v_cvt_pk_bf16_f32 v162, v24, v25
    v_add_f32 v86, 1.0, v86
    v_add_f32 v87, 1.0, v87
    v_cvt_pk_bf16_f32 v4, v86, v87
    v_lshlrev_b32 v86, 16, v4
    v_and_b32 v87, 0xffff0000, v4
    v_pk_mul_f32 v[26:27], v[26:27], v[86:87]
    v_cvt_pk_bf16_f32 v4, v26, v27
    v_lshlrev_b32 v26, 16, v4
    v_and_b32 v27, 0xffff0000, v4
    v_pk_add_f32 v[26:27], v[26:27], v[126:127]
    v_cvt_pk_bf16_f32 v163, v26, v27
    v_add_f32 v88, 1.0, v88
    v_add_f32 v89, 1.0, v89
    v_cvt_pk_bf16_f32 v4, v88, v89
    v_lshlrev_b32 v88, 16, v4
    v_and_b32 v89, 0xffff0000, v4
    v_pk_mul_f32 v[28:29], v[28:29], v[88:89]
    v_cvt_pk_bf16_f32 v4, v28, v29
    v_lshlrev_b32 v28, 16, v4
    v_and_b32 v29, 0xffff0000, v4
    v_pk_add_f32 v[28:29], v[28:29], v[128:129]
    v_cvt_pk_bf16_f32 v164, v28, v29
    v_add_f32 v90, 1.0, v90
    v_add_f32 v91, 1.0, v91
    v_cvt_pk_bf16_f32 v4, v90, v91
    v_lshlrev_b32 v90, 16, v4
    v_and_b32 v91, 0xffff0000, v4
    v_pk_mul_f32 v[30:31], v[30:31], v[90:91]
    v_cvt_pk_bf16_f32 v4, v30, v31
    v_lshlrev_b32 v30, 16, v4
    v_and_b32 v31, 0xffff0000, v4
    v_pk_add_f32 v[30:31], v[30:31], v[130:131]
    v_cvt_pk_bf16_f32 v165, v30, v31
    v_add_f32 v92, 1.0, v92
    v_add_f32 v93, 1.0, v93
    v_cvt_pk_bf16_f32 v4, v92, v93
    v_lshlrev_b32 v92, 16, v4
    v_and_b32 v93, 0xffff0000, v4
    v_pk_mul_f32 v[32:33], v[32:33], v[92:93]
    v_cvt_pk_bf16_f32 v4, v32, v33
    v_lshlrev_b32 v32, 16, v4
    v_and_b32 v33, 0xffff0000, v4
    v_pk_add_f32 v[32:33], v[32:33], v[132:133]
    v_cvt_pk_bf16_f32 v166, v32, v33
    v_add_f32 v94, 1.0, v94
    v_add_f32 v95, 1.0, v95
    v_cvt_pk_bf16_f32 v4, v94, v95
    v_lshlrev_b32 v94, 16, v4
    v_and_b32 v95, 0xffff0000, v4
    v_pk_mul_f32 v[34:35], v[34:35], v[94:95]
    v_cvt_pk_bf16_f32 v4, v34, v35
    v_lshlrev_b32 v34, 16, v4
    v_and_b32 v35, 0xffff0000, v4
    v_pk_add_f32 v[34:35], v[34:35], v[134:135]
    v_cvt_pk_bf16_f32 v167, v34, v35
    v_add_f32 v96, 1.0, v96
    v_add_f32 v97, 1.0, v97
    v_cvt_pk_bf16_f32 v4, v96, v97
    v_lshlrev_b32 v96, 16, v4
    v_and_b32 v97, 0xffff0000, v4
    v_pk_mul_f32 v[36:37], v[36:37], v[96:97]
    v_cvt_pk_bf16_f32 v4, v36, v37
    v_lshlrev_b32 v36, 16, v4
    v_and_b32 v37, 0xffff0000, v4
    v_pk_add_f32 v[36:37], v[36:37], v[136:137]
    v_cvt_pk_bf16_f32 v168, v36, v37
    v_add_f32 v98, 1.0, v98
    v_add_f32 v99, 1.0, v99
    v_cvt_pk_bf16_f32 v4, v98, v99
    v_lshlrev_b32 v98, 16, v4
    v_and_b32 v99, 0xffff0000, v4
    v_pk_mul_f32 v[38:39], v[38:39], v[98:99]
    v_cvt_pk_bf16_f32 v4, v38, v39
    v_lshlrev_b32 v38, 16, v4
    v_and_b32 v39, 0xffff0000, v4
    v_pk_add_f32 v[38:39], v[38:39], v[138:139]
    v_cvt_pk_bf16_f32 v169, v38, v39
    v_add_f32 v100, 1.0, v100
    v_add_f32 v101, 1.0, v101
    v_cvt_pk_bf16_f32 v4, v100, v101
    v_lshlrev_b32 v100, 16, v4
    v_and_b32 v101, 0xffff0000, v4
    v_pk_mul_f32 v[40:41], v[40:41], v[100:101]
    v_cvt_pk_bf16_f32 v4, v40, v41
    v_lshlrev_b32 v40, 16, v4
    v_and_b32 v41, 0xffff0000, v4
    v_pk_add_f32 v[40:41], v[40:41], v[140:141]
    v_cvt_pk_bf16_f32 v170, v40, v41
    v_add_f32 v102, 1.0, v102
    v_add_f32 v103, 1.0, v103
    v_cvt_pk_bf16_f32 v4, v102, v103
    v_lshlrev_b32 v102, 16, v4
    v_and_b32 v103, 0xffff0000, v4
    v_pk_mul_f32 v[42:43], v[42:43], v[102:103]
    v_cvt_pk_bf16_f32 v4, v42, v43
    v_lshlrev_b32 v42, 16, v4
    v_and_b32 v43, 0xffff0000, v4
    v_pk_add_f32 v[42:43], v[42:43], v[142:143]
    v_cvt_pk_bf16_f32 v171, v42, v43
    v_add_f32 v104, 1.0, v104
    v_add_f32 v105, 1.0, v105
    v_cvt_pk_bf16_f32 v4, v104, v105
    v_lshlrev_b32 v104, 16, v4
    v_and_b32 v105, 0xffff0000, v4
    v_pk_mul_f32 v[44:45], v[44:45], v[104:105]
    v_cvt_pk_bf16_f32 v4, v44, v45
    v_lshlrev_b32 v44, 16, v4
    v_and_b32 v45, 0xffff0000, v4
    v_pk_add_f32 v[44:45], v[44:45], v[144:145]
    v_cvt_pk_bf16_f32 v172, v44, v45
    v_add_f32 v106, 1.0, v106
    v_add_f32 v107, 1.0, v107
    v_cvt_pk_bf16_f32 v4, v106, v107
    v_lshlrev_b32 v106, 16, v4
    v_and_b32 v107, 0xffff0000, v4
    v_pk_mul_f32 v[46:47], v[46:47], v[106:107]
    v_cvt_pk_bf16_f32 v4, v46, v47
    v_lshlrev_b32 v46, 16, v4
    v_and_b32 v47, 0xffff0000, v4
    v_pk_add_f32 v[46:47], v[46:47], v[146:147]
    v_cvt_pk_bf16_f32 v173, v46, v47
    v_add_f32 v108, 1.0, v108
    v_add_f32 v109, 1.0, v109
    v_cvt_pk_bf16_f32 v4, v108, v109
    v_lshlrev_b32 v108, 16, v4
    v_and_b32 v109, 0xffff0000, v4
    v_pk_mul_f32 v[48:49], v[48:49], v[108:109]
    v_cvt_pk_bf16_f32 v4, v48, v49
    v_lshlrev_b32 v48, 16, v4
    v_and_b32 v49, 0xffff0000, v4
    v_pk_add_f32 v[48:49], v[48:49], v[148:149]
    v_cvt_pk_bf16_f32 v174, v48, v49
    v_add_f32 v110, 1.0, v110
    v_add_f32 v111, 1.0, v111
    v_cvt_pk_bf16_f32 v4, v110, v111
    v_lshlrev_b32 v110, 16, v4
    v_and_b32 v111, 0xffff0000, v4
    v_pk_mul_f32 v[50:51], v[50:51], v[110:111]
    v_cvt_pk_bf16_f32 v4, v50, v51
    v_lshlrev_b32 v50, 16, v4
    v_and_b32 v51, 0xffff0000, v4
    v_pk_add_f32 v[50:51], v[50:51], v[150:151]
    v_cvt_pk_bf16_f32 v175, v50, v51
    v_add_f32 v112, 1.0, v112
    v_add_f32 v113, 1.0, v113
    v_cvt_pk_bf16_f32 v4, v112, v113
    v_lshlrev_b32 v112, 16, v4
    v_and_b32 v113, 0xffff0000, v4
    v_pk_mul_f32 v[52:53], v[52:53], v[112:113]
    v_cvt_pk_bf16_f32 v4, v52, v53
    v_lshlrev_b32 v52, 16, v4
    v_and_b32 v53, 0xffff0000, v4
    v_pk_add_f32 v[52:53], v[52:53], v[152:153]
    v_cvt_pk_bf16_f32 v176, v52, v53
    v_add_f32 v114, 1.0, v114
    v_add_f32 v115, 1.0, v115
    v_cvt_pk_bf16_f32 v4, v114, v115
    v_lshlrev_b32 v114, 16, v4
    v_and_b32 v115, 0xffff0000, v4
    v_pk_mul_f32 v[54:55], v[54:55], v[114:115]
    v_cvt_pk_bf16_f32 v4, v54, v55
    v_lshlrev_b32 v54, 16, v4
    v_and_b32 v55, 0xffff0000, v4
    v_pk_add_f32 v[54:55], v[54:55], v[154:155]
    v_cvt_pk_bf16_f32 v177, v54, v55
    v_add_f32 v116, 1.0, v116
    v_add_f32 v117, 1.0, v117
    v_cvt_pk_bf16_f32 v4, v116, v117
    v_lshlrev_b32 v116, 16, v4
    v_and_b32 v117, 0xffff0000, v4
    v_pk_mul_f32 v[56:57], v[56:57], v[116:117]
    v_cvt_pk_bf16_f32 v4, v56, v57
    v_lshlrev_b32 v56, 16, v4
    v_and_b32 v57, 0xffff0000, v4
    v_pk_add_f32 v[56:57], v[56:57], v[156:157]
    v_cvt_pk_bf16_f32 v178, v56, v57
    v_add_f32 v118, 1.0, v118
    v_add_f32 v119, 1.0, v119
    v_cvt_pk_bf16_f32 v4, v118, v119
    v_lshlrev_b32 v118, 16, v4
    v_and_b32 v119, 0xffff0000, v4
    v_pk_mul_f32 v[58:59], v[58:59], v[118:119]
    v_cvt_pk_bf16_f32 v4, v58, v59
    v_lshlrev_b32 v58, 16, v4
    v_and_b32 v59, 0xffff0000, v4
    v_pk_add_f32 v[58:59], v[58:59], v[158:159]
    v_cvt_pk_bf16_f32 v179, v58, v59
    s_lshr_b32 s41, s16, 1
    s_mul_i32 s41, s41, 40960
    s_and_b32 s43, s16, 1
    s_lshl_b32 s43, s43, 10
    s_add_u32 s41, s41, s43
    s_mul_i32 s43, s18, 10240
    s_add_u32 s41, s41, s43
    s_add_u32 s41, s41, 0x600000
    s_add_u32 s43, s41, 0
    buffer_store_dwordx4 v[160:163], v3, s[4:7], s43 offen sc1
    s_add_u32 s43, s41, 2048
    buffer_store_dwordx4 v[164:167], v3, s[4:7], s43 offen sc1
    s_add_u32 s43, s41, 4096
    buffer_store_dwordx4 v[168:171], v3, s[4:7], s43 offen sc1
    s_add_u32 s43, s41, 6144
    buffer_store_dwordx4 v[172:175], v3, s[4:7], s43 offen sc1
    s_add_u32 s43, s41, 8192
    buffer_store_dwordx4 v[176:179], v3, s[4:7], s43 offen sc1
    s_lshl_b32 s22, s16, 2
    s_add_u32 s22, s22, 0x500000
    s_waitcnt vmcnt(0) lgkmcnt(0)
    s_barrier
    s_cmp_lg_u32 s18, 0
    s_cbranch_scc1 L_sig_7
    v_mov_b32 v4, 0
    v_mov_b32 v5, 1
    s_mov_b64 exec, 1
    buffer_store_dword v5, v4, s[4:7], s22 offen sc1
    s_mov_b64 exec, -1
L_sig_7:
    s_lshl_b32 s41, s18, 6
    v_add_u32 v19, s41, v0
    v_lshlrev_b32 v6, 4, v19
    v_mov_b32 v20, -1
    v_mov_b32 v21, -1
    v_mov_b32 v22, -1
    v_mov_b32 v23, -1
    v_mov_b32 v24, 0
    v_mov_b32 v25, 0
    v_mov_b32 v26, 0
    v_mov_b32 v27, 0
    s_add_u32 s41, s16, 0
    s_cmp_ge_u32 s41, 160
    s_cbranch_scc1 L_fill_8
    s_lshl_b32 s41, s41, 12
    s_add_u32 s41, s41, 0x100000
    buffer_store_dwordx4 v[20:23], v6, s[4:7], s41 offen sc1
L_fill_8:
    s_add_u32 s41, s16, 128
    s_cmp_ge_u32 s41, 160
    s_cbranch_scc1 L_fill_9
    s_lshl_b32 s41, s41, 12
    s_add_u32 s41, s41, 0x100000
    buffer_store_dwordx4 v[20:23], v6, s[4:7], s41 offen sc1
L_fill_9:
    s_add_u32 s41, s16, 0
    s_cmp_ge_u32 s41, 504
    s_cbranch_scc1 L_fill_10
    s_lshl_b32 s41, s41, 12
    s_add_u32 s41, s41, 0x208000
    buffer_store_dwordx4 v[20:23], v6, s[4:7], s41 offen sc1
L_fill_10:
    s_add_u32 s41, s16, 128
    s_cmp_ge_u32 s41, 504
    s_cbranch_scc1 L_fill_11
    s_lshl_b32 s41, s41, 12
    s_add_u32 s41, s41, 0x208000
    buffer_store_dwordx4 v[20:23], v6, s[4:7], s41 offen sc1
L_fill_11:
    s_add_u32 s41, s16, 256
    s_cmp_ge_u32 s41, 504
    s_cbranch_scc1 L_fill_12
    s_lshl_b32 s41, s41, 12
    s_add_u32 s41, s41, 0x208000
    buffer_store_dwordx4 v[20:23], v6, s[4:7], s41 offen sc1
L_fill_12:
    s_add_u32 s41, s16, 384
    s_cmp_ge_u32 s41, 504
    s_cbranch_scc1 L_fill_13
    s_lshl_b32 s41, s41, 12
    s_add_u32 s41, s41, 0x208000
    buffer_store_dwordx4 v[20:23], v6, s[4:7], s41 offen sc1
L_fill_13:
    s_add_u32 s41, s16, 0
    s_cmp_ge_u32 s41, 80
    s_cbranch_scc1 L_fill_14
    s_lshl_b32 s41, s41, 12
    s_add_u32 s41, s41, 0x400000
    buffer_store_dwordx4 v[20:23], v6, s[4:7], s41 offen sc1
L_fill_14:
    s_waitcnt vmcnt(0) lgkmcnt(0)
    s_barrier
    s_cmp_lg_u32 s18, 0
    s_cbranch_scc1 L_arr_15
    v_mov_b32 v5, 1
    s_mov_b64 exec, 1
    buffer_atomic_add v5, off, s[12:15], 0 offset:28 sc1
    s_mov_b64 exec, -1
L_arr_15:
    s_barrier
    s_mov_b32 s19, 0
    s_mov_b32 s40, 64
    s_cmp_eq_u32 s98, 4
    s_cbranch_scc1 L_q
    s_cmp_eq_u32 s98, 5
    s_cbranch_scc1 L_x5
    s_cmp_eq_u32 s98, 6
    s_cbranch_scc1 L_x6
    s_sub_u32 s16, s99, 11
    s_cmp_ge_u32 s99, 20
    s_cbranch_scc1 L_att
L_ff2:
    s_and_b32 s16, s99, 1
    s_lshr_b32 s17, s99, 1
    s_mov_b32 s41, 1280
    v_lshrrev_b32 v4, 2, v0
    v_mul_lo_u32 v4, v4, s41
    v_and_b32 v5, 3, v0
    v_lshl_add_u32 v8, v5, 4, v4
    v_lshrrev_b32 v4, 1, v0
    v_mul_lo_u32 v4, v4, s41
    v_and_b32 v5, 1, v0
    v_lshl_add_u32 v9, v5, 4, v4
    v_lshrrev_b32 v4, 2, v0
    v_and_b32 v5, 3, v0
    v_lshlrev_b32 v5, 3, v5
    v_lshl_add_u32 v10, v4, 6, v5
    v_add_u32 v10, s47, v10
    v_lshl_add_u32 v11, v4, 5, v5
    v_add_u32 v11, s47, v11
    s_load_dwordx2 s[44:45], s[0:1], 80
    s_waitcnt lgkmcnt(0)
    s_mov_b32 s8, s44
    s_mov_b32 s9, s45
    s_mov_b32 s10, 0x21c000
    s_mov_b32 s11, 0x20000
    s_lshl_b32 s20, s17, 7
    s_lshl_b32 s41, s18, 5
    s_add_u32 s20, s20, s41
    s_waitcnt lgkmcnt(0)
    s_add_u32 m0, s47, 0
    s_nop 0
    buffer_load_dwordx4 v9, s[8:11], s20 offen lds
    s_add_u32 s20, s20, 40960
    s_add_u32 m0, s47, 1024
    s_nop 0
    buffer_load_dwordx4 v9, s[8:11], s20 offen lds
    s_add_u32 s20, s20, 40960
    s_add_u32 m0, s47, 2048
    s_nop 0
    buffer_load_dwordx4 v9, s[8:11], s20 offen lds
    s_add_u32 s20, s20, 40960
    s_add_u32 m0, s47, 3072
    s_nop 0
    buffer_load_dwordx4 v9, s[8:11], s20 offen lds
    s_add_u32 s20, s20, 40960
    s_add_u32 m0, s47, 4096
    s_nop 0
    buffer_load_dwordx4 v9, s[8:11], s20 offen lds
    s_add_u32 s20, s20, 40960
    s_add_u32 m0, s47, 5120
    s_nop 0
    buffer_load_dwordx4 v9, s[8:11], s20 offen lds
    s_add_u32 s20, s20, 40960
    s_add_u32 m0, s47, 6144
    s_nop 0
    buffer_load_dwordx4 v9, s[8:11], s20 offen lds
    s_add_u32 s20, s20, 40960
    s_add_u32 m0, s47, 7168
    s_nop 0
    buffer_load_dwordx4 v9, s[8:11], s20 offen lds
    s_add_u32 s20, s20, 40960
    s_add_u32 m0, s47, 8192
    s_nop 0
    buffer_load_dwordx4 v9, s[8:11], s20 offen lds
    s_add_u32 s20, s20, 40960
    s_add_u32 m0, s47, 9216
    s_nop 0
    buffer_load_dwordx4 v9, s[8:11], s20 offen lds
    s_add_u32 s20, s20, 40960
    s_add_u32 m0, s47, 10240
    s_nop 0
    buffer_load_dwordx4 v9, s[8:11], s20 offen lds
    s_add_u32 s20, s20, 40960
    s_add_u32 m0, s47, 11264
    s_nop 0
    buffer_load_dwordx4 v9, s[8:11], s20 offen lds
    s_add_u32 s20, s20, 40960
    s_add_u32 m0, s47, 12288
    s_nop 0
    buffer_load_dwordx4 v9, s[8:11], s20 offen lds
    s_add_u32 s20, s20, 40960
    s_add_u32 m0, s47, 13312
    s_nop 0
    buffer_load_dwordx4 v9, s[8:11], s20 offen lds
    s_add_u32 s20, s20, 40960
    s_add_u32 m0, s47, 14336
    s_nop 0
    buffer_load_dwordx4 v9, s[8:11], s20 offen lds
    s_add_u32 s20, s20, 40960
    s_add_u32 m0, s47, 15360
    s_nop 0
    buffer_load_dwordx4 v9, s[8:11], s20 offen lds
    s_add_u32 s20, s20, 40960
    s_add_u32 m0, s47, 16384
    s_nop 0
    buffer_load_dwordx4 v9, s[8:11], s20 offen lds
    s_add_u32 s20, s20, 40960
    s_add_u32 m0, s47, 17408
    s_nop 0
    buffer_load_dwordx4 v9, s[8:11], s20 offen lds
    s_add_u32 s20, s20, 40960
    s_add_u32 m0, s47, 18432
    s_nop 0
    buffer_load_dwordx4 v9, s[8:11], s20 offen lds
    s_add_u32 s20, s20, 40960
    s_add_u32 m0, s47, 19456
    s_nop 0
    buffer_load_dwordx4 v9, s[8:11], s20 offen lds
    s_add_u32 s20, s20, 40960
    s_add_u32 m0, s47, 20480
    s_nop 0
    buffer_load_dwordx4 v9, s[8:11], s20 offen lds
    s_add_u32 s20, s20, 40960
    s_add_u32 m0, s47, 21504
    s_nop 0
    buffer_load_dwordx4 v9, s[8:11], s20 offen lds
    s_add_u32 s20, s20, 40960
    s_add_u32 m0, s47, 22528
    s_nop 0
    buffer_load_dwordx4 v9, s[8:11], s20 offen lds
    s_add_u32 s20, s20, 40960
    s_add_u32 m0, s47, 23552
    s_nop 0
    buffer_load_dwordx4 v9, s[8:11], s20 offen lds
    s_add_u32 s20, s20, 40960
    s_add_u32 m0, s47, 24576
    s_nop 0
    buffer_load_dwordx4 v9, s[8:11], s20 offen lds
    s_add_u32 s20, s20, 40960
    s_add_u32 m0, s47, 25600
    s_nop 0
    buffer_load_dwordx4 v9, s[8:11], s20 offen lds
    s_add_u32 s20, s20, 40960
    s_add_u32 m0, s47, 26624
    s_nop 0
    buffer_load_dwordx4 v9, s[8:11], s20 offen lds
    s_add_u32 s20, s20, 40960
    s_add_u32 m0, s47, 27648
    s_nop 0
    buffer_load_dwordx4 v9, s[8:11], s20 offen lds
    s_add_u32 s20, s20, 40960
    s_add_u32 m0, s47, 28672
    s_nop 0
    buffer_load_dwordx4 v9, s[8:11], s20 offen lds
    s_add_u32 s20, s20, 40960
    s_add_u32 m0, s47, 29696
    s_nop 0
    buffer_load_dwordx4 v9, s[8:11], s20 offen lds
    s_add_u32 s20, s20, 40960
    s_add_u32 m0, s47, 30720
    s_nop 0
    buffer_load_dwordx4 v9, s[8:11], s20 offen lds
    s_add_u32 s20, s20, 40960
    s_add_u32 m0, s47, 31744
    s_nop 0
    buffer_load_dwordx4 v9, s[8:11], s20 offen lds
    s_add_u32 s20, s20, 40960
    s_add_u32 m0, s47, 32768
    s_nop 0
    buffer_load_dwordx4 v9, s[8:11], s20 offen lds
    s_add_u32 s20, s20, 40960
    s_add_u32 m0, s47, 33792
    s_nop 0
    buffer_load_dwordx4 v9, s[8:11], s20 offen lds
    s_add_u32 s20, s20, 40960
    s_add_u32 m0, s47, 34816
    s_nop 0
    buffer_load_dwordx4 v9, s[8:11], s20 offen lds
    s_add_u32 s20, s20, 40960
    s_add_u32 m0, s47, 35840
    s_nop 0
    buffer_load_dwordx4 v9, s[8:11], s20 offen lds
    s_add_u32 s20, s20, 40960
    s_add_u32 m0, s47, 36864
    s_nop 0
    buffer_load_dwordx4 v9, s[8:11], s20 offen lds
    s_add_u32 s20, s20, 40960
    s_add_u32 m0, s47, 37888
    s_nop 0
    buffer_load_dwordx4 v9, s[8:11], s20 offen lds
    s_add_u32 s20, s20, 40960
    s_add_u32 m0, s47, 38912
    s_nop 0
    buffer_load_dwordx4 v9, s[8:11], s20 offen lds
    s_add_u32 s20, s20, 40960
    s_add_u32 m0, s47, 39936
    s_nop 0
    buffer_load_dwordx4 v9, s[8:11], s20 offen lds
    s_add_u32 s20, s20, 40960
    s_waitcnt vmcnt(39)
    ds_read_b64_tr_b16 a[0:1], v11 offset:0
    ds_read_b64_tr_b16 a[2:3], v11 offset:512
    s_waitcnt vmcnt(38)
    ds_read_b64_tr_b16 a[4:5], v11 offset:1024
    ds_read_b64_tr_b16 a[6:7], v11 offset:1536
    s_waitcnt vmcnt(37)
    ds_read_b64_tr_b16 a[8:9], v11 offset:2048
    ds_read_b64_tr_b16 a[10:11], v11 offset:2560
    s_waitcnt vmcnt(36)
    ds_read_b64_tr_b16 a[12:13], v11 offset:3072
    ds_read_b64_tr_b16 a[14:15], v11 offset:3584
    s_waitcnt vmcnt(35)
    ds_read_b64_tr_b16 a[16:17], v11 offset:4096
    ds_read_b64_tr_b16 a[18:19], v11 offset:4608
    s_waitcnt vmcnt(34)
    ds_read_b64_tr_b16 a[20:21], v11 offset:5120
    ds_read_b64_tr_b16 a[22:23], v11 offset:5632
    s_waitcnt vmcnt(33)
    ds_read_b64_tr_b16 a[24:25], v11 offset:6144
    ds_read_b64_tr_b16 a[26:27], v11 offset:6656
    s_waitcnt vmcnt(32)
    ds_read_b64_tr_b16 a[28:29], v11 offset:7168
    ds_read_b64_tr_b16 a[30:31], v11 offset:7680
    s_waitcnt vmcnt(31)
    ds_read_b64_tr_b16 a[32:33], v11 offset:8192
    ds_read_b64_tr_b16 a[34:35], v11 offset:8704
    s_waitcnt vmcnt(30)
    ds_read_b64_tr_b16 a[36:37], v11 offset:9216
    ds_read_b64_tr_b16 a[38:39], v11 offset:9728
    s_waitcnt vmcnt(29)
    ds_read_b64_tr_b16 a[40:41], v11 offset:10240
    ds_read_b64_tr_b16 a[42:43], v11 offset:10752
    s_waitcnt vmcnt(28)
    ds_read_b64_tr_b16 a[44:45], v11 offset:11264
    ds_read_b64_tr_b16 a[46:47], v11 offset:11776
    s_waitcnt vmcnt(27)
    ds_read_b64_tr_b16 a[48:49], v11 offset:12288
    ds_read_b64_tr_b16 a[50:51], v11 offset:12800
    s_waitcnt vmcnt(26)
    ds_read_b64_tr_b16 a[52:53], v11 offset:13312
    ds_read_b64_tr_b16 a[54:55], v11 offset:13824
    s_waitcnt vmcnt(25)
    ds_read_b64_tr_b16 a[56:57], v11 offset:14336
    ds_read_b64_tr_b16 a[58:59], v11 offset:14848
    s_waitcnt vmcnt(24)
    ds_read_b64_tr_b16 a[60:61], v11 offset:15360
    ds_read_b64_tr_b16 a[62:63], v11 offset:15872
    s_waitcnt vmcnt(23)
    ds_read_b64_tr_b16 a[64:65], v11 offset:16384
    ds_read_b64_tr_b16 a[66:67], v11 offset:16896
    s_waitcnt vmcnt(22)
    ds_read_b64_tr_b16 a[68:69], v11 offset:17408
    ds_read_b64_tr_b16 a[70:71], v11 offset:17920
    s_waitcnt vmcnt(21)
    ds_read_b64_tr_b16 a[72:73], v11 offset:18432
    ds_read_b64_tr_b16 a[74:75], v11 offset:18944
    s_waitcnt vmcnt(20)
    ds_read_b64_tr_b16 a[76:77], v11 offset:19456
    ds_read_b64_tr_b16 a[78:79], v11 offset:19968
    s_waitcnt vmcnt(19)
    ds_read_b64_tr_b16 a[80:81], v11 offset:20480
    ds_read_b64_tr_b16 a[82:83], v11 offset:20992
    s_waitcnt vmcnt(18)
    ds_read_b64_tr_b16 a[84:85], v11 offset:21504
    ds_read_b64_tr_b16 a[86:87], v11 offset:22016
    s_waitcnt vmcnt(17)
    ds_read_b64_tr_b16 a[88:89], v11 offset:22528
    ds_read_b64_tr_b16 a[90:91], v11 offset:23040
    s_waitcnt vmcnt(16)
    ds_read_b64_tr_b16 a[92:93], v11 offset:23552
    ds_read_b64_tr_b16 a[94:95], v11 offset:24064
    s_waitcnt vmcnt(15)
    ds_read_b64_tr_b16 a[96:97], v11 offset:24576
    ds_read_b64_tr_b16 a[98:99], v11 offset:25088
    s_waitcnt vmcnt(14)
    ds_read_b64_tr_b16 a[100:101], v11 offset:25600
    ds_read_b64_tr_b16 a[102:103], v11 offset:26112
    s_waitcnt vmcnt(13)
    ds_read_b64_tr_b16 a[104:105], v11 offset:26624
    ds_read_b64_tr_b16 a[106:107], v11 offset:27136
    s_waitcnt vmcnt(12)
    ds_read_b64_tr_b16 a[108:109], v11 offset:27648
    ds_read_b64_tr_b16 a[110:111], v11 offset:28160
    s_waitcnt vmcnt(11)
    ds_read_b64_tr_b16 a[112:113], v11 offset:28672
    ds_read_b64_tr_b16 a[114:115], v11 offset:29184
    s_waitcnt vmcnt(10)
    ds_read_b64_tr_b16 a[116:117], v11 offset:29696
    ds_read_b64_tr_b16 a[118:119], v11 offset:30208
    s_waitcnt vmcnt(9)
    ds_read_b64_tr_b16 a[120:121], v11 offset:30720
    ds_read_b64_tr_b16 a[122:123], v11 offset:31232
    s_waitcnt vmcnt(8)
    ds_read_b64_tr_b16 a[124:125], v11 offset:31744
    ds_read_b64_tr_b16 a[126:127], v11 offset:32256
    s_waitcnt vmcnt(7)
    ds_read_b64_tr_b16 a[128:129], v11 offset:32768
    ds_read_b64_tr_b16 a[130:131], v11 offset:33280
    s_waitcnt vmcnt(6)
    ds_read_b64_tr_b16 a[132:133], v11 offset:33792
    ds_read_b64_tr_b16 a[134:135], v11 offset:34304
    s_waitcnt vmcnt(5)
    ds_read_b64_tr_b16 a[136:137], v11 offset:34816
    ds_read_b64_tr_b16 a[138:139], v11 offset:35328
    s_waitcnt vmcnt(4)
    ds_read_b64_tr_b16 a[140:141], v11 offset:35840
    ds_read_b64_tr_b16 a[142:143], v11 offset:36352
    s_waitcnt vmcnt(3)
    ds_read_b64_tr_b16 a[144:145], v11 offset:36864
    ds_read_b64_tr_b16 a[146:147], v11 offset:37376
    s_waitcnt vmcnt(2)
    ds_read_b64_tr_b16 a[148:149], v11 offset:37888
    ds_read_b64_tr_b16 a[150:151], v11 offset:38400
    s_waitcnt vmcnt(1)
    ds_read_b64_tr_b16 a[152:153], v11 offset:38912
    ds_read_b64_tr_b16 a[154:155], v11 offset:39424
    s_waitcnt vmcnt(0)
    ds_read_b64_tr_b16 a[156:157], v11 offset:39936
    ds_read_b64_tr_b16 a[158:159], v11 offset:40448
    s_waitcnt lgkmcnt(0)
    s_add_u32 m0, s47, 0
    s_nop 0
    buffer_load_dwordx4 v9, s[8:11], s20 offen lds
    s_add_u32 s20, s20, 40960
    s_add_u32 m0, s47, 1024
    s_nop 0
    buffer_load_dwordx4 v9, s[8:11], s20 offen lds
    s_add_u32 s20, s20, 40960
    s_add_u32 m0, s47, 2048
    s_nop 0
    buffer_load_dwordx4 v9, s[8:11], s20 offen lds
    s_add_u32 s20, s20, 40960
    s_add_u32 m0, s47, 3072
    s_nop 0
    buffer_load_dwordx4 v9, s[8:11], s20 offen lds
    s_add_u32 s20, s20, 40960
    s_add_u32 m0, s47, 4096
    s_nop 0
    buffer_load_dwordx4 v9, s[8:11], s20 offen lds
    s_add_u32 s20, s20, 40960
    s_add_u32 m0, s47, 5120
    s_nop 0
    buffer_load_dwordx4 v9, s[8:11], s20 offen lds
    s_add_u32 s20, s20, 40960
    s_add_u32 m0, s47, 6144
    s_nop 0
    buffer_load_dwordx4 v9, s[8:11], s20 offen lds
    s_add_u32 s20, s20, 40960
    s_add_u32 m0, s47, 7168
    s_nop 0
    buffer_load_dwordx4 v9, s[8:11], s20 offen lds
    s_add_u32 s20, s20, 40960
    s_add_u32 m0, s47, 8192
    s_nop 0
    buffer_load_dwordx4 v9, s[8:11], s20 offen lds
    s_add_u32 s20, s20, 40960
    s_add_u32 m0, s47, 9216
    s_nop 0
    buffer_load_dwordx4 v9, s[8:11], s20 offen lds
    s_add_u32 s20, s20, 40960
    s_add_u32 m0, s47, 10240
    s_nop 0
    buffer_load_dwordx4 v9, s[8:11], s20 offen lds
    s_add_u32 s20, s20, 40960
    s_add_u32 m0, s47, 11264
    s_nop 0
    buffer_load_dwordx4 v9, s[8:11], s20 offen lds
    s_add_u32 s20, s20, 40960
    s_add_u32 m0, s47, 12288
    s_nop 0
    buffer_load_dwordx4 v9, s[8:11], s20 offen lds
    s_add_u32 s20, s20, 40960
    s_add_u32 m0, s47, 13312
    s_nop 0
    buffer_load_dwordx4 v9, s[8:11], s20 offen lds
    s_add_u32 s20, s20, 40960
    s_waitcnt vmcnt(13)
    ds_read_b64_tr_b16 a[160:161], v11 offset:0
    ds_read_b64_tr_b16 a[162:163], v11 offset:512
    s_waitcnt vmcnt(12)
    ds_read_b64_tr_b16 a[164:165], v11 offset:1024
    ds_read_b64_tr_b16 a[166:167], v11 offset:1536
    s_waitcnt vmcnt(11)
    ds_read_b64_tr_b16 a[168:169], v11 offset:2048
    ds_read_b64_tr_b16 a[170:171], v11 offset:2560
    s_waitcnt vmcnt(10)
    ds_read_b64_tr_b16 a[172:173], v11 offset:3072
    ds_read_b64_tr_b16 a[174:175], v11 offset:3584
    s_waitcnt vmcnt(9)
    ds_read_b64_tr_b16 a[176:177], v11 offset:4096
    ds_read_b64_tr_b16 a[178:179], v11 offset:4608
    s_waitcnt vmcnt(8)
    ds_read_b64_tr_b16 a[180:181], v11 offset:5120
    ds_read_b64_tr_b16 a[182:183], v11 offset:5632
    s_waitcnt vmcnt(7)
    ds_read_b64_tr_b16 a[184:185], v11 offset:6144
    ds_read_b64_tr_b16 a[186:187], v11 offset:6656
    s_waitcnt vmcnt(6)
    ds_read_b64_tr_b16 a[188:189], v11 offset:7168
    ds_read_b64_tr_b16 a[190:191], v11 offset:7680
    s_waitcnt vmcnt(5)
    ds_read_b64_tr_b16 a[192:193], v11 offset:8192
    ds_read_b64_tr_b16 a[194:195], v11 offset:8704
    s_waitcnt vmcnt(4)
    ds_read_b64_tr_b16 a[196:197], v11 offset:9216
    ds_read_b64_tr_b16 a[198:199], v11 offset:9728
    s_waitcnt vmcnt(3)
    ds_read_b64_tr_b16 a[200:201], v11 offset:10240
    ds_read_b64_tr_b16 a[202:203], v11 offset:10752
    s_waitcnt vmcnt(2)
    ds_read_b64_tr_b16 a[204:205], v11 offset:11264
    ds_read_b64_tr_b16 a[206:207], v11 offset:11776
    s_waitcnt vmcnt(1)
    ds_read_b64_tr_b16 a[208:209], v11 offset:12288
    ds_read_b64_tr_b16 a[210:211], v11 offset:12800
    s_waitcnt vmcnt(0)
    ds_read_b64_tr_b16 a[212:213], v11 offset:13312
    ds_read_b64_tr_b16 a[214:215], v11 offset:13824
    s_waitcnt lgkmcnt(0)
    s_lshl_b32 s20, s16, 10
    s_add_u32 s20, s20, 0x5b00000
    s_mov_b32 s21, 0
    s_add_u32 s21, s21, 0x52c000
    s_mov_b32 s22, 0x530000
    s_lshl_b32 s28, s17, 2
    s_add_u32 s28, s28, s18
    v_lshlrev_b32 v4, 4, v1
    s_lshl_b32 s41, s28, 6
    s_add_u32 s41, s41, 0x5f3200
    buffer_load_dwordx4 v[40:43], v4, s[4:7], s41 offen sc1
    s_lshr_b32 s26, s28, 1
    s_lshl_b32 s26, s26, 11
    s_lshl_b32 s41, s16, 10
    s_add_u32 s26, s26, s41
    s_and_b32 s41, s28, 1
    s_lshl_b32 s41, s41, 3
    s_add_u32 s26, s26, s41
    s_add_u32 s26, s26, 0x5500000
    v_mul_u32_u24 v46, 1280, v2
    v_lshl_add_u32 v46, v1, 3, v46
    s_mul_i32 s23, s16, 20480
    s_lshl_b32 s41, s28, 5
    s_add_u32 s23, s23, s41
    s_load_dwordx2 s[44:45], s[0:1], 104
    s_waitcnt lgkmcnt(0)
    s_mov_b32 s8, s44
    s_mov_b32 s9, s45
    s_mov_b32 s10, 0x280000
    s_mov_b32 s11, 0x20000
    v_min_u32 v10, 26, v0
    v_lshlrev_b32 v10, 2, v10
    s_mov_b32 s25, 0
    s_mul_i32 s41, s19, 110592
    s_add_u32 s20, s20, s41
    s_mul_i32 s41, s19, 128
    s_add_u32 s21, s21, s41
    s_mul_i32 s41, s19, 40960
    s_add_u32 s23, s23, s41
    s_mul_i32 s41, s19, 40960
    s_add_u32 s26, s26, s41
L_gload_18:
    v_min_u32 v4, 26, v0
    v_lshlrev_b32 v4, 2, v4
L_wf_20:
    buffer_load_dword v5, v4, s[4:7], s21 offen sc1
    s_waitcnt vmcnt(0)
    v_cmp_ne_u32 vcc, 1, v5
    s_cbranch_vccz L_wfd_21
    s_sleep 1
    s_add_u32 s46, s46, 1
    s_cmp_lt_u32 s46, 131072
    s_cbranch_scc1 L_wf_20
    s_branch L_end
L_wfd_21:
    s_lshl_b32 s38, s18, 10
    s_add_u32 s38, s38, s25
    s_mul_i32 s39, s18, 2048
    s_add_u32 s39, s39, s20
    s_add_u32 s20, s20, 110592
    s_add_u32 s21, s21, 128
    s_add_u32 m0, s38, 0
    s_nop 0
    buffer_load_dwordx4 v3, s[4:7], s39 offen sc1 lds
    s_add_u32 s39, s39, 8192
    s_add_u32 m0, s38, 4096
    s_nop 0
    buffer_load_dwordx4 v3, s[4:7], s39 offen sc1 lds
    s_add_u32 s39, s39, 8192
    s_add_u32 m0, s38, 8192
    s_nop 0
    buffer_load_dwordx4 v3, s[4:7], s39 offen sc1 lds
    s_add_u32 s39, s39, 8192
    s_add_u32 m0, s38, 12288
    s_nop 0
    buffer_load_dwordx4 v3, s[4:7], s39 offen sc1 lds
    s_add_u32 s39, s39, 8192
    s_add_u32 m0, s38, 16384
    s_nop 0
    buffer_load_dwordx4 v3, s[4:7], s39 offen sc1 lds
    s_add_u32 s39, s39, 8192
    s_add_u32 m0, s38, 20480
    s_nop 0
    buffer_load_dwordx4 v3, s[4:7], s39 offen sc1 lds
    s_add_u32 s39, s39, 8192
    s_add_u32 m0, s38, 24576
    s_nop 0
    buffer_load_dwordx4 v3, s[4:7], s39 offen sc1 lds
    s_add_u32 s39, s39, 8192
    s_add_u32 m0, s38, 28672
    s_nop 0
    buffer_load_dwordx4 v3, s[4:7], s39 offen sc1 lds
    s_add_u32 s39, s39, 8192
    s_add_u32 m0, s38, 32768
    s_nop 0
    buffer_load_dwordx4 v3, s[4:7], s39 offen sc1 lds
    s_add_u32 s39, s39, 8192
    s_add_u32 m0, s38, 36864
    s_nop 0
    buffer_load_dwordx4 v3, s[4:7], s39 offen sc1 lds
    s_add_u32 s39, s39, 8192
    s_add_u32 m0, s38, 40960
    s_nop 0
    buffer_load_dwordx4 v3, s[4:7], s39 offen sc1 lds
    s_add_u32 s39, s39, 8192
    s_add_u32 m0, s38, 45056
    s_nop 0
    buffer_load_dwordx4 v3, s[4:7], s39 offen sc1 lds
    s_add_u32 s39, s39, 8192
    s_add_u32 m0, s38, 49152
    s_nop 0
    buffer_load_dwordx4 v3, s[4:7], s39 offen sc1 lds
    s_add_u32 s39, s39, 8192
    s_cmp_ge_u32 s18, 2
    s_cbranch_scc1 L_dm_22
    s_add_u32 m0, s38, 53248
    s_nop 0
    buffer_load_dwordx4 v3, s[4:7], s39 offen sc1 lds
L_dm_22:
    s_add_u32 s39, s39, 8192
    buffer_load_dword v11, v10, s[4:7], s21 offen sc1
    s_mov_b32 s37, 0
    s_waitcnt vmcnt(0) lgkmcnt(0)
    s_branch L_ggo_19
L_gtop_16:
    s_waitcnt vmcnt(2)
L_ggo_19:
    s_barrier
    v_add_u32 v8, s25, v3
    s_add_u32 s27, s19, 1
    s_sub_u32 s25, 55296, s25
    ds_read_b128 v[16:19], v8 offset:0
    ds_read_b128 v[20:23], v8 offset:1024
    ds_read_b128 v[24:27], v8 offset:2048
    s_waitcnt lgkmcnt(2)
    v_mfma_f32_16x16x32_bf16 v[12:15], a[0:3], v[16:19], 0
    ds_read_b128 v[16:19], v8 offset:3072
    s_waitcnt lgkmcnt(2)
    v_mfma_f32_16x16x32_bf16 v[12:15], a[4:7], v[20:23], v[12:15]
    ds_read_b128 v[20:23], v8 offset:4096
    s_waitcnt lgkmcnt(2)
    v_mfma_f32_16x16x32_bf16 v[12:15], a[8:11], v[24:27], v[12:15]
    ds_read_b128 v[24:27], v8 offset:5120
    s_waitcnt lgkmcnt(2)
    v_mfma_f32_16x16x32_bf16 v[12:15], a[12:15], v[16:19], v[12:15]
    ds_read_b128 v[16:19], v8 offset:6144
    s_waitcnt lgkmcnt(2)
    v_mfma_f32_16x16x32_bf16 v[12:15], a[16:19], v[20:23], v[12:15]
    ds_read_b128 v[20:23], v8 offset:7168
    s_waitcnt lgkmcnt(2)
    v_mfma_f32_16x16x32_bf16 v[12:15], a[20:23], v[24:27], v[12:15]
    ds_read_b128 v[24:27], v8 offset:8192
    s_waitcnt lgkmcnt(2)
    v_mfma_f32_16x16x32_bf16 v[12:15], a[24:27], v[16:19], v[12:15]
    ds_read_b128 v[16:19], v8 offset:9216
    s_waitcnt lgkmcnt(2)
    v_mfma_f32_16x16x32_bf16 v[12:15], a[28:31], v[20:23], v[12:15]
    ds_read_b128 v[20:23], v8 offset:10240
    s_waitcnt lgkmcnt(2)
    v_mfma_f32_16x16x32_bf16 v[12:15], a[32:35], v[24:27], v[12:15]
    ds_read_b128 v[24:27], v8 offset:11264
    s_waitcnt lgkmcnt(2)
    v_mfma_f32_16x16x32_bf16 v[12:15], a[36:39], v[16:19], v[12:15]
    ds_read_b128 v[16:19], v8 offset:12288
    s_waitcnt lgkmcnt(2)
    v_mfma_f32_16x16x32_bf16 v[12:15], a[40:43], v[20:23], v[12:15]
    ds_read_b128 v[20:23], v8 offset:13312
    s_waitcnt lgkmcnt(2)
    v_mfma_f32_16x16x32_bf16 v[12:15], a[44:47], v[24:27], v[12:15]
    ds_read_b128 v[24:27], v8 offset:14336
    s_waitcnt lgkmcnt(2)
    v_mfma_f32_16x16x32_bf16 v[12:15], a[48:51], v[16:19], v[12:15]
    ds_read_b128 v[16:19], v8 offset:15360
    s_waitcnt lgkmcnt(2)
    v_mfma_f32_16x16x32_bf16 v[12:15], a[52:55], v[20:23], v[12:15]
    ds_read_b128 v[20:23], v8 offset:16384
    s_waitcnt vmcnt(0)
    v_cmp_ne_u32 vcc, 1, v11
    s_cmp_eq_u64 vcc, 0
    s_cselect_b32 s24, 1, 0
    s_cmp_ge_u32 s27, s40
    s_cselect_b32 s24, 0, s24
    v_mov_b32 v4, 110592
    s_cmp_lg_u32 s18, 0
    s_cbranch_scc1 L_dec_23
    v_mov_b32 v5, s24
    ds_write_b32 v4, v5
L_dec_23:
    s_waitcnt lgkmcnt(0)
    s_barrier
    ds_read_b32 v5, v4
    s_cmp_eq_u32 s37, 0
    s_cbranch_scc1 L_pend_24
    v_mov_b32 v6, 1
    s_cmp_lg_u32 s18, 0
    s_cbranch_scc1 L_sig_25
    s_mov_b64 exec, 1
    buffer_store_dword v6, off, s[4:7], s22 sc1
    s_mov_b64 exec, -1
L_sig_25:
    s_add_u32 s22, s22, 0
L_pend_24:
    s_waitcnt lgkmcnt(0)
    v_readfirstlane_b32 s24, v5
    s_cmp_eq_u32 s24, 0
    s_cbranch_scc1 L_nos_26
    s_lshl_b32 s38, s18, 10
    s_add_u32 s38, s38, s25
    s_mul_i32 s39, s18, 2048
    s_add_u32 s39, s39, s20
    s_add_u32 s20, s20, 110592
    s_add_u32 s21, s21, 128
L_nos_26:
    buffer_load_dwordx2 v[44:45], v3, s[4:7], s26 offen sc1
    s_add_u32 s26, s26, 40960
    v_mfma_f32_16x16x32_bf16 v[12:15], a[56:59], v[24:27], v[12:15]
    ds_read_b128 v[24:27], v8 offset:17408
    s_cmp_eq_u32 s24, 0
    s_cbranch_scc1 L_nod_27
    s_add_u32 m0, s38, 0
    s_nop 0
    buffer_load_dwordx4 v3, s[4:7], s39 offen sc1 lds
    s_add_u32 s39, s39, 8192
L_nod_27:
    v_mfma_f32_16x16x32_bf16 v[12:15], a[60:63], v[16:19], v[12:15]
    ds_read_b128 v[16:19], v8 offset:18432
    s_cmp_eq_u32 s24, 0
    s_cbranch_scc1 L_nod_28
    s_add_u32 m0, s38, 4096
    s_nop 0
    buffer_load_dwordx4 v3, s[4:7], s39 offen sc1 lds
    s_add_u32 s39, s39, 8192
L_nod_28:
    v_mfma_f32_16x16x32_bf16 v[12:15], a[64:67], v[20:23], v[12:15]
    ds_read_b128 v[20:23], v8 offset:19456
    s_cmp_eq_u32 s24, 0
    s_cbranch_scc1 L_nod_29
    s_add_u32 m0, s38, 8192
    s_nop 0
    buffer_load_dwordx4 v3, s[4:7], s39 offen sc1 lds
    s_add_u32 s39, s39, 8192
L_nod_29:
    s_waitcnt lgkmcnt(2)
    v_mfma_f32_16x16x32_bf16 v[12:15], a[68:71], v[24:27], v[12:15]
    ds_read_b128 v[24:27], v8 offset:20480
    s_cmp_eq_u32 s24, 0
    s_cbranch_scc1 L_nod_30
    s_add_u32 m0, s38, 12288
    s_nop 0
    buffer_load_dwordx4 v3, s[4:7], s39 offen sc1 lds
    s_add_u32 s39, s39, 8192
L_nod_30:
    s_waitcnt lgkmcnt(2)
    v_mfma_f32_16x16x32_bf16 v[12:15], a[72:75], v[16:19], v[12:15]
    ds_read_b128 v[16:19], v8 offset:21504
    s_cmp_eq_u32 s24, 0
    s_cbranch_scc1 L_nod_31
    s_add_u32 m0, s38, 16384
    s_nop 0
    buffer_load_dwordx4 v3, s[4:7], s39 offen sc1 lds
    s_add_u32 s39, s39, 8192
L_nod_31:
    s_waitcnt lgkmcnt(2)
    v_mfma_f32_16x16x32_bf16 v[12:15], a[76:79], v[20:23], v[12:15]
    ds_read_b128 v[20:23], v8 offset:22528
    s_cmp_eq_u32 s24, 0
    s_cbranch_scc1 L_nod_32
    s_add_u32 m0, s38, 20480
    s_nop 0
    buffer_load_dwordx4 v3, s[4:7], s39 offen sc1 lds
    s_add_u32 s39, s39, 8192
L_nod_32:
    s_waitcnt lgkmcnt(2)
    v_mfma_f32_16x16x32_bf16 v[12:15], a[80:83], v[24:27], v[12:15]
    ds_read_b128 v[24:27], v8 offset:23552
    s_cmp_eq_u32 s24, 0
    s_cbranch_scc1 L_nod_33
    s_add_u32 m0, s38, 24576
    s_nop 0
    buffer_load_dwordx4 v3, s[4:7], s39 offen sc1 lds
    s_add_u32 s39, s39, 8192
L_nod_33:
    s_waitcnt lgkmcnt(2)
    v_mfma_f32_16x16x32_bf16 v[12:15], a[84:87], v[16:19], v[12:15]
    ds_read_b128 v[16:19], v8 offset:24576
    s_cmp_eq_u32 s24, 0
    s_cbranch_scc1 L_nod_34
    s_add_u32 m0, s38, 28672
    s_nop 0
    buffer_load_dwordx4 v3, s[4:7], s39 offen sc1 lds
    s_add_u32 s39, s39, 8192
L_nod_34:
    s_waitcnt lgkmcnt(2)
    v_mfma_f32_16x16x32_bf16 v[12:15], a[88:91], v[20:23], v[12:15]
    ds_read_b128 v[20:23], v8 offset:25600
    s_cmp_eq_u32 s24, 0
    s_cbranch_scc1 L_nod_35
    s_add_u32 m0, s38, 32768
    s_nop 0
    buffer_load_dwordx4 v3, s[4:7], s39 offen sc1 lds
    s_add_u32 s39, s39, 8192
L_nod_35:
    s_waitcnt lgkmcnt(2)
    v_mfma_f32_16x16x32_bf16 v[12:15], a[92:95], v[24:27], v[12:15]
    ds_read_b128 v[24:27], v8 offset:26624
    s_cmp_eq_u32 s24, 0
    s_cbranch_scc1 L_nod_36
    s_add_u32 m0, s38, 36864
    s_nop 0
    buffer_load_dwordx4 v3, s[4:7], s39 offen sc1 lds
    s_add_u32 s39, s39, 8192
L_nod_36:
    s_waitcnt lgkmcnt(2)
    v_mfma_f32_16x16x32_bf16 v[12:15], a[96:99], v[16:19], v[12:15]
    ds_read_b128 v[16:19], v8 offset:27648
    s_cmp_eq_u32 s24, 0
    s_cbranch_scc1 L_nod_37
    s_add_u32 m0, s38, 40960
    s_nop 0
    buffer_load_dwordx4 v3, s[4:7], s39 offen sc1 lds
    s_add_u32 s39, s39, 8192
L_nod_37:
    s_waitcnt lgkmcnt(2)
    v_mfma_f32_16x16x32_bf16 v[12:15], a[100:103], v[20:23], v[12:15]
    ds_read_b128 v[20:23], v8 offset:28672
    s_cmp_eq_u32 s24, 0
    s_cbranch_scc1 L_nod_38
    s_add_u32 m0, s38, 45056
    s_nop 0
    buffer_load_dwordx4 v3, s[4:7], s39 offen sc1 lds
    s_add_u32 s39, s39, 8192
L_nod_38:
    s_waitcnt lgkmcnt(2)
    v_mfma_f32_16x16x32_bf16 v[12:15], a[104:107], v[24:27], v[12:15]
    ds_read_b128 v[24:27], v8 offset:29696
    s_cmp_eq_u32 s24, 0
    s_cbranch_scc1 L_nod_39
    s_add_u32 m0, s38, 49152
    s_nop 0
    buffer_load_dwordx4 v3, s[4:7], s39 offen sc1 lds
    s_add_u32 s39, s39, 8192
L_nod_39:
    s_waitcnt lgkmcnt(2)
    v_mfma_f32_16x16x32_bf16 v[12:15], a[108:111], v[16:19], v[12:15]
    ds_read_b128 v[16:19], v8 offset:30720
    s_cmp_eq_u32 s24, 0
    s_cbranch_scc1 L_nod_40
    s_cmp_ge_u32 s18, 2
    s_cbranch_scc1 L_dm_41
    s_add_u32 m0, s38, 53248
    s_nop 0
    buffer_load_dwordx4 v3, s[4:7], s39 offen sc1 lds
L_dm_41:
    s_add_u32 s39, s39, 8192
L_nod_40:
    s_waitcnt lgkmcnt(2)
    v_mfma_f32_16x16x32_bf16 v[12:15], a[112:115], v[20:23], v[12:15]
    ds_read_b128 v[20:23], v8 offset:31744
    s_waitcnt lgkmcnt(2)
    v_mfma_f32_16x16x32_bf16 v[12:15], a[116:119], v[24:27], v[12:15]
    ds_read_b128 v[24:27], v8 offset:32768
    s_waitcnt lgkmcnt(2)
    v_mfma_f32_16x16x32_bf16 v[12:15], a[120:123], v[16:19], v[12:15]
    ds_read_b128 v[16:19], v8 offset:33792
    s_waitcnt lgkmcnt(2)
    v_mfma_f32_16x16x32_bf16 v[12:15], a[124:127], v[20:23], v[12:15]
    ds_read_b128 v[20:23], v8 offset:34816
    s_waitcnt lgkmcnt(2)
    v_mfma_f32_16x16x32_bf16 v[12:15], a[128:131], v[24:27], v[12:15]
    ds_read_b128 v[24:27], v8 offset:35840
    s_waitcnt lgkmcnt(2)
    v_mfma_f32_16x16x32_bf16 v[12:15], a[132:135], v[16:19], v[12:15]
    ds_read_b128 v[16:19], v8 offset:36864
    s_waitcnt lgkmcnt(2)
    v_mfma_f32_16x16x32_bf16 v[12:15], a[136:139], v[20:23], v[12:15]
    ds_read_b128 v[20:23], v8 offset:37888
    s_waitcnt lgkmcnt(2)
    v_mfma_f32_16x16x32_bf16 v[12:15], a[140:143], v[24:27], v[12:15]
    ds_read_b128 v[24:27], v8 offset:38912
    s_waitcnt lgkmcnt(2)
    v_mfma_f32_16x16x32_bf16 v[12:15], a[144:147], v[16:19], v[12:15]
    ds_read_b128 v[16:19], v8 offset:39936
    s_waitcnt lgkmcnt(2)
    v_mfma_f32_16x16x32_bf16 v[12:15], a[148:151], v[20:23], v[12:15]
    ds_read_b128 v[20:23], v8 offset:40960
    s_waitcnt lgkmcnt(2)
    v_mfma_f32_16x16x32_bf16 v[12:15], a[152:155], v[24:27], v[12:15]
    ds_read_b128 v[24:27], v8 offset:41984
    s_waitcnt lgkmcnt(2)
    v_mfma_f32_16x16x32_bf16 v[12:15], a[156:159], v[16:19], v[12:15]
    ds_read_b128 v[16:19], v8 offset:43008
    s_waitcnt lgkmcnt(2)
    v_mfma_f32_16x16x32_bf16 v[12:15], a[160:163], v[20:23], v[12:15]
    ds_read_b128 v[20:23], v8 offset:44032
    s_waitcnt lgkmcnt(2)
    v_mfma_f32_16x16x32_bf16 v[12:15], a[164:167], v[24:27], v[12:15]
    ds_read_b128 v[24:27], v8 offset:45056
    s_waitcnt lgkmcnt(2)
    v_mfma_f32_16x16x32_bf16 v[12:15], a[168:171], v[16:19], v[12:15]
    ds_read_b128 v[16:19], v8 offset:46080
    s_waitcnt lgkmcnt(2)
    v_mfma_f32_16x16x32_bf16 v[12:15], a[172:175], v[20:23], v[12:15]
    ds_read_b128 v[20:23], v8 offset:47104
    s_waitcnt lgkmcnt(2)
    v_mfma_f32_16x16x32_bf16 v[12:15], a[176:179], v[24:27], v[12:15]
    ds_read_b128 v[24:27], v8 offset:48128
    s_waitcnt lgkmcnt(2)
    v_mfma_f32_16x16x32_bf16 v[12:15], a[180:183], v[16:19], v[12:15]
    ds_read_b128 v[16:19], v8 offset:49152
    s_waitcnt lgkmcnt(2)
    v_mfma_f32_16x16x32_bf16 v[12:15], a[184:187], v[20:23], v[12:15]
    ds_read_b128 v[20:23], v8 offset:50176
    s_waitcnt lgkmcnt(2)
    v_mfma_f32_16x16x32_bf16 v[12:15], a[188:191], v[24:27], v[12:15]
    ds_read_b128 v[24:27], v8 offset:51200
    s_waitcnt lgkmcnt(2)
    v_mfma_f32_16x16x32_bf16 v[12:15], a[192:195], v[16:19], v[12:15]
    ds_read_b128 v[16:19], v8 offset:52224
    s_waitcnt lgkmcnt(2)
    v_mfma_f32_16x16x32_bf16 v[12:15], a[196:199], v[20:23], v[12:15]
    ds_read_b128 v[20:23], v8 offset:53248
    s_waitcnt lgkmcnt(2)
    v_mfma_f32_16x16x32_bf16 v[12:15], a[200:203], v[24:27], v[12:15]
    ds_read_b128 v[24:27], v8 offset:54272
    s_waitcnt lgkmcnt(2)
    v_mfma_f32_16x16x32_bf16 v[12:15], a[204:207], v[16:19], v[12:15]
    s_waitcnt lgkmcnt(1)
    v_mfma_f32_16x16x32_bf16 v[12:15], a[208:211], v[20:23], v[12:15]
    s_waitcnt lgkmcnt(0)
    v_mfma_f32_16x16x32_bf16 v[12:15], a[212:215], v[24:27], v[12:15]
    s_waitcnt vmcnt(0)
    s_nop 6
    v_cvt_pk_bf16_f32 v4, v12, v13
    v_lshlrev_b32 v12, 16, v4
    v_and_b32 v13, 0xffff0000, v4
    v_pk_mul_f32 v[12:13], v[12:13], v[40:41]
    v_cvt_pk_bf16_f32 v4, v12, v13
    v_lshlrev_b32 v12, 16, v4
    v_and_b32 v13, 0xffff0000, v4
    v_lshlrev_b32 v4, 16, v44
    v_and_b32 v5, 0xffff0000, v44
    v_pk_add_f32 v[12:13], v[12:13], v[4:5]
    v_cvt_pk_bf16_f32 v4, v14, v15
    v_lshlrev_b32 v14, 16, v4
    v_and_b32 v15, 0xffff0000, v4
    v_pk_mul_f32 v[14:15], v[14:15], v[42:43]
    v_cvt_pk_bf16_f32 v4, v14, v15
    v_lshlrev_b32 v14, 16, v4
    v_and_b32 v15, 0xffff0000, v4
    v_lshlrev_b32 v4, 16, v45
    v_and_b32 v5, 0xffff0000, v45
    v_pk_add_f32 v[14:15], v[14:15], v[4:5]
    v_cvt_pk_bf16_f32 v44, v12, v13
    v_cvt_pk_bf16_f32 v45, v14, v15
    buffer_store_dwordx2 v[44:45], v46, s[8:11], s23 offen
    s_add_u32 s23, s23, 40960
    buffer_load_dword v11, v10, s[4:7], s21 offen sc1
    s_mov_b32 s19, s27
    s_mov_b32 s37, 1
    s_cmp_eq_u32 s24, 1
    s_cbranch_scc1 L_gtop_16
    s_waitcnt vmcnt(0) lgkmcnt(0)
    s_barrier
    s_cmp_lg_u32 s18, 0
    s_cbranch_scc1 L_sig_42
    v_mov_b32 v5, 1
    s_mov_b64 exec, 1
    buffer_store_dword v5, off, s[4:7], s22 sc1
    s_mov_b64 exec, -1
L_sig_42:
    s_add_u32 s22, s22, 0
    s_cmp_lt_u32 s19, s40
    s_cbranch_scc1 L_gload_18
L_gend_17:
    s_branch L_end
L_x6:
    s_sub_u32 s16, s99, 23
    s_cmp_ge_u32 s99, 27
    s_cbranch_scc1 L_att
L_ff1:
    s_mov_b32 s16, s99
    s_mov_b32 s41, 3456
    v_lshrrev_b32 v4, 2, v0
    v_mul_lo_u32 v4, v4, s41
    v_and_b32 v5, 3, v0
    v_lshl_add_u32 v8, v5, 4, v4
    v_lshrrev_b32 v4, 1, v0
    v_mul_lo_u32 v4, v4, s41
    v_and_b32 v5, 1, v0
    v_lshl_add_u32 v9, v5, 4, v4
    v_lshrrev_b32 v4, 2, v0
    v_and_b32 v5, 3, v0
    v_lshlrev_b32 v5, 3, v5
    v_lshl_add_u32 v10, v4, 6, v5
    v_add_u32 v10, s47, v10
    v_lshl_add_u32 v11, v4, 5, v5
    v_add_u32 v11, s47, v11
    s_load_dwordx2 s[44:45], s[0:1], 64
    s_waitcnt lgkmcnt(0)
    s_mov_b32 s8, s44
    s_mov_b32 s9, s45
    s_mov_b32 s10, 0x21c000
    s_mov_b32 s11, 0x20000
    s_lshl_b32 s20, s16, 7
    s_lshr_b32 s41, s18, 1
    s_lshl_b32 s41, s41, 6
    s_add_u32 s20, s20, s41
    s_waitcnt lgkmcnt(0)
    s_add_u32 m0, s47, 0
    s_nop 0
    buffer_load_dwordx4 v8, s[8:11], s20 offen lds
    s_add_u32 s20, s20, 55296
    s_add_u32 m0, s47, 1024
    s_nop 0
    buffer_load_dwordx4 v8, s[8:11], s20 offen lds
    s_add_u32 s20, s20, 55296
    s_add_u32 m0, s47, 2048
    s_nop 0
    buffer_load_dwordx4 v8, s[8:11], s20 offen lds
    s_add_u32 s20, s20, 55296
    s_add_u32 m0, s47, 3072
    s_nop 0
    buffer_load_dwordx4 v8, s[8:11], s20 offen lds
    s_add_u32 s20, s20, 55296
    s_add_u32 m0, s47, 4096
    s_nop 0
    buffer_load_dwordx4 v8, s[8:11], s20 offen lds
    s_add_u32 s20, s20, 55296
    s_add_u32 m0, s47, 5120
    s_nop 0
    buffer_load_dwordx4 v8, s[8:11], s20 offen lds
    s_add_u32 s20, s20, 55296
    s_add_u32 m0, s47, 6144
    s_nop 0
    buffer_load_dwordx4 v8, s[8:11], s20 offen lds
    s_add_u32 s20, s20, 55296
    s_add_u32 m0, s47, 7168
    s_nop 0
    buffer_load_dwordx4 v8, s[8:11], s20 offen lds
    s_add_u32 s20, s20, 55296
    s_add_u32 m0, s47, 8192
    s_nop 0
    buffer_load_dwordx4 v8, s[8:11], s20 offen lds
    s_add_u32 s20, s20, 55296
    s_add_u32 m0, s47, 9216
    s_nop 0
    buffer_load_dwordx4 v8, s[8:11], s20 offen lds
    s_add_u32 s20, s20, 55296
    s_add_u32 m0, s47, 10240
    s_nop 0
    buffer_load_dwordx4 v8, s[8:11], s20 offen lds
    s_add_u32 s20, s20, 55296
    s_add_u32 m0, s47, 11264
    s_nop 0
    buffer_load_dwordx4 v8, s[8:11], s20 offen lds
    s_add_u32 s20, s20, 55296
    s_add_u32 m0, s47, 12288
    s_nop 0
    buffer_load_dwordx4 v8, s[8:11], s20 offen lds
    s_add_u32 s20, s20, 55296
    s_add_u32 m0, s47, 13312
    s_nop 0
    buffer_load_dwordx4 v8, s[8:11], s20 offen lds
    s_add_u32 s20, s20, 55296
    s_add_u32 m0, s47, 14336
    s_nop 0
    buffer_load_dwordx4 v8, s[8:11], s20 offen lds
    s_add_u32 s20, s20, 55296
    s_add_u32 m0, s47, 15360
    s_nop 0
    buffer_load_dwordx4 v8, s[8:11], s20 offen lds
    s_add_u32 s20, s20, 55296
    s_add_u32 m0, s47, 16384
    s_nop 0
    buffer_load_dwordx4 v8, s[8:11], s20 offen lds
    s_add_u32 s20, s20, 55296
    s_add_u32 m0, s47, 17408
    s_nop 0
    buffer_load_dwordx4 v8, s[8:11], s20 offen lds
    s_add_u32 s20, s20, 55296
    s_add_u32 m0, s47, 18432
    s_nop 0
    buffer_load_dwordx4 v8, s[8:11], s20 offen lds
    s_add_u32 s20, s20, 55296
    s_add_u32 m0, s47, 19456
    s_nop 0
    buffer_load_dwordx4 v8, s[8:11], s20 offen lds
    s_add_u32 s20, s20, 55296
    s_add_u32 m0, s47, 20480
    s_nop 0
    buffer_load_dwordx4 v8, s[8:11], s20 offen lds
    s_add_u32 s20, s20, 55296
    s_add_u32 m0, s47, 21504
    s_nop 0
    buffer_load_dwordx4 v8, s[8:11], s20 offen lds
    s_add_u32 s20, s20, 55296
    s_add_u32 m0, s47, 22528
    s_nop 0
    buffer_load_dwordx4 v8, s[8:11], s20 offen lds
    s_add_u32 s20, s20, 55296
    s_add_u32 m0, s47, 23552
    s_nop 0
    buffer_load_dwordx4 v8, s[8:11], s20 offen lds
    s_add_u32 s20, s20, 55296
    s_add_u32 m0, s47, 24576
    s_nop 0
    buffer_load_dwordx4 v8, s[8:11], s20 offen lds
    s_add_u32 s20, s20, 55296
    s_add_u32 m0, s47, 25600
    s_nop 0
    buffer_load_dwordx4 v8, s[8:11], s20 offen lds
    s_add_u32 s20, s20, 55296
    s_add_u32 m0, s47, 26624
    s_nop 0
    buffer_load_dwordx4 v8, s[8:11], s20 offen lds
    s_add_u32 s20, s20, 55296
    s_add_u32 m0, s47, 27648
    s_nop 0
    buffer_load_dwordx4 v8, s[8:11], s20 offen lds
    s_add_u32 s20, s20, 55296
    s_add_u32 m0, s47, 28672
    s_nop 0
    buffer_load_dwordx4 v8, s[8:11], s20 offen lds
    s_add_u32 s20, s20, 55296
    s_add_u32 m0, s47, 29696
    s_nop 0
    buffer_load_dwordx4 v8, s[8:11], s20 offen lds
    s_add_u32 s20, s20, 55296
    s_add_u32 m0, s47, 30720
    s_nop 0
    buffer_load_dwordx4 v8, s[8:11], s20 offen lds
    s_add_u32 s20, s20, 55296
    s_add_u32 m0, s47, 31744
    s_nop 0
    buffer_load_dwordx4 v8, s[8:11], s20 offen lds
    s_add_u32 s20, s20, 55296
    s_add_u32 m0, s47, 32768
    s_nop 0
    buffer_load_dwordx4 v8, s[8:11], s20 offen lds
    s_add_u32 s20, s20, 55296
    s_add_u32 m0, s47, 33792
    s_nop 0
    buffer_load_dwordx4 v8, s[8:11], s20 offen lds
    s_add_u32 s20, s20, 55296
    s_add_u32 m0, s47, 34816
    s_nop 0
    buffer_load_dwordx4 v8, s[8:11], s20 offen lds
    s_add_u32 s20, s20, 55296
    s_add_u32 m0, s47, 35840
    s_nop 0
    buffer_load_dwordx4 v8, s[8:11], s20 offen lds
    s_add_u32 s20, s20, 55296
    s_add_u32 m0, s47, 36864
    s_nop 0
    buffer_load_dwordx4 v8, s[8:11], s20 offen lds
    s_add_u32 s20, s20, 55296
    s_add_u32 m0, s47, 37888
    s_nop 0
    buffer_load_dwordx4 v8, s[8:11], s20 offen lds
    s_add_u32 s20, s20, 55296
    s_add_u32 m0, s47, 38912
    s_nop 0
    buffer_load_dwordx4 v8, s[8:11], s20 offen lds
    s_add_u32 s20, s20, 55296
    s_add_u32 m0, s47, 39936
    s_nop 0
    buffer_load_dwordx4 v8, s[8:11], s20 offen lds
    s_add_u32 s20, s20, 55296
    s_waitcnt vmcnt(38)
    ds_read_b64_tr_b16 a[0:1], v10 offset:0
    ds_read_b64_tr_b16 a[2:3], v10 offset:1024
    ds_read_b64_tr_b16 a[4:5], v10 offset:32
    ds_read_b64_tr_b16 a[6:7], v10 offset:1056
    s_waitcnt vmcnt(36)
    ds_read_b64_tr_b16 a[8:9], v10 offset:2048
    ds_read_b64_tr_b16 a[10:11], v10 offset:3072
    ds_read_b64_tr_b16 a[12:13], v10 offset:2080
    ds_read_b64_tr_b16 a[14:15], v10 offset:3104
    s_waitcnt vmcnt(34)
    ds_read_b64_tr_b16 a[16:17], v10 offset:4096
    ds_read_b64_tr_b16 a[18:19], v10 offset:5120
    ds_read_b64_tr_b16 a[20:21], v10 offset:4128
    ds_read_b64_tr_b16 a[22:23], v10 offset:5152
    s_waitcnt vmcnt(32)
    ds_read_b64_tr_b16 a[24:25], v10 offset:6144
    ds_read_b64_tr_b16 a[26:27], v10 offset:7168
    ds_read_b64_tr_b16 a[28:29], v10 offset:6176
    ds_read_b64_tr_b16 a[30:31], v10 offset:7200
    s_waitcnt vmcnt(30)
    ds_read_b64_tr_b16 a[32:33], v10 offset:8192
    ds_read_b64_tr_b16 a[34:35], v10 offset:9216
    ds_read_b64_tr_b16 a[36:37], v10 offset:8224
    ds_read_b64_tr_b16 a[38:39], v10 offset:9248
    s_waitcnt vmcnt(28)
    ds_read_b64_tr_b16 a[40:41], v10 offset:10240
    ds_read_b64_tr_b16 a[42:43], v10 offset:11264
    ds_read_b64_tr_b16 a[44:45], v10 offset:10272
    ds_read_b64_tr_b16 a[46:47], v10 offset:11296
    s_waitcnt vmcnt(26)
    ds_read_b64_tr_b16 a[48:49], v10 offset:12288
    ds_read_b64_tr_b16 a[50:51], v10 offset:13312
    ds_read_b64_tr_b16 a[52:53], v10 offset:12320
    ds_read_b64_tr_b16 a[54:55], v10 offset:13344
    s_waitcnt vmcnt(24)
    ds_read_b64_tr_b16 a[56:57], v10 offset:14336
    ds_read_b64_tr_b16 a[58:59], v10 offset:15360
    ds_read_b64_tr_b16 a[60:61], v10 offset:14368
    ds_read_b64_tr_b16 a[62:63], v10 offset:15392
    s_waitcnt vmcnt(22)
    ds_read_b64_tr_b16 a[64:65], v10 offset:16384
    ds_read_b64_tr_b16 a[66:67], v10 offset:17408
    ds_read_b64_tr_b16 a[68:69], v10 offset:16416
    ds_read_b64_tr_b16 a[70:71], v10 offset:17440
    s_waitcnt vmcnt(20)
    ds_read_b64_tr_b16 a[72:73], v10 offset:18432
    ds_read_b64_tr_b16 a[74:75], v10 offset:19456
    ds_read_b64_tr_b16 a[76:77], v10 offset:18464
    ds_read_b64_tr_b16 a[78:79], v10 offset:19488
    s_waitcnt vmcnt(18)
    ds_read_b64_tr_b16 a[80:81], v10 offset:20480
    ds_read_b64_tr_b16 a[82:83], v10 offset:21504
    ds_read_b64_tr_b16 a[84:85], v10 offset:20512
    ds_read_b64_tr_b16 a[86:87], v10 offset:21536
    s_waitcnt vmcnt(16)
    ds_read_b64_tr_b16 a[88:89], v10 offset:22528
    ds_read_b64_tr_b16 a[90:91], v10 offset:23552
    ds_read_b64_tr_b16 a[92:93], v10 offset:22560
    ds_read_b64_tr_b16 a[94:95], v10 offset:23584
    s_waitcnt vmcnt(14)
    ds_read_b64_tr_b16 a[96:97], v10 offset:24576
    ds_read_b64_tr_b16 a[98:99], v10 offset:25600
    ds_read_b64_tr_b16 a[100:101], v10 offset:24608
    ds_read_b64_tr_b16 a[102:103], v10 offset:25632
    s_waitcnt vmcnt(12)
    ds_read_b64_tr_b16 a[104:105], v10 offset:26624
    ds_read_b64_tr_b16 a[106:107], v10 offset:27648
    ds_read_b64_tr_b16 a[108:109], v10 offset:26656
    ds_read_b64_tr_b16 a[110:111], v10 offset:27680
    s_waitcnt vmcnt(10)
    ds_read_b64_tr_b16 a[112:113], v10 offset:28672
    ds_read_b64_tr_b16 a[114:115], v10 offset:29696
    ds_read_b64_tr_b16 a[116:117], v10 offset:28704
    ds_read_b64_tr_b16 a[118:119], v10 offset:29728
    s_waitcnt vmcnt(8)
    ds_read_b64_tr_b16 a[120:121], v10 offset:30720
    ds_read_b64_tr_b16 a[122:123], v10 offset:31744
    ds_read_b64_tr_b16 a[124:125], v10 offset:30752
    ds_read_b64_tr_b16 a[126:127], v10 offset:31776
    s_waitcnt vmcnt(6)
    ds_read_b64_tr_b16 a[128:129], v10 offset:32768
    ds_read_b64_tr_b16 a[130:131], v10 offset:33792
    ds_read_b64_tr_b16 a[132:133], v10 offset:32800
    ds_read_b64_tr_b16 a[134:135], v10 offset:33824
    s_waitcnt vmcnt(4)
    ds_read_b64_tr_b16 a[136:137], v10 offset:34816
    ds_read_b64_tr_b16 a[138:139], v10 offset:35840
    ds_read_b64_tr_b16 a[140:141], v10 offset:34848
    ds_read_b64_tr_b16 a[142:143], v10 offset:35872
    s_waitcnt vmcnt(2)
    ds_read_b64_tr_b16 a[144:145], v10 offset:36864
    ds_read_b64_tr_b16 a[146:147], v10 offset:37888
    ds_read_b64_tr_b16 a[148:149], v10 offset:36896
    ds_read_b64_tr_b16 a[150:151], v10 offset:37920
    s_waitcnt vmcnt(0)
    ds_read_b64_tr_b16 a[152:153], v10 offset:38912
    ds_read_b64_tr_b16 a[154:155], v10 offset:39936
    ds_read_b64_tr_b16 a[156:157], v10 offset:38944
    ds_read_b64_tr_b16 a[158:159], v10 offset:39968
    s_waitcnt lgkmcnt(0)
    s_load_dwordx2 s[44:45], s[0:1], 72
    s_waitcnt lgkmcnt(0)
    s_mov_b32 s8, s44
    s_mov_b32 s9, s45
    s_mov_b32 s10, 0x21c000
    s_mov_b32 s11, 0x20000
    s_lshl_b32 s20, s16, 7
    s_lshr_b32 s41, s18, 1
    s_lshl_b32 s41, s41, 6
    s_add_u32 s20, s20, s41
    s_waitcnt lgkmcnt(0)
    s_add_u32 m0, s47, 0
    s_nop 0
    buffer_load_dwordx4 v8, s[8:11], s20 offen lds
    s_add_u32 s20, s20, 55296
    s_add_u32 m0, s47, 1024
    s_nop 0
    buffer_load_dwordx4 v8, s[8:11], s20 offen lds
    s_add_u32 s20, s20, 55296
    s_add_u32 m0, s47, 2048
    s_nop 0
    buffer_load_dwordx4 v8, s[8:11], s20 offen lds
    s_add_u32 s20, s20, 55296
    s_add_u32 m0, s47, 3072
    s_nop 0
    buffer_load_dwordx4 v8, s[8:11], s20 offen lds
    s_add_u32 s20, s20, 55296
    s_add_u32 m0, s47, 4096
    s_nop 0
    buffer_load_dwordx4 v8, s[8:11], s20 offen lds
    s_add_u32 s20, s20, 55296
    s_add_u32 m0, s47, 5120
    s_nop 0
    buffer_load_dwordx4 v8, s[8:11], s20 offen lds
    s_add_u32 s20, s20, 55296
    s_add_u32 m0, s47, 6144
    s_nop 0
    buffer_load_dwordx4 v8, s[8:11], s20 offen lds
    s_add_u32 s20, s20, 55296
    s_add_u32 m0, s47, 7168
    s_nop 0
    buffer_load_dwordx4 v8, s[8:11], s20 offen lds
    s_add_u32 s20, s20, 55296
    s_add_u32 m0, s47, 8192
    s_nop 0
    buffer_load_dwordx4 v8, s[8:11], s20 offen lds
    s_add_u32 s20, s20, 55296
    s_add_u32 m0, s47, 9216
    s_nop 0
    buffer_load_dwordx4 v8, s[8:11], s20 offen lds
    s_add_u32 s20, s20, 55296
    s_add_u32 m0, s47, 10240
    s_nop 0
    buffer_load_dwordx4 v8, s[8:11], s20 offen lds
    s_add_u32 s20, s20, 55296
    s_add_u32 m0, s47, 11264
    s_nop 0
    buffer_load_dwordx4 v8, s[8:11], s20 offen lds
    s_add_u32 s20, s20, 55296
    s_add_u32 m0, s47, 12288
    s_nop 0
    buffer_load_dwordx4 v8, s[8:11], s20 offen lds
    s_add_u32 s20, s20, 55296
    s_add_u32 m0, s47, 13312
    s_nop 0
    buffer_load_dwordx4 v8, s[8:11], s20 offen lds
    s_add_u32 s20, s20, 55296
    s_add_u32 m0, s47, 14336
    s_nop 0
    buffer_load_dwordx4 v8, s[8:11], s20 offen lds
    s_add_u32 s20, s20, 55296
    s_add_u32 m0, s47, 15360
    s_nop 0
    buffer_load_dwordx4 v8, s[8:11], s20 offen lds
    s_add_u32 s20, s20, 55296
    s_add_u32 m0, s47, 16384
    s_nop 0
    buffer_load_dwordx4 v8, s[8:11], s20 offen lds
    s_add_u32 s20, s20, 55296
    s_add_u32 m0, s47, 17408
    s_nop 0
    buffer_load_dwordx4 v8, s[8:11], s20 offen lds
    s_add_u32 s20, s20, 55296
    s_add_u32 m0, s47, 18432
    s_nop 0
    buffer_load_dwordx4 v8, s[8:11], s20 offen lds
    s_add_u32 s20, s20, 55296
    s_add_u32 m0, s47, 19456
    s_nop 0
    buffer_load_dwordx4 v8, s[8:11], s20 offen lds
    s_add_u32 s20, s20, 55296
    s_add_u32 m0, s47, 20480
    s_nop 0
    buffer_load_dwordx4 v8, s[8:11], s20 offen lds
    s_add_u32 s20, s20, 55296
    s_add_u32 m0, s47, 21504
    s_nop 0
    buffer_load_dwordx4 v8, s[8:11], s20 offen lds
    s_add_u32 s20, s20, 55296
    s_add_u32 m0, s47, 22528
    s_nop 0
    buffer_load_dwordx4 v8, s[8:11], s20 offen lds
    s_add_u32 s20, s20, 55296
    s_add_u32 m0, s47, 23552
    s_nop 0
    buffer_load_dwordx4 v8, s[8:11], s20 offen lds
    s_add_u32 s20, s20, 55296
    s_add_u32 m0, s47, 24576
    s_nop 0
    buffer_load_dwordx4 v8, s[8:11], s20 offen lds
    s_add_u32 s20, s20, 55296
    s_add_u32 m0, s47, 25600
    s_nop 0
    buffer_load_dwordx4 v8, s[8:11], s20 offen lds
    s_add_u32 s20, s20, 55296
    s_add_u32 m0, s47, 26624
    s_nop 0
    buffer_load_dwordx4 v8, s[8:11], s20 offen lds
    s_add_u32 s20, s20, 55296
    s_add_u32 m0, s47, 27648
    s_nop 0
    buffer_load_dwordx4 v8, s[8:11], s20 offen lds
    s_add_u32 s20, s20, 55296
    s_add_u32 m0, s47, 28672
    s_nop 0
    buffer_load_dwordx4 v8, s[8:11], s20 offen lds
    s_add_u32 s20, s20, 55296
    s_add_u32 m0, s47, 29696
    s_nop 0
    buffer_load_dwordx4 v8, s[8:11], s20 offen lds
    s_add_u32 s20, s20, 55296
    s_add_u32 m0, s47, 30720
    s_nop 0
    buffer_load_dwordx4 v8, s[8:11], s20 offen lds
    s_add_u32 s20, s20, 55296
    s_add_u32 m0, s47, 31744
    s_nop 0
    buffer_load_dwordx4 v8, s[8:11], s20 offen lds
    s_add_u32 s20, s20, 55296
    s_add_u32 m0, s47, 32768
    s_nop 0
    buffer_load_dwordx4 v8, s[8:11], s20 offen lds
    s_add_u32 s20, s20, 55296
    s_add_u32 m0, s47, 33792
    s_nop 0
    buffer_load_dwordx4 v8, s[8:11], s20 offen lds
    s_add_u32 s20, s20, 55296
    s_add_u32 m0, s47, 34816
    s_nop 0
    buffer_load_dwordx4 v8, s[8:11], s20 offen lds
    s_add_u32 s20, s20, 55296
    s_add_u32 m0, s47, 35840
    s_nop 0
    buffer_load_dwordx4 v8, s[8:11], s20 offen lds
    s_add_u32 s20, s20, 55296
    s_add_u32 m0, s47, 36864
    s_nop 0
    buffer_load_dwordx4 v8, s[8:11], s20 offen lds
    s_add_u32 s20, s20, 55296
    s_add_u32 m0, s47, 37888
    s_nop 0
    buffer_load_dwordx4 v8, s[8:11], s20 offen lds
    s_add_u32 s20, s20, 55296
    s_add_u32 m0, s47, 38912
    s_nop 0
    buffer_load_dwordx4 v8, s[8:11], s20 offen lds
    s_add_u32 s20, s20, 55296
    s_add_u32 m0, s47, 39936
    s_nop 0
    buffer_load_dwordx4 v8, s[8:11], s20 offen lds
    s_add_u32 s20, s20, 55296
    s_waitcnt vmcnt(38)
    ds_read_b64_tr_b16 a[160:161], v10 offset:0
    ds_read_b64_tr_b16 a[162:163], v10 offset:1024
    ds_read_b64_tr_b16 a[164:165], v10 offset:32
    ds_read_b64_tr_b16 a[166:167], v10 offset:1056
    s_waitcnt vmcnt(36)
    ds_read_b64_tr_b16 a[168:169], v10 offset:2048
    ds_read_b64_tr_b16 a[170:171], v10 offset:3072
    ds_read_b64_tr_b16 a[172:173], v10 offset:2080
    ds_read_b64_tr_b16 a[174:175], v10 offset:3104
    s_waitcnt vmcnt(34)
    ds_read_b64_tr_b16 a[176:177], v10 offset:4096
    ds_read_b64_tr_b16 a[178:179], v10 offset:5120
    ds_read_b64_tr_b16 a[180:181], v10 offset:4128
    ds_read_b64_tr_b16 a[182:183], v10 offset:5152
    s_waitcnt vmcnt(32)
    ds_read_b64_tr_b16 a[184:185], v10 offset:6144
    ds_read_b64_tr_b16 a[186:187], v10 offset:7168
    ds_read_b64_tr_b16 a[188:189], v10 offset:6176
    ds_read_b64_tr_b16 a[190:191], v10 offset:7200
    s_waitcnt vmcnt(30)
    ds_read_b64_tr_b16 a[192:193], v10 offset:8192
    ds_read_b64_tr_b16 a[194:195], v10 offset:9216
    ds_read_b64_tr_b16 a[196:197], v10 offset:8224
    ds_read_b64_tr_b16 a[198:199], v10 offset:9248
    s_waitcnt vmcnt(28)
    ds_read_b64_tr_b16 a[200:201], v10 offset:10240
    ds_read_b64_tr_b16 a[202:203], v10 offset:11264
    ds_read_b64_tr_b16 a[204:205], v10 offset:10272
    ds_read_b64_tr_b16 a[206:207], v10 offset:11296
    s_waitcnt vmcnt(26)
    ds_read_b64_tr_b16 a[208:209], v10 offset:12288
    ds_read_b64_tr_b16 a[210:211], v10 offset:13312
    ds_read_b64_tr_b16 a[212:213], v10 offset:12320
    ds_read_b64_tr_b16 a[214:215], v10 offset:13344
    s_waitcnt vmcnt(24)
    ds_read_b64_tr_b16 a[216:217], v10 offset:14336
    ds_read_b64_tr_b16 a[218:219], v10 offset:15360
    ds_read_b64_tr_b16 a[220:221], v10 offset:14368
    ds_read_b64_tr_b16 a[222:223], v10 offset:15392
    s_waitcnt vmcnt(22)
    ds_read_b64_tr_b16 a[224:225], v10 offset:16384
    ds_read_b64_tr_b16 a[226:227], v10 offset:17408
    ds_read_b64_tr_b16 a[228:229], v10 offset:16416
    ds_read_b64_tr_b16 a[230:231], v10 offset:17440
    s_waitcnt vmcnt(20)
    ds_read_b64_tr_b16 a[232:233], v10 offset:18432
    ds_read_b64_tr_b16 a[234:235], v10 offset:19456
    ds_read_b64_tr_b16 a[236:237], v10 offset:18464
    ds_read_b64_tr_b16 a[238:239], v10 offset:19488
    s_waitcnt vmcnt(18)
    ds_read_b64_tr_b16 a[240:241], v10 offset:20480
    ds_read_b64_tr_b16 a[242:243], v10 offset:21504
    ds_read_b64_tr_b16 a[244:245], v10 offset:20512
    ds_read_b64_tr_b16 a[246:247], v10 offset:21536
    s_waitcnt vmcnt(16)
    ds_read_b64_tr_b16 a[248:249], v10 offset:22528
    ds_read_b64_tr_b16 a[250:251], v10 offset:23552
    ds_read_b64_tr_b16 a[252:253], v10 offset:22560
    ds_read_b64_tr_b16 a[254:255], v10 offset:23584
    s_waitcnt vmcnt(14)
    ds_read_b64_tr_b16 v[96:97], v10 offset:24576
    ds_read_b64_tr_b16 v[98:99], v10 offset:25600
    ds_read_b64_tr_b16 v[100:101], v10 offset:24608
    ds_read_b64_tr_b16 v[102:103], v10 offset:25632
    s_waitcnt vmcnt(12)
    ds_read_b64_tr_b16 v[104:105], v10 offset:26624
    ds_read_b64_tr_b16 v[106:107], v10 offset:27648
    ds_read_b64_tr_b16 v[108:109], v10 offset:26656
    ds_read_b64_tr_b16 v[110:111], v10 offset:27680
    s_waitcnt vmcnt(10)
    ds_read_b64_tr_b16 v[112:113], v10 offset:28672
    ds_read_b64_tr_b16 v[114:115], v10 offset:29696
    ds_read_b64_tr_b16 v[116:117], v10 offset:28704
    ds_read_b64_tr_b16 v[118:119], v10 offset:29728
    s_waitcnt vmcnt(8)
    ds_read_b64_tr_b16 v[120:121], v10 offset:30720
    ds_read_b64_tr_b16 v[122:123], v10 offset:31744
    ds_read_b64_tr_b16 v[124:125], v10 offset:30752
    ds_read_b64_tr_b16 v[126:127], v10 offset:31776
    s_waitcnt vmcnt(6)
    ds_read_b64_tr_b16 v[128:129], v10 offset:32768
    ds_read_b64_tr_b16 v[130:131], v10 offset:33792
    ds_read_b64_tr_b16 v[132:133], v10 offset:32800
    ds_read_b64_tr_b16 v[134:135], v10 offset:33824
    s_waitcnt vmcnt(4)
    ds_read_b64_tr_b16 v[136:137], v10 offset:34816
    ds_read_b64_tr_b16 v[138:139], v10 offset:35840
    ds_read_b64_tr_b16 v[140:141], v10 offset:34848
    ds_read_b64_tr_b16 v[142:143], v10 offset:35872
    s_waitcnt vmcnt(2)
    ds_read_b64_tr_b16 v[144:145], v10 offset:36864
    ds_read_b64_tr_b16 v[146:147], v10 offset:37888
    ds_read_b64_tr_b16 v[148:149], v10 offset:36896
    ds_read_b64_tr_b16 v[150:151], v10 offset:37920
    s_waitcnt vmcnt(0)
    ds_read_b64_tr_b16 v[152:153], v10 offset:38912
    ds_read_b64_tr_b16 v[154:155], v10 offset:39936
    ds_read_b64_tr_b16 v[156:157], v10 offset:38944
    ds_read_b64_tr_b16 v[158:159], v10 offset:39968
    s_waitcnt lgkmcnt(0)
    s_mov_b32 s20, 0x5800000
    s_mov_b32 s21, 0x528000
    s_lshl_b32 s22, s16, 2
    s_add_u32 s22, s22, 0x52c000
    s_lshl_b32 s23, s16, 12
    s_lshl_b32 s41, s18, 10
    s_add_u32 s23, s23, s41
    s_add_u32 s23, s23, 0x5b00000
    s_mov_b32 s26, 0xbfb8aa3b
    v_min_u32 v10, 3, v0
    v_lshlrev_b32 v10, 2, v10
    s_mov_b32 s25, 0
    s_mul_i32 s41, s19, 40960
    s_add_u32 s20, s20, s41
    s_mul_i32 s41, s19, 128
    s_add_u32 s21, s21, s41
    s_mul_i32 s41, s19, 128
    s_add_u32 s22, s22, s41
    s_mul_i32 s41, s19, 110592
    s_add_u32 s23, s23, s41
L_gload_45:
    v_min_u32 v4, 3, v0
    v_lshlrev_b32 v4, 2, v4
L_wf_47:
    buffer_load_dword v5, v4, s[4:7], s21 offen sc1
    s_waitcnt vmcnt(0)
    v_cmp_ne_u32 vcc, 1, v5
    s_cbranch_vccz L_wfd_48
    s_sleep 1
    s_add_u32 s46, s46, 1
    s_cmp_lt_u32 s46, 131072
    s_cbranch_scc1 L_wf_47
    s_branch L_end
L_wfd_48:
    s_lshl_b32 s38, s18, 10
    s_add_u32 s38, s38, s25
    s_lshl_b32 s39, s18, 10
    s_add_u32 s39, s39, s20
    s_add_u32 s20, s20, 40960
    s_add_u32 s21, s21, 128
    s_add_u32 m0, s38, 0
    s_nop 0
    buffer_load_dwordx4 v3, s[4:7], s39 offen sc1 lds
    s_add_u32 s39, s39, 4096
    s_add_u32 m0, s38, 4096
    s_nop 0
    buffer_load_dwordx4 v3, s[4:7], s39 offen sc1 lds
    s_add_u32 s39, s39, 4096
    s_add_u32 m0, s38, 8192
    s_nop 0
    buffer_load_dwordx4 v3, s[4:7], s39 offen sc1 lds
    s_add_u32 s39, s39, 4096
    s_add_u32 m0, s38, 12288
    s_nop 0
    buffer_load_dwordx4 v3, s[4:7], s39 offen sc1 lds
    s_add_u32 s39, s39, 4096
    s_add_u32 m0, s38, 16384
    s_nop 0
    buffer_load_dwordx4 v3, s[4:7], s39 offen sc1 lds
    s_add_u32 s39, s39, 4096
    s_add_u32 m0, s38, 20480
    s_nop 0
    buffer_load_dwordx4 v3, s[4:7], s39 offen sc1 lds
    s_add_u32 s39, s39, 4096
    s_add_u32 m0, s38, 24576
    s_nop 0
    buffer_load_dwordx4 v3, s[4:7], s39 offen sc1 lds
    s_add_u32 s39, s39, 4096
    s_add_u32 m0, s38, 28672
    s_nop 0
    buffer_load_dwordx4 v3, s[4:7], s39 offen sc1 lds
    s_add_u32 s39, s39, 4096
    s_add_u32 m0, s38, 32768
    s_nop 0
    buffer_load_dwordx4 v3, s[4:7], s39 offen sc1 lds
    s_add_u32 s39, s39, 4096
    s_add_u32 m0, s38, 36864
    s_nop 0
    buffer_load_dwordx4 v3, s[4:7], s39 offen sc1 lds
    s_add_u32 s39, s39, 4096
    buffer_load_dword v11, v10, s[4:7], s21 offen sc1
    s_mov_b32 s37, 0
    s_waitcnt vmcnt(0) lgkmcnt(0)
    s_branch L_ggo_46
L_gtop_43:
    s_waitcnt vmcnt(2)
L_ggo_46:
    s_barrier
    s_and_b32 s41, s18, 1
    s_lshl_b32 s41, s41, 10
    s_add_u32 s41, s41, s25
    v_add_u32 v8, s41, v3
    s_add_u32 s27, s19, 1
    s_sub_u32 s25, 40960, s25
    ds_read_b128 v[28:31], v8 offset:0
    ds_read_b128 v[32:35], v8 offset:2048
    ds_read_b128 v[36:39], v8 offset:4096
    s_waitcnt lgkmcnt(2)
    v_mfma_f32_16x16x32_bf16 v[12:15], a[0:3], v[28:31], 0
    v_mfma_f32_16x16x32_bf16 v[16:19], a[4:7], v[28:31], 0
    v_mfma_f32_16x16x32_bf16 v[20:23], a[160:163], v[28:31], 0
    v_mfma_f32_16x16x32_bf16 v[24:27], a[164:167], v[28:31], 0
    ds_read_b128 v[28:31], v8 offset:6144
    s_waitcnt lgkmcnt(2)
    v_mfma_f32_16x16x32_bf16 v[12:15], a[8:11], v[32:35], v[12:15]
    v_mfma_f32_16x16x32_bf16 v[16:19], a[12:15], v[32:35], v[16:19]
    v_mfma_f32_16x16x32_bf16 v[20:23], a[168:171], v[32:35], v[20:23]
    v_mfma_f32_16x16x32_bf16 v[24:27], a[172:175], v[32:35], v[24:27]
    ds_read_b128 v[32:35], v8 offset:8192
    s_waitcnt lgkmcnt(2)
    v_mfma_f32_16x16x32_bf16 v[12:15], a[16:19], v[36:39], v[12:15]
    v_mfma_f32_16x16x32_bf16 v[16:19], a[20:23], v[36:39], v[16:19]
    v_mfma_f32_16x16x32_bf16 v[20:23], a[176:179], v[36:39], v[20:23]
    v_mfma_f32_16x16x32_bf16 v[24:27], a[180:183], v[36:39], v[24:27]
    ds_read_b128 v[36:39], v8 offset:10240
    s_waitcnt lgkmcnt(2)
    v_mfma_f32_16x16x32_bf16 v[12:15], a[24:27], v[28:31], v[12:15]
    v_mfma_f32_16x16x32_bf16 v[16:19], a[28:31], v[28:31], v[16:19]
    v_mfma_f32_16x16x32_bf16 v[20:23], a[184:187], v[28:31], v[20:23]
    v_mfma_f32_16x16x32_bf16 v[24:27], a[188:191], v[28:31], v[24:27]
    ds_read_b128 v[28:31], v8 offset:12288
    s_waitcnt lgkmcnt(2)
    v_mfma_f32_16x16x32_bf16 v[12:15], a[32:35], v[32:35], v[12:15]
    v_mfma_f32_16x16x32_bf16 v[16:19], a[36:39], v[32:35], v[16:19]
    v_mfma_f32_16x16x32_bf16 v[20:23], a[192:195], v[32:35], v[20:23]
    v_mfma_f32_16x16x32_bf16 v[24:27], a[196:199], v[32:35], v[24:27]
    ds_read_b128 v[32:35], v8 offset:14336
    s_waitcnt lgkmcnt(2)
    v_mfma_f32_16x16x32_bf16 v[12:15], a[40:43], v[36:39], v[12:15]
    v_mfma_f32_16x16x32_bf16 v[16:19], a[44:47], v[36:39], v[16:19]
    v_mfma_f32_16x16x32_bf16 v[20:23], a[200:203], v[36:39], v[20:23]
    v_mfma_f32_16x16x32_bf16 v[24:27], a[204:207], v[36:39], v[24:27]
    ds_read_b128 v[36:39], v8 offset:16384
    s_waitcnt vmcnt(0)
    v_cmp_ne_u32 vcc, 1, v11
    s_cmp_eq_u64 vcc, 0
    s_cselect_b32 s24, 1, 0
    s_cmp_ge_u32 s27, s40
    s_cselect_b32 s24, 0, s24
    v_mov_b32 v4, 81920
    s_cmp_lg_u32 s18, 0
    s_cbranch_scc1 L_dec_49
    v_mov_b32 v5, s24
    ds_write_b32 v4, v5
L_dec_49:
    s_waitcnt lgkmcnt(0)
    s_barrier
    ds_read_b32 v5, v4
    s_cmp_eq_u32 s37, 0
    s_cbranch_scc1 L_pend_50
    v_mov_b32 v6, 1
    s_cmp_lg_u32 s18, 0
    s_cbranch_scc1 L_sig_51
    s_mov_b64 exec, 1
    buffer_store_dword v6, off, s[4:7], s22 sc1
    s_mov_b64 exec, -1
L_sig_51:
    s_add_u32 s22, s22, 128
L_pend_50:
    s_waitcnt lgkmcnt(0)
    v_readfirstlane_b32 s24, v5
    s_cmp_eq_u32 s24, 0
    s_cbranch_scc1 L_nos_52
    s_lshl_b32 s38, s18, 10
    s_add_u32 s38, s38, s25
    s_lshl_b32 s39, s18, 10
    s_add_u32 s39, s39, s20
    s_add_u32 s20, s20, 40960
    s_add_u32 s21, s21, 128
L_nos_52:
    v_mfma_f32_16x16x32_bf16 v[12:15], a[48:51], v[28:31], v[12:15]
    v_mfma_f32_16x16x32_bf16 v[16:19], a[52:55], v[28:31], v[16:19]
    v_mfma_f32_16x16x32_bf16 v[20:23], a[208:211], v[28:31], v[20:23]
    v_mfma_f32_16x16x32_bf16 v[24:27], a[212:215], v[28:31], v[24:27]
    ds_read_b128 v[28:31], v8 offset:18432
    s_cmp_eq_u32 s24, 0
    s_cbranch_scc1 L_nod_53
    s_add_u32 m0, s38, 0
    s_nop 0
    buffer_load_dwordx4 v3, s[4:7], s39 offen sc1 lds
    s_add_u32 s39, s39, 4096
L_nod_53:
    v_mfma_f32_16x16x32_bf16 v[12:15], a[56:59], v[32:35], v[12:15]
    v_mfma_f32_16x16x32_bf16 v[16:19], a[60:63], v[32:35], v[16:19]
    v_mfma_f32_16x16x32_bf16 v[20:23], a[216:219], v[32:35], v[20:23]
    v_mfma_f32_16x16x32_bf16 v[24:27], a[220:223], v[32:35], v[24:27]
    ds_read_b128 v[32:35], v8 offset:20480
    s_cmp_eq_u32 s24, 0
    s_cbranch_scc1 L_nod_54
    s_add_u32 m0, s38, 4096
    s_nop 0
    buffer_load_dwordx4 v3, s[4:7], s39 offen sc1 lds
    s_add_u32 s39, s39, 4096
L_nod_54:
    v_mfma_f32_16x16x32_bf16 v[12:15], a[64:67], v[36:39], v[12:15]
    v_mfma_f32_16x16x32_bf16 v[16:19], a[68:71], v[36:39], v[16:19]
    v_mfma_f32_16x16x32_bf16 v[20:23], a[224:227], v[36:39], v[20:23]
    v_mfma_f32_16x16x32_bf16 v[24:27], a[228:231], v[36:39], v[24:27]
    ds_read_b128 v[36:39], v8 offset:22528
    s_cmp_eq_u32 s24, 0
    s_cbranch_scc1 L_nod_55
    s_add_u32 m0, s38, 8192
    s_nop 0
    buffer_load_dwordx4 v3, s[4:7], s39 offen sc1 lds
    s_add_u32 s39, s39, 4096
L_nod_55:
    s_waitcnt lgkmcnt(2)
    v_mfma_f32_16x16x32_bf16 v[12:15], a[72:75], v[28:31], v[12:15]
    v_mfma_f32_16x16x32_bf16 v[16:19], a[76:79], v[28:31], v[16:19]
    v_mfma_f32_16x16x32_bf16 v[20:23], a[232:235], v[28:31], v[20:23]
    v_mfma_f32_16x16x32_bf16 v[24:27], a[236:239], v[28:31], v[24:27]
    ds_read_b128 v[28:31], v8 offset:24576
    s_cmp_eq_u32 s24, 0
    s_cbranch_scc1 L_nod_56
    s_add_u32 m0, s38, 12288
    s_nop 0
    buffer_load_dwordx4 v3, s[4:7], s39 offen sc1 lds
    s_add_u32 s39, s39, 4096
L_nod_56:
    s_waitcnt lgkmcnt(2)
    v_mfma_f32_16x16x32_bf16 v[12:15], a[80:83], v[32:35], v[12:15]
    v_mfma_f32_16x16x32_bf16 v[16:19], a[84:87], v[32:35], v[16:19]
    v_mfma_f32_16x16x32_bf16 v[20:23], a[240:243], v[32:35], v[20:23]
    v_mfma_f32_16x16x32_bf16 v[24:27], a[244:247], v[32:35], v[24:27]
    ds_read_b128 v[32:35], v8 offset:26624
    s_cmp_eq_u32 s24, 0
    s_cbranch_scc1 L_nod_57
    s_add_u32 m0, s38, 16384
    s_nop 0
    buffer_load_dwordx4 v3, s[4:7], s39 offen sc1 lds
    s_add_u32 s39, s39, 4096
L_nod_57:
    s_waitcnt lgkmcnt(2)
    v_mfma_f32_16x16x32_bf16 v[12:15], a[88:91], v[36:39], v[12:15]
    v_mfma_f32_16x16x32_bf16 v[16:19], a[92:95], v[36:39], v[16:19]
    v_mfma_f32_16x16x32_bf16 v[20:23], a[248:251], v[36:39], v[20:23]
    v_mfma_f32_16x16x32_bf16 v[24:27], a[252:255], v[36:39], v[24:27]
    ds_read_b128 v[36:39], v8 offset:28672
    s_cmp_eq_u32 s24, 0
    s_cbranch_scc1 L_nod_58
    s_add_u32 m0, s38, 20480
    s_nop 0
    buffer_load_dwordx4 v3, s[4:7], s39 offen sc1 lds
    s_add_u32 s39, s39, 4096
L_nod_58:
    s_waitcnt lgkmcnt(2)
    v_mfma_f32_16x16x32_bf16 v[12:15], a[96:99], v[28:31], v[12:15]
    v_mfma_f32_16x16x32_bf16 v[16:19], a[100:103], v[28:31], v[16:19]
    v_mfma_f32_16x16x32_bf16 v[20:23], v[96:99], v[28:31], v[20:23]
    v_mfma_f32_16x16x32_bf16 v[24:27], v[100:103], v[28:31], v[24:27]
    ds_read_b128 v[28:31], v8 offset:30720
    s_cmp_eq_u32 s24, 0
    s_cbranch_scc1 L_nod_59
    s_add_u32 m0, s38, 24576
    s_nop 0
    buffer_load_dwordx4 v3, s[4:7], s39 offen sc1 lds
    s_add_u32 s39, s39, 4096
L_nod_59:
    s_waitcnt lgkmcnt(2)
    v_mfma_f32_16x16x32_bf16 v[12:15], a[104:107], v[32:35], v[12:15]
    v_mfma_f32_16x16x32_bf16 v[16:19], a[108:111], v[32:35], v[16:19]
    v_mfma_f32_16x16x32_bf16 v[20:23], v[104:107], v[32:35], v[20:23]
    v_mfma_f32_16x16x32_bf16 v[24:27], v[108:111], v[32:35], v[24:27]
    ds_read_b128 v[32:35], v8 offset:32768
    s_cmp_eq_u32 s24, 0
    s_cbranch_scc1 L_nod_60
    s_add_u32 m0, s38, 28672
    s_nop 0
    buffer_load_dwordx4 v3, s[4:7], s39 offen sc1 lds
    s_add_u32 s39, s39, 4096
L_nod_60:
    s_waitcnt lgkmcnt(2)
    v_mfma_f32_16x16x32_bf16 v[12:15], a[112:115], v[36:39], v[12:15]
    v_mfma_f32_16x16x32_bf16 v[16:19], a[116:119], v[36:39], v[16:19]
    v_mfma_f32_16x16x32_bf16 v[20:23], v[112:115], v[36:39], v[20:23]
    v_mfma_f32_16x16x32_bf16 v[24:27], v[116:119], v[36:39], v[24:27]
    ds_read_b128 v[36:39], v8 offset:34816
    s_cmp_eq_u32 s24, 0
    s_cbranch_scc1 L_nod_61
    s_add_u32 m0, s38, 32768
    s_nop 0
    buffer_load_dwordx4 v3, s[4:7], s39 offen sc1 lds
    s_add_u32 s39, s39, 4096
L_nod_61:
    s_waitcnt lgkmcnt(2)
    v_mfma_f32_16x16x32_bf16 v[12:15], a[120:123], v[28:31], v[12:15]
    v_mfma_f32_16x16x32_bf16 v[16:19], a[124:127], v[28:31], v[16:19]
    v_mfma_f32_16x16x32_bf16 v[20:23], v[120:123], v[28:31], v[20:23]
    v_mfma_f32_16x16x32_bf16 v[24:27], v[124:127], v[28:31], v[24:27]
    ds_read_b128 v[28:31], v8 offset:36864
    s_cmp_eq_u32 s24, 0
    s_cbranch_scc1 L_nod_62
    s_add_u32 m0, s38, 36864
    s_nop 0
    buffer_load_dwordx4 v3, s[4:7], s39 offen sc1 lds
    s_add_u32 s39, s39, 4096
L_nod_62:
    s_waitcnt lgkmcnt(2)
    v_mfma_f32_16x16x32_bf16 v[12:15], a[128:131], v[32:35], v[12:15]
    v_mfma_f32_16x16x32_bf16 v[16:19], a[132:135], v[32:35], v[16:19]
    v_mfma_f32_16x16x32_bf16 v[20:23], v[128:131], v[32:35], v[20:23]
    v_mfma_f32_16x16x32_bf16 v[24:27], v[132:135], v[32:35], v[24:27]
    ds_read_b128 v[32:35], v8 offset:38912
    s_waitcnt lgkmcnt(2)
    v_mfma_f32_16x16x32_bf16 v[12:15], a[136:139], v[36:39], v[12:15]
    v_mfma_f32_16x16x32_bf16 v[16:19], a[140:143], v[36:39], v[16:19]
    v_mfma_f32_16x16x32_bf16 v[20:23], v[136:139], v[36:39], v[20:23]
    v_mfma_f32_16x16x32_bf16 v[24:27], v[140:143], v[36:39], v[24:27]
    s_waitcnt lgkmcnt(1)
    v_mfma_f32_16x16x32_bf16 v[12:15], a[144:147], v[28:31], v[12:15]
    v_mfma_f32_16x16x32_bf16 v[16:19], a[148:151], v[28:31], v[16:19]
    v_mfma_f32_16x16x32_bf16 v[20:23], v[144:147], v[28:31], v[20:23]
    v_mfma_f32_16x16x32_bf16 v[24:27], v[148:151], v[28:31], v[24:27]
    s_waitcnt lgkmcnt(0)
    v_mfma_f32_16x16x32_bf16 v[12:15], a[152:155], v[32:35], v[12:15]
    v_mfma_f32_16x16x32_bf16 v[16:19], a[156:159], v[32:35], v[16:19]
    v_mfma_f32_16x16x32_bf16 v[20:23], v[152:155], v[32:35], v[20:23]
    v_mfma_f32_16x16x32_bf16 v[24:27], v[156:159], v[32:35], v[24:27]
    s_nop 4
    v_cvt_pk_bf16_f32 v4, v12, v13
    v_lshlrev_b32 v12, 16, v4
    v_and_b32 v13, 0xffff0000, v4
    v_cvt_pk_bf16_f32 v4, v20, v21
    v_lshlrev_b32 v20, 16, v4
    v_and_b32 v21, 0xffff0000, v4
    v_mul_f32 v5, s26, v12
    v_exp_f32 v5, v5
    s_nop 0
    v_add_f32 v5, 1.0, v5
    v_rcp_f32 v5, v5
    s_nop 0
    v_mul_f32 v12, v12, v5
    v_mul_f32 v5, s26, v13
    v_exp_f32 v5, v5
    s_nop 0
    v_add_f32 v5, 1.0, v5
    v_rcp_f32 v5, v5
    s_nop 0
    v_mul_f32 v13, v13, v5
    v_cvt_pk_bf16_f32 v4, v12, v13
    v_lshlrev_b32 v12, 16, v4
    v_and_b32 v13, 0xffff0000, v4
    v_pk_mul_f32 v[12:13], v[12:13], v[20:21]
    v_cvt_pk_bf16_f32 v4, v14, v15
    v_lshlrev_b32 v14, 16, v4
    v_and_b32 v15, 0xffff0000, v4
    v_cvt_pk_bf16_f32 v4, v22, v23
    v_lshlrev_b32 v22, 16, v4
    v_and_b32 v23, 0xffff0000, v4
    v_mul_f32 v5, s26, v14
    v_exp_f32 v5, v5
    s_nop 0
    v_add_f32 v5, 1.0, v5
    v_rcp_f32 v5, v5
    s_nop 0
    v_mul_f32 v14, v14, v5
    v_mul_f32 v5, s26, v15
    v_exp_f32 v5, v5
    s_nop 0
    v_add_f32 v5, 1.0, v5
    v_rcp_f32 v5, v5
    s_nop 0
    v_mul_f32 v15, v15, v5
    v_cvt_pk_bf16_f32 v4, v14, v15
    v_lshlrev_b32 v14, 16, v4
    v_and_b32 v15, 0xffff0000, v4
    v_pk_mul_f32 v[14:15], v[14:15], v[22:23]
    v_cvt_pk_bf16_f32 v44, v12, v13
    v_cvt_pk_bf16_f32 v45, v14, v15
    v_cvt_pk_bf16_f32 v4, v16, v17
    v_lshlrev_b32 v16, 16, v4
    v_and_b32 v17, 0xffff0000, v4
    v_cvt_pk_bf16_f32 v4, v24, v25
    v_lshlrev_b32 v24, 16, v4
    v_and_b32 v25, 0xffff0000, v4
    v_mul_f32 v5, s26, v16
    v_exp_f32 v5, v5
    s_nop 0
    v_add_f32 v5, 1.0, v5
    v_rcp_f32 v5, v5
    s_nop 0
    v_mul_f32 v16, v16, v5
    v_mul_f32 v5, s26, v17
    v_exp_f32 v5, v5
    s_nop 0
    v_add_f32 v5, 1.0, v5
    v_rcp_f32 v5, v5
    s_nop 0
    v_mul_f32 v17, v17, v5
    v_cvt_pk_bf16_f32 v4, v16, v17
    v_lshlrev_b32 v16, 16, v4
    v_and_b32 v17, 0xffff0000, v4
    v_pk_mul_f32 v[16:17], v[16:17], v[24:25]
    v_cvt_pk_bf16_f32 v4, v18, v19
    v_lshlrev_b32 v18, 16, v4
    v_and_b32 v19, 0xffff0000, v4
    v_cvt_pk_bf16_f32 v4, v26, v27
    v_lshlrev_b32 v26, 16, v4
    v_and_b32 v27, 0xffff0000, v4
    v_mul_f32 v5, s26, v18
    v_exp_f32 v5, v5
    s_nop 0
    v_add_f32 v5, 1.0, v5
    v_rcp_f32 v5, v5
    s_nop 0
    v_mul_f32 v18, v18, v5
    v_mul_f32 v5, s26, v19
    v_exp_f32 v5, v5
    s_nop 0
    v_add_f32 v5, 1.0, v5
    v_rcp_f32 v5, v5
    s_nop 0
    v_mul_f32 v19, v19, v5
    v_cvt_pk_bf16_f32 v4, v18, v19
    v_lshlrev_b32 v18, 16, v4
    v_and_b32 v19, 0xffff0000, v4
    v_pk_mul_f32 v[18:19], v[18:19], v[26:27]
    v_cvt_pk_bf16_f32 v46, v16, v17
    v_cvt_pk_bf16_f32 v47, v18, v19
    buffer_store_dwordx4 v[44:47], v3, s[4:7], s23 offen sc1
    s_add_u32 s23, s23, 110592
    buffer_load_dword v11, v10, s[4:7], s21 offen sc1
    s_mov_b32 s19, s27
    s_mov_b32 s37, 1
    s_cmp_eq_u32 s24, 1
    s_cbranch_scc1 L_gtop_43
    s_waitcnt vmcnt(0) lgkmcnt(0)
    s_barrier
    s_cmp_lg_u32 s18, 0
    s_cbranch_scc1 L_sig_63
    v_mov_b32 v5, 1
    s_mov_b64 exec, 1
    buffer_store_dword v5, off, s[4:7], s22 sc1
    s_mov_b64 exec, -1
L_sig_63:
    s_add_u32 s22, s22, 128
    s_cmp_lt_u32 s19, s40
    s_cbranch_scc1 L_gload_45
L_gend_44:
    s_branch L_end
L_x5:
    s_sub_u32 s16, s99, 28
    s_cmp_ge_u32 s99, 28
    s_cbranch_scc1 L_att
    s_cmp_ge_u32 s99, 20
    s_cbranch_scc1 L_ln2r
    s_mul_i32 s16, s99, 52
    s_lshr_b32 s16, s16, 8
    s_mul_i32 s17, s16, 5
    s_sub_u32 s17, s99, s17
    s_load_dwordx2 s[44:45], s[0:1], 40
    s_waitcnt lgkmcnt(0)
    s_mov_b32 s8, s44
    s_mov_b32 s9, s45
    s_mov_b32 s10, 0x500000
    s_mov_b32 s11, 0x20000
    s_mul_i32 s20, s16, 1310720
    s_lshl_b32 s41, s17, 8
    s_add_u32 s20, s20, s41
    s_mov_b32 s41, 1280
    v_or_b32 v4, 0, v1
    v_lshlrev_b32 v4, 1, v4
    v_xor_b32 v4, v4, v2
    v_mul_lo_u32 v5, v1, s41
    v_lshl_add_u32 v8, v4, 4, v5
    v_or_b32 v4, 4, v1
    v_lshlrev_b32 v4, 1, v4
    v_xor_b32 v4, v4, v2
    v_mul_lo_u32 v5, v1, s41
    v_lshl_add_u32 v9, v4, 4, v5
    v_bfe_u32 v4, v0, 2, 3
    v_lshlrev_b32 v4, 1, v4
    v_bfe_u32 v5, v0, 1, 1
    s_lshl_b32 s41, s18, 2
    v_or_b32 v5, s41, v5
    v_xor_b32 v4, v4, v5
    v_lshlrev_b32 v4, 4, v4
    v_lshrrev_b32 v5, 2, v0
    v_lshl_add_u32 v4, v5, 8, v4
    v_and_b32 v5, 1, v0
    v_lshl_add_u32 v6, v5, 3, v4
    s_mul_i32 s41, s18, 20480
    s_add_u32 s20, s20, s41
    s_lshl_b32 s42, s18, 12
    s_waitcnt lgkmcnt(0)
    s_barrier
    s_add_u32 m0, s42, 0
    s_nop 0
    buffer_load_dwordx4 v8, s[8:11], s20 offen lds
    s_add_u32 s20, s20, 5120
    s_add_u32 m0, s42, 1024
    s_nop 0
    buffer_load_dwordx4 v9, s[8:11], s20 offen lds
    s_add_u32 s20, s20, 5120
    s_add_u32 m0, s42, 2048
    s_nop 0
    buffer_load_dwordx4 v8, s[8:11], s20 offen lds
    s_add_u32 s20, s20, 5120
    s_add_u32 m0, s42, 3072
    s_nop 0
    buffer_load_dwordx4 v9, s[8:11], s20 offen lds
    s_add_u32 s20, s20, 66560
    s_add_u32 m0, s42, 16384
    s_nop 0
    buffer_load_dwordx4 v8, s[8:11], s20 offen lds
    s_add_u32 s20, s20, 5120
    s_add_u32 m0, s42, 17408
    s_nop 0
    buffer_load_dwordx4 v9, s[8:11], s20 offen lds
    s_add_u32 s20, s20, 5120
    s_add_u32 m0, s42, 18432
    s_nop 0
    buffer_load_dwordx4 v8, s[8:11], s20 offen lds
    s_add_u32 s20, s20, 5120
    s_add_u32 m0, s42, 19456
    s_nop 0
    buffer_load_dwordx4 v9, s[8:11], s20 offen lds
    s_add_u32 s20, s20, 66560
    s_add_u32 m0, s42, 32768
    s_nop 0
    buffer_load_dwordx4 v8, s[8:11], s20 offen lds
    s_add_u32 s20, s20, 5120
    s_add_u32 m0, s42, 33792
    s_nop 0
    buffer_load_dwordx4 v9, s[8:11], s20 offen lds
    s_add_u32 s20, s20, 5120
    s_add_u32 m0, s42, 34816
    s_nop 0
    buffer_load_dwordx4 v8, s[8:11], s20 offen lds
    s_add_u32 s20, s20, 5120
    s_add_u32 m0, s42, 35840
    s_nop 0
    buffer_load_dwordx4 v9, s[8:11], s20 offen lds
    s_add_u32 s20, s20, 66560
    s_add_u32 m0, s42, 49152
    s_nop 0
    buffer_load_dwordx4 v8, s[8:11], s20 offen lds
    s_add_u32 s20, s20, 5120
    s_add_u32 m0, s42, 50176
    s_nop 0
    buffer_load_dwordx4 v9, s[8:11], s20 offen lds
    s_add_u32 s20, s20, 5120
    s_add_u32 m0, s42, 51200
    s_nop 0
    buffer_load_dwordx4 v8, s[8:11], s20 offen lds
    s_add_u32 s20, s20, 5120
    s_add_u32 m0, s42, 52224
    s_nop 0
    buffer_load_dwordx4 v9, s[8:11], s20 offen lds
    s_add_u32 s20, s20, 66560
    s_add_u32 m0, s42, 65536
    s_nop 0
    buffer_load_dwordx4 v8, s[8:11], s20 offen lds
    s_add_u32 s20, s20, 5120
    s_add_u32 m0, s42, 66560
    s_nop 0
    buffer_load_dwordx4 v9, s[8:11], s20 offen lds
    s_add_u32 s20, s20, 5120
    s_add_u32 m0, s42, 67584
    s_nop 0
    buffer_load_dwordx4 v8, s[8:11], s20 offen lds
    s_add_u32 s20, s20, 5120
    s_add_u32 m0, s42, 68608
    s_nop 0
    buffer_load_dwordx4 v9, s[8:11], s20 offen lds
    s_add_u32 s20, s20, 66560
    s_add_u32 m0, s42, 81920
    s_nop 0
    buffer_load_dwordx4 v8, s[8:11], s20 offen lds
    s_add_u32 s20, s20, 5120
    s_add_u32 m0, s42, 82944
    s_nop 0
    buffer_load_dwordx4 v9, s[8:11], s20 offen lds
    s_add_u32 s20, s20, 5120
    s_add_u32 m0, s42, 83968
    s_nop 0
    buffer_load_dwordx4 v8, s[8:11], s20 offen lds
    s_add_u32 s20, s20, 5120
    s_add_u32 m0, s42, 84992
    s_nop 0
    buffer_load_dwordx4 v9, s[8:11], s20 offen lds
    s_add_u32 s20, s20, 66560
    s_add_u32 m0, s42, 98304
    s_nop 0
    buffer_load_dwordx4 v8, s[8:11], s20 offen lds
    s_add_u32 s20, s20, 5120
    s_add_u32 m0, s42, 99328
    s_nop 0
    buffer_load_dwordx4 v9, s[8:11], s20 offen lds
    s_add_u32 s20, s20, 5120
    s_add_u32 m0, s42, 100352
    s_nop 0
    buffer_load_dwordx4 v8, s[8:11], s20 offen lds
    s_add_u32 s20, s20, 5120
    s_add_u32 m0, s42, 101376
    s_nop 0
    buffer_load_dwordx4 v9, s[8:11], s20 offen lds
    s_add_u32 s20, s20, 66560
    s_add_u32 m0, s42, 114688
    s_nop 0
    buffer_load_dwordx4 v8, s[8:11], s20 offen lds
    s_add_u32 s20, s20, 5120
    s_add_u32 m0, s42, 115712
    s_nop 0
    buffer_load_dwordx4 v9, s[8:11], s20 offen lds
    s_add_u32 s20, s20, 5120
    s_add_u32 m0, s42, 116736
    s_nop 0
    buffer_load_dwordx4 v8, s[8:11], s20 offen lds
    s_add_u32 s20, s20, 5120
    s_add_u32 m0, s42, 117760
    s_nop 0
    buffer_load_dwordx4 v9, s[8:11], s20 offen lds
    s_add_u32 s20, s20, 66560
    s_add_u32 m0, s42, 131072
    s_nop 0
    buffer_load_dwordx4 v8, s[8:11], s20 offen lds
    s_add_u32 s20, s20, 5120
    s_add_u32 m0, s42, 132096
    s_nop 0
    buffer_load_dwordx4 v9, s[8:11], s20 offen lds
    s_add_u32 s20, s20, 5120
    s_add_u32 m0, s42, 133120
    s_nop 0
    buffer_load_dwordx4 v8, s[8:11], s20 offen lds
    s_add_u32 s20, s20, 5120
    s_add_u32 m0, s42, 134144
    s_nop 0
    buffer_load_dwordx4 v9, s[8:11], s20 offen lds
    s_add_u32 s20, s20, 66560
    s_add_u32 m0, s42, 147456
    s_nop 0
    buffer_load_dwordx4 v8, s[8:11], s20 offen lds
    s_add_u32 s20, s20, 5120
    s_add_u32 m0, s42, 148480
    s_nop 0
    buffer_load_dwordx4 v9, s[8:11], s20 offen lds
    s_add_u32 s20, s20, 5120
    s_add_u32 m0, s42, 149504
    s_nop 0
    buffer_load_dwordx4 v8, s[8:11], s20 offen lds
    s_add_u32 s20, s20, 5120
    s_add_u32 m0, s42, 150528
    s_nop 0
    buffer_load_dwordx4 v9, s[8:11], s20 offen lds
    s_add_u32 s20, s20, 66560
    v_add_u32 v10, 0, v6
    v_xor_b32 v11, 32, v10
    s_waitcnt vmcnt(36)
    s_barrier
    ds_read_b64_tr_b16 a[0:1], v10 offset:0
    ds_read_b64_tr_b16 a[2:3], v10 offset:4096
    ds_read_b64_tr_b16 a[4:5], v11 offset:0
    ds_read_b64_tr_b16 a[6:7], v11 offset:4096
    ds_read_b64_tr_b16 a[8:9], v10 offset:8192
    ds_read_b64_tr_b16 a[10:11], v10 offset:12288
    ds_read_b64_tr_b16 a[12:13], v11 offset:8192
    ds_read_b64_tr_b16 a[14:15], v11 offset:12288
    s_waitcnt vmcnt(32)
    s_barrier
    ds_read_b64_tr_b16 a[16:17], v10 offset:16384
    ds_read_b64_tr_b16 a[18:19], v10 offset:20480
    ds_read_b64_tr_b16 a[20:21], v11 offset:16384
    ds_read_b64_tr_b16 a[22:23], v11 offset:20480
    ds_read_b64_tr_b16 a[24:25], v10 offset:24576
    ds_read_b64_tr_b16 a[26:27], v10 offset:28672
    ds_read_b64_tr_b16 a[28:29], v11 offset:24576
    ds_read_b64_tr_b16 a[30:31], v11 offset:28672
    s_waitcnt vmcnt(28)
    s_barrier
    ds_read_b64_tr_b16 a[32:33], v10 offset:32768
    ds_read_b64_tr_b16 a[34:35], v10 offset:36864
    ds_read_b64_tr_b16 a[36:37], v11 offset:32768
    ds_read_b64_tr_b16 a[38:39], v11 offset:36864
    ds_read_b64_tr_b16 a[40:41], v10 offset:40960
    ds_read_b64_tr_b16 a[42:43], v10 offset:45056
    ds_read_b64_tr_b16 a[44:45], v11 offset:40960
    ds_read_b64_tr_b16 a[46:47], v11 offset:45056
    s_waitcnt vmcnt(24)
    s_barrier
    ds_read_b64_tr_b16 a[48:49], v10 offset:49152
    ds_read_b64_tr_b16 a[50:51], v10 offset:53248
    ds_read_b64_tr_b16 a[52:53], v11 offset:49152
    ds_read_b64_tr_b16 a[54:55], v11 offset:53248
    ds_read_b64_tr_b16 a[56:57], v10 offset:57344
    ds_read_b64_tr_b16 a[58:59], v10 offset:61440
    ds_read_b64_tr_b16 a[60:61], v11 offset:57344
    ds_read_b64_tr_b16 a[62:63], v11 offset:61440
    v_add_u32 v10, 65536, v6
    v_xor_b32 v11, 32, v10
    s_waitcnt vmcnt(20)
    s_barrier
    ds_read_b64_tr_b16 a[64:65], v10 offset:0
    ds_read_b64_tr_b16 a[66:67], v10 offset:4096
    ds_read_b64_tr_b16 a[68:69], v11 offset:0
    ds_read_b64_tr_b16 a[70:71], v11 offset:4096
    ds_read_b64_tr_b16 a[72:73], v10 offset:8192
    ds_read_b64_tr_b16 a[74:75], v10 offset:12288
    ds_read_b64_tr_b16 a[76:77], v11 offset:8192
    ds_read_b64_tr_b16 a[78:79], v11 offset:12288
    s_waitcnt vmcnt(16)
    s_barrier
    ds_read_b64_tr_b16 a[80:81], v10 offset:16384
    ds_read_b64_tr_b16 a[82:83], v10 offset:20480
    ds_read_b64_tr_b16 a[84:85], v11 offset:16384
    ds_read_b64_tr_b16 a[86:87], v11 offset:20480
    ds_read_b64_tr_b16 a[88:89], v10 offset:24576
    ds_read_b64_tr_b16 a[90:91], v10 offset:28672
    ds_read_b64_tr_b16 a[92:93], v11 offset:24576
    ds_read_b64_tr_b16 a[94:95], v11 offset:28672
    s_waitcnt vmcnt(12)
    s_barrier
    ds_read_b64_tr_b16 a[96:97], v10 offset:32768
    ds_read_b64_tr_b16 a[98:99], v10 offset:36864
    ds_read_b64_tr_b16 a[100:101], v11 offset:32768
    ds_read_b64_tr_b16 a[102:103], v11 offset:36864
    ds_read_b64_tr_b16 a[104:105], v10 offset:40960
    ds_read_b64_tr_b16 a[106:107], v10 offset:45056
    ds_read_b64_tr_b16 a[108:109], v11 offset:40960
    ds_read_b64_tr_b16 a[110:111], v11 offset:45056
    s_waitcnt vmcnt(8)
    s_barrier
    ds_read_b64_tr_b16 a[112:113], v10 offset:49152
    ds_read_b64_tr_b16 a[114:115], v10 offset:53248
    ds_read_b64_tr_b16 a[116:117], v11 offset:49152
    ds_read_b64_tr_b16 a[118:119], v11 offset:53248
    ds_read_b64_tr_b16 a[120:121], v10 offset:57344
    ds_read_b64_tr_b16 a[122:123], v10 offset:61440
    ds_read_b64_tr_b16 a[124:125], v11 offset:57344
    ds_read_b64_tr_b16 a[126:127], v11 offset:61440
    v_add_u32 v10, 131072, v6
    v_xor_b32 v11, 32, v10
    s_waitcnt vmcnt(4)
    s_barrier
    ds_read_b64_tr_b16 a[128:129], v10 offset:0
    ds_read_b64_tr_b16 a[130:131], v10 offset:4096
    ds_read_b64_tr_b16 a[132:133], v11 offset:0
    ds_read_b64_tr_b16 a[134:135], v11 offset:4096
    ds_read_b64_tr_b16 a[136:137], v10 offset:8192
    ds_read_b64_tr_b16 a[138:139], v10 offset:12288
    ds_read_b64_tr_b16 a[140:141], v11 offset:8192
    ds_read_b64_tr_b16 a[142:143], v11 offset:12288
    s_waitcnt vmcnt(0)
    s_barrier
    ds_read_b64_tr_b16 a[144:145], v10 offset:16384
    ds_read_b64_tr_b16 a[146:147], v10 offset:20480
    ds_read_b64_tr_b16 a[148:149], v11 offset:16384
    ds_read_b64_tr_b16 a[150:151], v11 offset:20480
    ds_read_b64_tr_b16 a[152:153], v10 offset:24576
    ds_read_b64_tr_b16 a[154:155], v10 offset:28672
    ds_read_b64_tr_b16 a[156:157], v11 offset:24576
    ds_read_b64_tr_b16 a[158:159], v11 offset:28672
    s_waitcnt lgkmcnt(0)
    s_barrier
    s_add_u32 m0, s42, 0
    s_nop 0
    buffer_load_dwordx4 v8, s[8:11], s20 offen lds
    s_add_u32 s20, s20, 5120
    s_add_u32 m0, s42, 1024
    s_nop 0
    buffer_load_dwordx4 v9, s[8:11], s20 offen lds
    s_add_u32 s20, s20, 5120
    s_add_u32 m0, s42, 2048
    s_nop 0
    buffer_load_dwordx4 v8, s[8:11], s20 offen lds
    s_add_u32 s20, s20, 5120
    s_add_u32 m0, s42, 3072
    s_nop 0
    buffer_load_dwordx4 v9, s[8:11], s20 offen lds
    s_add_u32 s20, s20, 66560
    s_add_u32 m0, s42, 16384
    s_nop 0
    buffer_load_dwordx4 v8, s[8:11], s20 offen lds
    s_add_u32 s20, s20, 5120
    s_add_u32 m0, s42, 17408
    s_nop 0
    buffer_load_dwordx4 v9, s[8:11], s20 offen lds
    s_add_u32 s20, s20, 5120
    s_add_u32 m0, s42, 18432
    s_nop 0
    buffer_load_dwordx4 v8, s[8:11], s20 offen lds
    s_add_u32 s20, s20, 5120
    s_add_u32 m0, s42, 19456
    s_nop 0
    buffer_load_dwordx4 v9, s[8:11], s20 offen lds
    s_add_u32 s20, s20, 66560
    s_add_u32 m0, s42, 32768
    s_nop 0
    buffer_load_dwordx4 v8, s[8:11], s20 offen lds
    s_add_u32 s20, s20, 5120
    s_add_u32 m0, s42, 33792
    s_nop 0
    buffer_load_dwordx4 v9, s[8:11], s20 offen lds
    s_add_u32 s20, s20, 5120
    s_add_u32 m0, s42, 34816
    s_nop 0
    buffer_load_dwordx4 v8, s[8:11], s20 offen lds
    s_add_u32 s20, s20, 5120
    s_add_u32 m0, s42, 35840
    s_nop 0
    buffer_load_dwordx4 v9, s[8:11], s20 offen lds
    s_add_u32 s20, s20, 66560
    s_add_u32 m0, s42, 49152
    s_nop 0
    buffer_load_dwordx4 v8, s[8:11], s20 offen lds
    s_add_u32 s20, s20, 5120
    s_add_u32 m0, s42, 50176
    s_nop 0
    buffer_load_dwordx4 v9, s[8:11], s20 offen lds
    s_add_u32 s20, s20, 5120
    s_add_u32 m0, s42, 51200
    s_nop 0
    buffer_load_dwordx4 v8, s[8:11], s20 offen lds
    s_add_u32 s20, s20, 5120
    s_add_u32 m0, s42, 52224
    s_nop 0
    buffer_load_dwordx4 v9, s[8:11], s20 offen lds
    s_add_u32 s20, s20, 66560
    s_add_u32 m0, s42, 65536
    s_nop 0
    buffer_load_dwordx4 v8, s[8:11], s20 offen lds
    s_add_u32 s20, s20, 5120
    s_add_u32 m0, s42, 66560
    s_nop 0
    buffer_load_dwordx4 v9, s[8:11], s20 offen lds
    s_add_u32 s20, s20, 5120
    s_add_u32 m0, s42, 67584
    s_nop 0
    buffer_load_dwordx4 v8, s[8:11], s20 offen lds
    s_add_u32 s20, s20, 5120
    s_add_u32 m0, s42, 68608
    s_nop 0
    buffer_load_dwordx4 v9, s[8:11], s20 offen lds
    s_add_u32 s20, s20, 66560
    s_add_u32 m0, s42, 81920
    s_nop 0
    buffer_load_dwordx4 v8, s[8:11], s20 offen lds
    s_add_u32 s20, s20, 5120
    s_add_u32 m0, s42, 82944
    s_nop 0
    buffer_load_dwordx4 v9, s[8:11], s20 offen lds
    s_add_u32 s20, s20, 5120
    s_add_u32 m0, s42, 83968
    s_nop 0
    buffer_load_dwordx4 v8, s[8:11], s20 offen lds
    s_add_u32 s20, s20, 5120
    s_add_u32 m0, s42, 84992
    s_nop 0
    buffer_load_dwordx4 v9, s[8:11], s20 offen lds
    s_add_u32 s20, s20, 66560
    v_add_u32 v10, 0, v6
    v_xor_b32 v11, 32, v10
    s_waitcnt vmcnt(20)
    s_barrier
    ds_read_b64_tr_b16 a[160:161], v10 offset:0
    ds_read_b64_tr_b16 a[162:163], v10 offset:4096
    ds_read_b64_tr_b16 a[164:165], v11 offset:0
    ds_read_b64_tr_b16 a[166:167], v11 offset:4096
    ds_read_b64_tr_b16 a[168:169], v10 offset:8192
    ds_read_b64_tr_b16 a[170:171], v10 offset:12288
    ds_read_b64_tr_b16 a[172:173], v11 offset:8192
    ds_read_b64_tr_b16 a[174:175], v11 offset:12288
    s_waitcnt vmcnt(16)
    s_barrier
    ds_read_b64_tr_b16 a[176:177], v10 offset:16384
    ds_read_b64_tr_b16 a[178:179], v10 offset:20480
    ds_read_b64_tr_b16 a[180:181], v11 offset:16384
    ds_read_b64_tr_b16 a[182:183], v11 offset:20480
    ds_read_b64_tr_b16 a[184:185], v10 offset:24576
    ds_read_b64_tr_b16 a[186:187], v10 offset:28672
    ds_read_b64_tr_b16 a[188:189], v11 offset:24576
    ds_read_b64_tr_b16 a[190:191], v11 offset:28672
    s_waitcnt vmcnt(12)
    s_barrier
    ds_read_b64_tr_b16 a[192:193], v10 offset:32768
    ds_read_b64_tr_b16 a[194:195], v10 offset:36864
    ds_read_b64_tr_b16 a[196:197], v11 offset:32768
    ds_read_b64_tr_b16 a[198:199], v11 offset:36864
    ds_read_b64_tr_b16 a[200:201], v10 offset:40960
    ds_read_b64_tr_b16 a[202:203], v10 offset:45056
    ds_read_b64_tr_b16 a[204:205], v11 offset:40960
    ds_read_b64_tr_b16 a[206:207], v11 offset:45056
    s_waitcnt vmcnt(8)
    s_barrier
    ds_read_b64_tr_b16 a[208:209], v10 offset:49152
    ds_read_b64_tr_b16 a[210:211], v10 offset:53248
    ds_read_b64_tr_b16 a[212:213], v11 offset:49152
    ds_read_b64_tr_b16 a[214:215], v11 offset:53248
    ds_read_b64_tr_b16 a[216:217], v10 offset:57344
    ds_read_b64_tr_b16 a[218:219], v10 offset:61440
    ds_read_b64_tr_b16 a[220:221], v11 offset:57344
    ds_read_b64_tr_b16 a[222:223], v11 offset:61440
    v_add_u32 v10, 65536, v6
    v_xor_b32 v11, 32, v10
    s_waitcnt vmcnt(4)
    s_barrier
    ds_read_b64_tr_b16 a[224:225], v10 offset:0
    ds_read_b64_tr_b16 a[226:227], v10 offset:4096
    ds_read_b64_tr_b16 a[228:229], v11 offset:0
    ds_read_b64_tr_b16 a[230:231], v11 offset:4096
    ds_read_b64_tr_b16 a[232:233], v10 offset:8192
    ds_read_b64_tr_b16 a[234:235], v10 offset:12288
    ds_read_b64_tr_b16 a[236:237], v11 offset:8192
    ds_read_b64_tr_b16 a[238:239], v11 offset:12288
    s_waitcnt vmcnt(0)
    s_barrier
    ds_read_b64_tr_b16 a[240:241], v10 offset:16384
    ds_read_b64_tr_b16 a[242:243], v10 offset:20480
    ds_read_b64_tr_b16 a[244:245], v11 offset:16384
    ds_read_b64_tr_b16 a[246:247], v11 offset:20480
    ds_read_b64_tr_b16 a[248:249], v10 offset:24576
    ds_read_b64_tr_b16 a[250:251], v10 offset:28672
    ds_read_b64_tr_b16 a[252:253], v11 offset:24576
    ds_read_b64_tr_b16 a[254:255], v11 offset:28672
    s_waitcnt lgkmcnt(0)
    s_barrier
    s_mov_b32 s40, 42
    s_lshl_b32 s20, s16, 16
    s_add_u32 s20, s20, 0x3100000
    s_lshl_b32 s21, s16, 6
    s_add_u32 s21, s21, 0x520000
    s_mul_i32 s22, s16, 5
    s_add_u32 s22, s22, s17
    s_lshl_b32 s22, s22, 2
    s_add_u32 s22, s22, 0x524000
    s_mul_i32 s23, s16, 81920
    s_lshl_b32 s41, s17, 14
    s_add_u32 s23, s23, s41
    s_lshl_b32 s41, s18, 12
    s_add_u32 s23, s23, s41
    s_add_u32 s23, s23, 0x4100000
    v_min_u32 v10, 15, v0
    v_lshlrev_b32 v10, 2, v10
    s_mov_b32 s25, 0
    s_mul_i32 s41, s19, 262144
    s_add_u32 s20, s20, s41
    s_mul_i32 s41, s19, 256
    s_add_u32 s21, s21, s41
    s_mul_i32 s41, s19, 128
    s_add_u32 s22, s22, s41
    s_mul_i32 s41, s19, 327680
    s_add_u32 s23, s23, s41
L_gload_66:
    v_min_u32 v4, 15, v0
    v_lshlrev_b32 v4, 2, v4
L_wf_68:
    buffer_load_dword v5, v4, s[4:7], s21 offen sc1
    s_waitcnt vmcnt(0)
    v_cmp_ne_u32 vcc, 1, v5
    s_cbranch_vccz L_wfd_69
    s_sleep 1
    s_add_u32 s46, s46, 1
    s_cmp_lt_u32 s46, 131072
    s_cbranch_scc1 L_wf_68
    s_branch L_end
L_wfd_69:
    s_lshl_b32 s38, s18, 10
    s_add_u32 s38, s38, s25
    s_lshl_b32 s39, s18, 10
    s_add_u32 s39, s39, s20
    s_add_u32 s20, s20, 262144
    s_add_u32 s21, s21, 256
    s_add_u32 m0, s38, 0
    s_nop 0
    buffer_load_dwordx4 v3, s[4:7], s39 offen sc1 lds
    s_add_u32 s39, s39, 4096
    s_add_u32 m0, s38, 4096
    s_nop 0
    buffer_load_dwordx4 v3, s[4:7], s39 offen sc1 lds
    s_add_u32 s39, s39, 4096
    s_add_u32 m0, s38, 8192
    s_nop 0
    buffer_load_dwordx4 v3, s[4:7], s39 offen sc1 lds
    s_add_u32 s39, s39, 4096
    s_add_u32 m0, s38, 12288
    s_nop 0
    buffer_load_dwordx4 v3, s[4:7], s39 offen sc1 lds
    s_add_u32 s39, s39, 4096
    s_add_u32 m0, s38, 16384
    s_nop 0
    buffer_load_dwordx4 v3, s[4:7], s39 offen sc1 lds
    s_add_u32 s39, s39, 4096
    s_add_u32 m0, s38, 20480
    s_nop 0
    buffer_load_dwordx4 v3, s[4:7], s39 offen sc1 lds
    s_add_u32 s39, s39, 4096
    s_add_u32 m0, s38, 24576
    s_nop 0
    buffer_load_dwordx4 v3, s[4:7], s39 offen sc1 lds
    s_add_u32 s39, s39, 4096
    s_add_u32 m0, s38, 28672
    s_nop 0
    buffer_load_dwordx4 v3, s[4:7], s39 offen sc1 lds
    s_add_u32 s39, s39, 4096
    s_add_u32 m0, s38, 32768
    s_nop 0
    buffer_load_dwordx4 v3, s[4:7], s39 offen sc1 lds
    s_add_u32 s39, s39, 4096
    s_add_u32 m0, s38, 36864
    s_nop 0
    buffer_load_dwordx4 v3, s[4:7], s39 offen sc1 lds
    s_add_u32 s39, s39, 4096
    s_add_u32 m0, s38, 40960
    s_nop 0
    buffer_load_dwordx4 v3, s[4:7], s39 offen sc1 lds
    s_add_u32 s39, s39, 4096
    s_add_u32 m0, s38, 45056
    s_nop 0
    buffer_load_dwordx4 v3, s[4:7], s39 offen sc1 lds
    s_add_u32 s39, s39, 4096
    s_add_u32 m0, s38, 49152
    s_nop 0
    buffer_load_dwordx4 v3, s[4:7], s39 offen sc1 lds
    s_add_u32 s39, s39, 4096
    s_add_u32 m0, s38, 53248
    s_nop 0
    buffer_load_dwordx4 v3, s[4:7], s39 offen sc1 lds
    s_add_u32 s39, s39, 4096
    s_add_u32 m0, s38, 57344
    s_nop 0
    buffer_load_dwordx4 v3, s[4:7], s39 offen sc1 lds
    s_add_u32 s39, s39, 4096
    s_add_u32 m0, s38, 61440
    s_nop 0
    buffer_load_dwordx4 v3, s[4:7], s39 offen sc1 lds
    s_add_u32 s39, s39, 4096
    buffer_load_dword v11, v10, s[4:7], s21 offen sc1
    s_mov_b32 s37, 0
    s_waitcnt vmcnt(0) lgkmcnt(0)
    s_branch L_ggo_67
L_gtop_64:
    s_waitcnt vmcnt(5)
L_ggo_67:
    s_barrier
    v_add_u32 v8, s25, v3
    v_add_u32 v9, 0x10000, v8
    s_add_u32 s27, s19, 1
    s_sub_u32 s25, 65536, s25
    ds_read_b128 v[28:31], v8 offset:0
    ds_read_b128 v[32:35], v8 offset:1024
    ds_read_b128 v[36:39], v8 offset:2048
    ds_read_b128 v[40:43], v8 offset:3072
    ds_read_b128 v[44:47], v8 offset:4096
    ds_read_b128 v[48:51], v8 offset:5120
    s_waitcnt lgkmcnt(4)
    v_mfma_f32_16x16x32_bf16 v[12:15], a[0:3], v[28:31], 0
    v_mfma_f32_16x16x32_bf16 v[16:19], a[0:3], v[32:35], 0
    v_mfma_f32_16x16x32_bf16 v[20:23], a[4:7], v[28:31], 0
    v_mfma_f32_16x16x32_bf16 v[24:27], a[4:7], v[32:35], 0
    ds_read_b128 v[28:31], v8 offset:6144
    ds_read_b128 v[32:35], v8 offset:7168
    s_waitcnt lgkmcnt(4)
    v_mfma_f32_16x16x32_bf16 v[12:15], a[8:11], v[36:39], v[12:15]
    v_mfma_f32_16x16x32_bf16 v[16:19], a[8:11], v[40:43], v[16:19]
    v_mfma_f32_16x16x32_bf16 v[20:23], a[12:15], v[36:39], v[20:23]
    v_mfma_f32_16x16x32_bf16 v[24:27], a[12:15], v[40:43], v[24:27]
    ds_read_b128 v[36:39], v8 offset:8192
    ds_read_b128 v[40:43], v8 offset:9216
    s_waitcnt lgkmcnt(4)
    v_mfma_f32_16x16x32_bf16 v[12:15], a[16:19], v[44:47], v[12:15]
    v_mfma_f32_16x16x32_bf16 v[16:19], a[16:19], v[48:51], v[16:19]
    v_mfma_f32_16x16x32_bf16 v[20:23], a[20:23], v[44:47], v[20:23]
    v_mfma_f32_16x16x32_bf16 v[24:27], a[20:23], v[48:51], v[24:27]
    ds_read_b128 v[44:47], v8 offset:10240
    ds_read_b128 v[48:51], v8 offset:11264
    s_waitcnt lgkmcnt(4)
    v_mfma_f32_16x16x32_bf16 v[12:15], a[24:27], v[28:31], v[12:15]
    v_mfma_f32_16x16x32_bf16 v[16:19], a[24:27], v[32:35], v[16:19]
    v_mfma_f32_16x16x32_bf16 v[20:23], a[28:31], v[28:31], v[20:23]
    v_mfma_f32_16x16x32_bf16 v[24:27], a[28:31], v[32:35], v[24:27]
    ds_read_b128 v[28:31], v8 offset:12288
    ds_read_b128 v[32:35], v8 offset:13312
    s_waitcnt lgkmcnt(4)
    v_mfma_f32_16x16x32_bf16 v[12:15], a[32:35], v[36:39], v[12:15]
    v_mfma_f32_16x16x32_bf16 v[16:19], a[32:35], v[40:43], v[16:19]
    v_mfma_f32_16x16x32_bf16 v[20:23], a[36:39], v[36:39], v[20:23]
    v_mfma_f32_16x16x32_bf16 v[24:27], a[36:39], v[40:43], v[24:27]
    ds_read_b128 v[36:39], v8 offset:14336
    ds_read_b128 v[40:43], v8 offset:15360
    s_waitcnt lgkmcnt(4)
    v_mfma_f32_16x16x32_bf16 v[12:15], a[40:43], v[44:47], v[12:15]
    v_mfma_f32_16x16x32_bf16 v[16:19], a[40:43], v[48:51], v[16:19]
    v_mfma_f32_16x16x32_bf16 v[20:23], a[44:47], v[44:47], v[20:23]
    v_mfma_f32_16x16x32_bf16 v[24:27], a[44:47], v[48:51], v[24:27]
    ds_read_b128 v[44:47], v8 offset:16384
    ds_read_b128 v[48:51], v8 offset:17408
    s_waitcnt lgkmcnt(4)
    v_mfma_f32_16x16x32_bf16 v[12:15], a[48:51], v[28:31], v[12:15]
    v_mfma_f32_16x16x32_bf16 v[16:19], a[48:51], v[32:35], v[16:19]
    v_mfma_f32_16x16x32_bf16 v[20:23], a[52:55], v[28:31], v[20:23]
    v_mfma_f32_16x16x32_bf16 v[24:27], a[52:55], v[32:35], v[24:27]
    ds_read_b128 v[28:31], v8 offset:18432
    ds_read_b128 v[32:35], v8 offset:19456
    s_waitcnt lgkmcnt(4)
    v_mfma_f32_16x16x32_bf16 v[12:15], a[56:59], v[36:39], v[12:15]
    v_mfma_f32_16x16x32_bf16 v[16:19], a[56:59], v[40:43], v[16:19]
    v_mfma_f32_16x16x32_bf16 v[20:23], a[60:63], v[36:39], v[20:23]
    v_mfma_f32_16x16x32_bf16 v[24:27], a[60:63], v[40:43], v[24:27]
    ds_read_b128 v[36:39], v8 offset:20480
    ds_read_b128 v[40:43], v8 offset:21504
    s_waitcnt lgkmcnt(4)
    v_mfma_f32_16x16x32_bf16 v[12:15], a[64:67], v[44:47], v[12:15]
    v_mfma_f32_16x16x32_bf16 v[16:19], a[64:67], v[48:51], v[16:19]
    v_mfma_f32_16x16x32_bf16 v[20:23], a[68:71], v[44:47], v[20:23]
    v_mfma_f32_16x16x32_bf16 v[24:27], a[68:71], v[48:51], v[24:27]
    ds_read_b128 v[44:47], v8 offset:22528
    ds_read_b128 v[48:51], v8 offset:23552
    s_waitcnt vmcnt(0)
    v_cmp_ne_u32 vcc, 1, v11
    s_cmp_eq_u64 vcc, 0
    s_cselect_b32 s24, 1, 0
    s_cmp_ge_u32 s27, s40
    s_cselect_b32 s24, 0, s24
    v_mov_b32 v4, 131072
    s_cmp_lg_u32 s18, 0
    s_cbranch_scc1 L_dec_70
    v_mov_b32 v5, s24
    ds_write_b32 v4, v5
L_dec_70:
    s_waitcnt lgkmcnt(0)
    s_barrier
    ds_read_b32 v5, v4
    s_cmp_eq_u32 s37, 0
    s_cbranch_scc1 L_pend_71
    v_mov_b32 v6, 1
    s_cmp_lg_u32 s18, 0
    s_cbranch_scc1 L_sig_72
    s_mov_b64 exec, 1
    buffer_store_dword v6, off, s[4:7], s22 sc1
    s_mov_b64 exec, -1
L_sig_72:
    s_add_u32 s22, s22, 128
L_pend_71:
    s_waitcnt lgkmcnt(0)
    v_readfirstlane_b32 s24, v5
    s_cmp_eq_u32 s24, 0
    s_cbranch_scc1 L_nos_73
    s_lshl_b32 s38, s18, 10
    s_add_u32 s38, s38, s25
    s_lshl_b32 s39, s18, 10
    s_add_u32 s39, s39, s20
    s_add_u32 s20, s20, 262144
    s_add_u32 s21, s21, 256
L_nos_73:
    v_mfma_f32_16x16x32_bf16 v[12:15], a[72:75], v[28:31], v[12:15]
    v_mfma_f32_16x16x32_bf16 v[16:19], a[72:75], v[32:35], v[16:19]
    v_mfma_f32_16x16x32_bf16 v[20:23], a[76:79], v[28:31], v[20:23]
    v_mfma_f32_16x16x32_bf16 v[24:27], a[76:79], v[32:35], v[24:27]
    ds_read_b128 v[28:31], v8 offset:24576
    ds_read_b128 v[32:35], v8 offset:25600
    s_cmp_eq_u32 s24, 0
    s_cbranch_scc1 L_nod_74
    s_add_u32 m0, s38, 0
    s_nop 0
    buffer_load_dwordx4 v3, s[4:7], s39 offen sc1 lds
    s_add_u32 s39, s39, 4096
L_nod_74:
    v_mfma_f32_16x16x32_bf16 v[12:15], a[80:83], v[36:39], v[12:15]
    v_mfma_f32_16x16x32_bf16 v[16:19], a[80:83], v[40:43], v[16:19]
    v_mfma_f32_16x16x32_bf16 v[20:23], a[84:87], v[36:39], v[20:23]
    v_mfma_f32_16x16x32_bf16 v[24:27], a[84:87], v[40:43], v[24:27]
    ds_read_b128 v[36:39], v8 offset:26624
    ds_read_b128 v[40:43], v8 offset:27648
    s_cmp_eq_u32 s24, 0
    s_cbranch_scc1 L_nod_75
    s_add_u32 m0, s38, 4096
    s_nop 0
    buffer_load_dwordx4 v3, s[4:7], s39 offen sc1 lds
    s_add_u32 s39, s39, 4096
L_nod_75:
    v_mfma_f32_16x16x32_bf16 v[12:15], a[88:91], v[44:47], v[12:15]
    v_mfma_f32_16x16x32_bf16 v[16:19], a[88:91], v[48:51], v[16:19]
    v_mfma_f32_16x16x32_bf16 v[20:23], a[92:95], v[44:47], v[20:23]
    v_mfma_f32_16x16x32_bf16 v[24:27], a[92:95], v[48:51], v[24:27]
    ds_read_b128 v[44:47], v8 offset:28672
    ds_read_b128 v[48:51], v8 offset:29696
    s_cmp_eq_u32 s24, 0
    s_cbranch_scc1 L_nod_76
    s_add_u32 m0, s38, 8192
    s_nop 0
    buffer_load_dwordx4 v3, s[4:7], s39 offen sc1 lds
    s_add_u32 s39, s39, 4096
L_nod_76:
    s_waitcnt lgkmcnt(4)
    v_mfma_f32_16x16x32_bf16 v[12:15], a[96:99], v[28:31], v[12:15]
    v_mfma_f32_16x16x32_bf16 v[16:19], a[96:99], v[32:35], v[16:19]
    v_mfma_f32_16x16x32_bf16 v[20:23], a[100:103], v[28:31], v[20:23]
    v_mfma_f32_16x16x32_bf16 v[24:27], a[100:103], v[32:35], v[24:27]
    ds_read_b128 v[28:31], v8 offset:30720
    ds_read_b128 v[32:35], v8 offset:31744
    s_cmp_eq_u32 s24, 0
    s_cbranch_scc1 L_nod_77
    s_add_u32 m0, s38, 12288
    s_nop 0
    buffer_load_dwordx4 v3, s[4:7], s39 offen sc1 lds
    s_add_u32 s39, s39, 4096
L_nod_77:
    s_waitcnt lgkmcnt(4)
    v_mfma_f32_16x16x32_bf16 v[12:15], a[104:107], v[36:39], v[12:15]
    v_mfma_f32_16x16x32_bf16 v[16:19], a[104:107], v[40:43], v[16:19]
    v_mfma_f32_16x16x32_bf16 v[20:23], a[108:111], v[36:39], v[20:23]
    v_mfma_f32_16x16x32_bf16 v[24:27], a[108:111], v[40:43], v[24:27]
    ds_read_b128 v[36:39], v8 offset:32768
    ds_read_b128 v[40:43], v8 offset:33792
    s_cmp_eq_u32 s24, 0
    s_cbranch_scc1 L_nod_78
    s_add_u32 m0, s38, 16384
    s_nop 0
    buffer_load_dwordx4 v3, s[4:7], s39 offen sc1 lds
    s_add_u32 s39, s39, 4096
L_nod_78:
    s_waitcnt lgkmcnt(4)
    v_mfma_f32_16x16x32_bf16 v[12:15], a[112:115], v[44:47], v[12:15]
    v_mfma_f32_16x16x32_bf16 v[16:19], a[112:115], v[48:51], v[16:19]
    v_mfma_f32_16x16x32_bf16 v[20:23], a[116:119], v[44:47], v[20:23]
    v_mfma_f32_16x16x32_bf16 v[24:27], a[116:119], v[48:51], v[24:27]
    ds_read_b128 v[44:47], v8 offset:34816
    ds_read_b128 v[48:51], v8 offset:35840
    s_cmp_eq_u32 s24, 0
    s_cbranch_scc1 L_nod_79
    s_add_u32 m0, s38, 20480
    s_nop 0
    buffer_load_dwordx4 v3, s[4:7], s39 offen sc1 lds
    s_add_u32 s39, s39, 4096
L_nod_79:
    s_waitcnt lgkmcnt(4)
    v_mfma_f32_16x16x32_bf16 v[12:15], a[120:123], v[28:31], v[12:15]
    v_mfma_f32_16x16x32_bf16 v[16:19], a[120:123], v[32:35], v[16:19]
    v_mfma_f32_16x16x32_bf16 v[20:23], a[124:127], v[28:31], v[20:23]
    v_mfma_f32_16x16x32_bf16 v[24:27], a[124:127], v[32:35], v[24:27]
    ds_read_b128 v[28:31], v8 offset:36864
    ds_read_b128 v[32:35], v8 offset:37888
    s_cmp_eq_u32 s24, 0
    s_cbranch_scc1 L_nod_80
    s_add_u32 m0, s38, 24576
    s_nop 0
    buffer_load_dwordx4 v3, s[4:7], s39 offen sc1 lds
    s_add_u32 s39, s39, 4096
L_nod_80:
    s_waitcnt lgkmcnt(4)
    v_mfma_f32_16x16x32_bf16 v[12:15], a[128:131], v[36:39], v[12:15]
    v_mfma_f32_16x16x32_bf16 v[16:19], a[128:131], v[40:43], v[16:19]
    v_mfma_f32_16x16x32_bf16 v[20:23], a[132:135], v[36:39], v[20:23]
    v_mfma_f32_16x16x32_bf16 v[24:27], a[132:135], v[40:43], v[24:27]
    ds_read_b128 v[36:39], v8 offset:38912
    ds_read_b128 v[40:43], v8 offset:39936
    s_cmp_eq_u32 s24, 0
    s_cbranch_scc1 L_nod_81
    s_add_u32 m0, s38, 28672
    s_nop 0
    buffer_load_dwordx4 v3, s[4:7], s39 offen sc1 lds
    s_add_u32 s39, s39, 4096
L_nod_81:
    s_waitcnt lgkmcnt(4)
    v_mfma_f32_16x16x32_bf16 v[12:15], a[136:139], v[44:47], v[12:15]
    v_mfma_f32_16x16x32_bf16 v[16:19], a[136:139], v[48:51], v[16:19]
    v_mfma_f32_16x16x32_bf16 v[20:23], a[140:143], v[44:47], v[20:23]
    v_mfma_f32_16x16x32_bf16 v[24:27], a[140:143], v[48:51], v[24:27]
    ds_read_b128 v[44:47], v8 offset:40960
    ds_read_b128 v[48:51], v8 offset:41984
    s_cmp_eq_u32 s24, 0
    s_cbranch_scc1 L_nod_82
    s_add_u32 m0, s38, 32768
    s_nop 0
    buffer_load_dwordx4 v3, s[4:7], s39 offen sc1 lds
    s_add_u32 s39, s39, 4096
L_nod_82:
    s_waitcnt lgkmcnt(4)
    v_mfma_f32_16x16x32_bf16 v[12:15], a[144:147], v[28:31], v[12:15]
    v_mfma_f32_16x16x32_bf16 v[16:19], a[144:147], v[32:35], v[16:19]
    v_mfma_f32_16x16x32_bf16 v[20:23], a[148:151], v[28:31], v[20:23]
    v_mfma_f32_16x16x32_bf16 v[24:27], a[148:151], v[32:35], v[24:27]
    ds_read_b128 v[28:31], v8 offset:43008
    ds_read_b128 v[32:35], v8 offset:44032
    s_cmp_eq_u32 s24, 0
    s_cbranch_scc1 L_nod_83
    s_add_u32 m0, s38, 36864
    s_nop 0
    buffer_load_dwordx4 v3, s[4:7], s39 offen sc1 lds
    s_add_u32 s39, s39, 4096
L_nod_83:
    s_waitcnt lgkmcnt(4)
    v_mfma_f32_16x16x32_bf16 v[12:15], a[152:155], v[36:39], v[12:15]
    v_mfma_f32_16x16x32_bf16 v[16:19], a[152:155], v[40:43], v[16:19]
    v_mfma_f32_16x16x32_bf16 v[20:23], a[156:159], v[36:39], v[20:23]
    v_mfma_f32_16x16x32_bf16 v[24:27], a[156:159], v[40:43], v[24:27]
    ds_read_b128 v[36:39], v8 offset:45056
    ds_read_b128 v[40:43], v8 offset:46080
    s_cmp_eq_u32 s24, 0
    s_cbranch_scc1 L_nod_84
    s_add_u32 m0, s38, 40960
    s_nop 0
    buffer_load_dwordx4 v3, s[4:7], s39 offen sc1 lds
    s_add_u32 s39, s39, 4096
L_nod_84:
    s_waitcnt lgkmcnt(4)
    v_mfma_f32_16x16x32_bf16 v[12:15], a[160:163], v[44:47], v[12:15]
    v_mfma_f32_16x16x32_bf16 v[16:19], a[160:163], v[48:51], v[16:19]
    v_mfma_f32_16x16x32_bf16 v[20:23], a[164:167], v[44:47], v[20:23]
    v_mfma_f32_16x16x32_bf16 v[24:27], a[164:167], v[48:51], v[24:27]
    ds_read_b128 v[44:47], v8 offset:47104
    ds_read_b128 v[48:51], v8 offset:48128
    s_cmp_eq_u32 s24, 0
    s_cbranch_scc1 L_nod_85
    s_add_u32 m0, s38, 45056
    s_nop 0
    buffer_load_dwordx4 v3, s[4:7], s39 offen sc1 lds
    s_add_u32 s39, s39, 4096
L_nod_85:
    s_waitcnt lgkmcnt(4)
    v_mfma_f32_16x16x32_bf16 v[12:15], a[168:171], v[28:31], v[12:15]
    v_mfma_f32_16x16x32_bf16 v[16:19], a[168:171], v[32:35], v[16:19]
    v_mfma_f32_16x16x32_bf16 v[20:23], a[172:175], v[28:31], v[20:23]
    v_mfma_f32_16x16x32_bf16 v[24:27], a[172:175], v[32:35], v[24:27]
    ds_read_b128 v[28:31], v8 offset:49152
    ds_read_b128 v[32:35], v8 offset:50176
    s_cmp_eq_u32 s24, 0
    s_cbranch_scc1 L_nod_86
    s_add_u32 m0, s38, 49152
    s_nop 0
    buffer_load_dwordx4 v3, s[4:7], s39 offen sc1 lds
    s_add_u32 s39, s39, 4096
L_nod_86:
    s_waitcnt lgkmcnt(4)
    v_mfma_f32_16x16x32_bf16 v[12:15], a[176:179], v[36:39], v[12:15]
    v_mfma_f32_16x16x32_bf16 v[16:19], a[176:179], v[40:43], v[16:19]
    v_mfma_f32_16x16x32_bf16 v[20:23], a[180:183], v[36:39], v[20:23]
    v_mfma_f32_16x16x32_bf16 v[24:27], a[180:183], v[40:43], v[24:27]
    ds_read_b128 v[36:39], v8 offset:51200
    ds_read_b128 v[40:43], v8 offset:52224
    s_cmp_eq_u32 s24, 0
    s_cbranch_scc1 L_nod_87
    s_add_u32 m0, s38, 53248
    s_nop 0
    buffer_load_dwordx4 v3, s[4:7], s39 offen sc1 lds
    s_add_u32 s39, s39, 4096
L_nod_87:
    s_waitcnt lgkmcnt(4)
    v_mfma_f32_16x16x32_bf16 v[12:15], a[184:187], v[44:47], v[12:15]
    v_mfma_f32_16x16x32_bf16 v[16:19], a[184:187], v[48:51], v[16:19]
    v_mfma_f32_16x16x32_bf16 v[20:23], a[188:191], v[44:47], v[20:23]
    v_mfma_f32_16x16x32_bf16 v[24:27], a[188:191], v[48:51], v[24:27]
    ds_read_b128 v[44:47], v8 offset:53248
    ds_read_b128 v[48:51], v8 offset:54272
    s_cmp_eq_u32 s24, 0
    s_cbranch_scc1 L_nod_88
    s_add_u32 m0, s38, 57344
    s_nop 0
    buffer_load_dwordx4 v3, s[4:7], s39 offen sc1 lds
    s_add_u32 s39, s39, 4096
L_nod_88:
    s_waitcnt lgkmcnt(4)
    v_mfma_f32_16x16x32_bf16 v[12:15], a[192:195], v[28:31], v[12:15]
    v_mfma_f32_16x16x32_bf16 v[16:19], a[192:195], v[32:35], v[16:19]
    v_mfma_f32_16x16x32_bf16 v[20:23], a[196:199], v[28:31], v[20:23]
    v_mfma_f32_16x16x32_bf16 v[24:27], a[196:199], v[32:35], v[24:27]
    ds_read_b128 v[28:31], v8 offset:55296
    ds_read_b128 v[32:35], v8 offset:56320
    s_cmp_eq_u32 s24, 0
    s_cbranch_scc1 L_nod_89
    s_add_u32 m0, s38, 61440
    s_nop 0
    buffer_load_dwordx4 v3, s[4:7], s39 offen sc1 lds
    s_add_u32 s39, s39, 4096
L_nod_89:
    s_waitcnt lgkmcnt(4)
    v_mfma_f32_16x16x32_bf16 v[12:15], a[200:203], v[36:39], v[12:15]
    v_mfma_f32_16x16x32_bf16 v[16:19], a[200:203], v[40:43], v[16:19]
    v_mfma_f32_16x16x32_bf16 v[20:23], a[204:207], v[36:39], v[20:23]
    v_mfma_f32_16x16x32_bf16 v[24:27], a[204:207], v[40:43], v[24:27]
    ds_read_b128 v[36:39], v8 offset:57344
    ds_read_b128 v[40:43], v8 offset:58368
    s_waitcnt lgkmcnt(4)
    v_mfma_f32_16x16x32_bf16 v[12:15], a[208:211], v[44:47], v[12:15]
    v_mfma_f32_16x16x32_bf16 v[16:19], a[208:211], v[48:51], v[16:19]
    v_mfma_f32_16x16x32_bf16 v[20:23], a[212:215], v[44:47], v[20:23]
    v_mfma_f32_16x16x32_bf16 v[24:27], a[212:215], v[48:51], v[24:27]
    ds_read_b128 v[44:47], v8 offset:59392
    ds_read_b128 v[48:51], v8 offset:60416
    s_waitcnt lgkmcnt(4)
    v_mfma_f32_16x16x32_bf16 v[12:15], a[216:219], v[28:31], v[12:15]
    v_mfma_f32_16x16x32_bf16 v[16:19], a[216:219], v[32:35], v[16:19]
    v_mfma_f32_16x16x32_bf16 v[20:23], a[220:223], v[28:31], v[20:23]
    v_mfma_f32_16x16x32_bf16 v[24:27], a[220:223], v[32:35], v[24:27]
    ds_read_b128 v[28:31], v8 offset:61440
    ds_read_b128 v[32:35], v8 offset:62464
    s_waitcnt lgkmcnt(4)
    v_mfma_f32_16x16x32_bf16 v[12:15], a[224:227], v[36:39], v[12:15]
    v_mfma_f32_16x16x32_bf16 v[16:19], a[224:227], v[40:43], v[16:19]
    v_mfma_f32_16x16x32_bf16 v[20:23], a[228:231], v[36:39], v[20:23]
    v_mfma_f32_16x16x32_bf16 v[24:27], a[228:231], v[40:43], v[24:27]
    ds_read_b128 v[36:39], v8 offset:63488
    ds_read_b128 v[40:43], v8 offset:64512
    s_waitcnt lgkmcnt(4)
    v_mfma_f32_16x16x32_bf16 v[12:15], a[232:235], v[44:47], v[12:15]
    v_mfma_f32_16x16x32_bf16 v[16:19], a[232:235], v[48:51], v[16:19]
    v_mfma_f32_16x16x32_bf16 v[20:23], a[236:239], v[44:47], v[20:23]
    v_mfma_f32_16x16x32_bf16 v[24:27], a[236:239], v[48:51], v[24:27]
    s_waitcnt lgkmcnt(2)
    v_mfma_f32_16x16x32_bf16 v[12:15], a[240:243], v[28:31], v[12:15]
    v_mfma_f32_16x16x32_bf16 v[16:19], a[240:243], v[32:35], v[16:19]
    v_mfma_f32_16x16x32_bf16 v[20:23], a[244:247], v[28:31], v[20:23]
    v_mfma_f32_16x16x32_bf16 v[24:27], a[244:247], v[32:35], v[24:27]
    s_waitcnt lgkmcnt(0)
    v_mfma_f32_16x16x32_bf16 v[12:15], a[248:251], v[36:39], v[12:15]
    v_mfma_f32_16x16x32_bf16 v[16:19], a[248:251], v[40:43], v[16:19]
    v_mfma_f32_16x16x32_bf16 v[20:23], a[252:255], v[36:39], v[20:23]
    v_mfma_f32_16x16x32_bf16 v[24:27], a[252:255], v[40:43], v[24:27]
    s_nop 4
    buffer_store_dwordx4 v[12:15], v3, s[4:7], s23 offen offset:0 sc1
    buffer_store_dwordx4 v[16:19], v3, s[4:7], s23 offen offset:1024 sc1
    buffer_store_dwordx4 v[20:23], v3, s[4:7], s23 offen offset:2048 sc1
    buffer_store_dwordx4 v[24:27], v3, s[4:7], s23 offen offset:3072 sc1
    s_add_u32 s23, s23, 327680
    buffer_load_dword v11, v10, s[4:7], s21 offen sc1
    s_mov_b32 s19, s27
    s_mov_b32 s37, 1
    s_cmp_eq_u32 s24, 1
    s_cbranch_scc1 L_gtop_64
    s_waitcnt vmcnt(0) lgkmcnt(0)
    s_barrier
    s_cmp_lg_u32 s18, 0
    s_cbranch_scc1 L_sig_90
    v_mov_b32 v5, 1
    s_mov_b64 exec, 1
    buffer_store_dword v5, off, s[4:7], s22 sc1
    s_mov_b64 exec, -1
L_sig_90:
    s_add_u32 s22, s22, 128
    s_cmp_lt_u32 s19, s40
    s_cbranch_scc1 L_gload_66
L_gend_65:
    s_mov_b32 s29, 0
L_ops:
    s_barrier
    s_mov_b32 s19, 42
    s_mov_b32 s40, 64
    s_lshl_b32 s20, s16, 16
    s_add_u32 s20, s20, 0x3100000
    s_lshl_b32 s21, s16, 6
    s_add_u32 s21, s21, 0x520000
    s_mul_i32 s22, s16, 5
    s_add_u32 s22, s22, s17
    s_lshl_b32 s22, s22, 2
    s_add_u32 s22, s22, 0x524000
    s_mul_i32 s23, s16, 81920
    s_lshl_b32 s41, s17, 14
    s_add_u32 s23, s23, s41
    s_lshl_b32 s41, s18, 12
    s_add_u32 s23, s23, s41
    s_add_u32 s23, s23, 0x4100000
    s_lshl_b32 s41, s29, 10
    s_add_u32 s20, s20, s41
    s_add_u32 s23, s23, s41
    s_lshl_b32 s41, s29, 13
    s_add_u32 s22, s22, s41
    v_min_u32 v10, 15, v0
    v_lshlrev_b32 v10, 2, v10
    s_mov_b32 s25, 0
    s_mul_i32 s41, s19, 262144
    s_add_u32 s20, s20, s41
    s_mul_i32 s41, s19, 256
    s_add_u32 s21, s21, s41
    s_mul_i32 s41, s19, 128
    s_add_u32 s22, s22, s41
    s_mul_i32 s41, s19, 327680
    s_add_u32 s23, s23, s41
L_gload_93:
    v_min_u32 v4, 15, v0
    v_lshlrev_b32 v4, 2, v4
L_wf_95:
    buffer_load_dword v5, v4, s[4:7], s21 offen sc1
    s_waitcnt vmcnt(0)
    v_cmp_ne_u32 vcc, 1, v5
    s_cbranch_vccz L_wfd_96
    s_sleep 1
    s_add_u32 s46, s46, 1
    s_cmp_lt_u32 s46, 131072
    s_cbranch_scc1 L_wf_95
    s_branch L_end
L_wfd_96:
    s_lshl_b32 s38, s18, 10
    s_add_u32 s38, s38, s25
    s_mul_i32 s39, s18, 2048
    s_add_u32 s39, s39, s20
    s_add_u32 s20, s20, 262144
    s_add_u32 s21, s21, 256
    s_add_u32 m0, s38, 0
    s_nop 0
    buffer_load_dwordx4 v3, s[4:7], s39 offen sc1 lds
    s_add_u32 s39, s39, 8192
    s_add_u32 m0, s38, 4096
    s_nop 0
    buffer_load_dwordx4 v3, s[4:7], s39 offen sc1 lds
    s_add_u32 s39, s39, 8192
    s_add_u32 m0, s38, 8192
    s_nop 0
    buffer_load_dwordx4 v3, s[4:7], s39 offen sc1 lds
    s_add_u32 s39, s39, 8192
    s_add_u32 m0, s38, 12288
    s_nop 0
    buffer_load_dwordx4 v3, s[4:7], s39 offen sc1 lds
    s_add_u32 s39, s39, 8192
    s_add_u32 m0, s38, 16384
    s_nop 0
    buffer_load_dwordx4 v3, s[4:7], s39 offen sc1 lds
    s_add_u32 s39, s39, 8192
    s_add_u32 m0, s38, 20480
    s_nop 0
    buffer_load_dwordx4 v3, s[4:7], s39 offen sc1 lds
    s_add_u32 s39, s39, 8192
    s_add_u32 m0, s38, 24576
    s_nop 0
    buffer_load_dwordx4 v3, s[4:7], s39 offen sc1 lds
    s_add_u32 s39, s39, 8192
    s_add_u32 m0, s38, 28672
    s_nop 0
    buffer_load_dwordx4 v3, s[4:7], s39 offen sc1 lds
    s_add_u32 s39, s39, 8192
    buffer_load_dword v11, v10, s[4:7], s21 offen sc1
    s_mov_b32 s37, 0
    s_waitcnt vmcnt(0) lgkmcnt(0)
    s_branch L_ggo_94
L_gtop_91:
    s_waitcnt vmcnt(3)
L_ggo_94:
    s_barrier
    v_add_u32 v8, s25, v3
    s_add_u32 s27, s19, 1
    s_sub_u32 s25, 32768, s25
    ds_read_b128 v[20:23], v8 offset:0
    ds_read_b128 v[24:27], v8 offset:1024
    ds_read_b128 v[28:31], v8 offset:2048
    s_waitcnt lgkmcnt(2)
    v_mfma_f32_16x16x32_bf16 v[12:15], a[0:3], v[20:23], 0
    v_mfma_f32_16x16x32_bf16 v[16:19], a[4:7], v[20:23], 0
    ds_read_b128 v[20:23], v8 offset:3072
    s_waitcnt lgkmcnt(2)
    v_mfma_f32_16x16x32_bf16 v[12:15], a[8:11], v[24:27], v[12:15]
    v_mfma_f32_16x16x32_bf16 v[16:19], a[12:15], v[24:27], v[16:19]
    ds_read_b128 v[24:27], v8 offset:4096
    s_waitcnt lgkmcnt(2)
    v_mfma_f32_16x16x32_bf16 v[12:15], a[16:19], v[28:31], v[12:15]
    v_mfma_f32_16x16x32_bf16 v[16:19], a[20:23], v[28:31], v[16:19]
    ds_read_b128 v[28:31], v8 offset:5120
    s_waitcnt lgkmcnt(2)
    v_mfma_f32_16x16x32_bf16 v[12:15], a[24:27], v[20:23], v[12:15]
    v_mfma_f32_16x16x32_bf16 v[16:19], a[28:31], v[20:23], v[16:19]
    ds_read_b128 v[20:23], v8 offset:6144
    s_waitcnt lgkmcnt(2)
    v_mfma_f32_16x16x32_bf16 v[12:15], a[32:35], v[24:27], v[12:15]
    v_mfma_f32_16x16x32_bf16 v[16:19], a[36:39], v[24:27], v[16:19]
    ds_read_b128 v[24:27], v8 offset:7168
    s_waitcnt lgkmcnt(2)
    v_mfma_f32_16x16x32_bf16 v[12:15], a[40:43], v[28:31], v[12:15]
    v_mfma_f32_16x16x32_bf16 v[16:19], a[44:47], v[28:31], v[16:19]
    ds_read_b128 v[28:31], v8 offset:8192
    s_waitcnt lgkmcnt(2)
    v_mfma_f32_16x16x32_bf16 v[12:15], a[48:51], v[20:23], v[12:15]
    v_mfma_f32_16x16x32_bf16 v[16:19], a[52:55], v[20:23], v[16:19]
    ds_read_b128 v[20:23], v8 offset:9216
    s_waitcnt lgkmcnt(2)
    v_mfma_f32_16x16x32_bf16 v[12:15], a[56:59], v[24:27], v[12:15]
    v_mfma_f32_16x16x32_bf16 v[16:19], a[60:63], v[24:27], v[16:19]
    ds_read_b128 v[24:27], v8 offset:10240
    s_waitcnt lgkmcnt(2)
    v_mfma_f32_16x16x32_bf16 v[12:15], a[64:67], v[28:31], v[12:15]
    v_mfma_f32_16x16x32_bf16 v[16:19], a[68:71], v[28:31], v[16:19]
    ds_read_b128 v[28:31], v8 offset:11264
    s_waitcnt vmcnt(0)
    v_cmp_ne_u32 vcc, 1, v11
    s_cmp_eq_u64 vcc, 0
    s_cselect_b32 s24, 1, 0
    s_cmp_ge_u32 s27, s40
    s_cselect_b32 s24, 0, s24
    v_mov_b32 v4, 65536
    s_cmp_lg_u32 s18, 0
    s_cbranch_scc1 L_dec_97
    v_mov_b32 v5, s24
    ds_write_b32 v4, v5
L_dec_97:
    s_waitcnt lgkmcnt(0)
    s_barrier
    ds_read_b32 v5, v4
    s_cmp_eq_u32 s37, 0
    s_cbranch_scc1 L_pend_98
    v_mov_b32 v6, 1
    s_cmp_lg_u32 s18, 0
    s_cbranch_scc1 L_sig_99
    s_mov_b64 exec, 1
    buffer_store_dword v6, off, s[4:7], s22 sc1
    s_mov_b64 exec, -1
L_sig_99:
    s_add_u32 s22, s22, 128
L_pend_98:
    s_waitcnt lgkmcnt(0)
    v_readfirstlane_b32 s24, v5
    s_cmp_eq_u32 s24, 0
    s_cbranch_scc1 L_nos_100
    s_lshl_b32 s38, s18, 10
    s_add_u32 s38, s38, s25
    s_mul_i32 s39, s18, 2048
    s_add_u32 s39, s39, s20
    s_add_u32 s20, s20, 262144
    s_add_u32 s21, s21, 256
L_nos_100:
    v_mfma_f32_16x16x32_bf16 v[12:15], a[72:75], v[20:23], v[12:15]
    v_mfma_f32_16x16x32_bf16 v[16:19], a[76:79], v[20:23], v[16:19]
    ds_read_b128 v[20:23], v8 offset:12288
    s_cmp_eq_u32 s24, 0
    s_cbranch_scc1 L_nod_101
    s_add_u32 m0, s38, 0
    s_nop 0
    buffer_load_dwordx4 v3, s[4:7], s39 offen sc1 lds
    s_add_u32 s39, s39, 8192
L_nod_101:
    v_mfma_f32_16x16x32_bf16 v[12:15], a[80:83], v[24:27], v[12:15]
    v_mfma_f32_16x16x32_bf16 v[16:19], a[84:87], v[24:27], v[16:19]
    ds_read_b128 v[24:27], v8 offset:13312
    s_cmp_eq_u32 s24, 0
    s_cbranch_scc1 L_nod_102
    s_add_u32 m0, s38, 4096
    s_nop 0
    buffer_load_dwordx4 v3, s[4:7], s39 offen sc1 lds
    s_add_u32 s39, s39, 8192
L_nod_102:
    v_mfma_f32_16x16x32_bf16 v[12:15], a[88:91], v[28:31], v[12:15]
    v_mfma_f32_16x16x32_bf16 v[16:19], a[92:95], v[28:31], v[16:19]
    ds_read_b128 v[28:31], v8 offset:14336
    s_cmp_eq_u32 s24, 0
    s_cbranch_scc1 L_nod_103
    s_add_u32 m0, s38, 8192
    s_nop 0
    buffer_load_dwordx4 v3, s[4:7], s39 offen sc1 lds
    s_add_u32 s39, s39, 8192
L_nod_103:
    s_waitcnt lgkmcnt(2)
    v_mfma_f32_16x16x32_bf16 v[12:15], a[96:99], v[20:23], v[12:15]
    v_mfma_f32_16x16x32_bf16 v[16:19], a[100:103], v[20:23], v[16:19]
    ds_read_b128 v[20:23], v8 offset:15360
    s_cmp_eq_u32 s24, 0
    s_cbranch_scc1 L_nod_104
    s_add_u32 m0, s38, 12288
    s_nop 0
    buffer_load_dwordx4 v3, s[4:7], s39 offen sc1 lds
    s_add_u32 s39, s39, 8192
L_nod_104:
    s_waitcnt lgkmcnt(2)
    v_mfma_f32_16x16x32_bf16 v[12:15], a[104:107], v[24:27], v[12:15]
    v_mfma_f32_16x16x32_bf16 v[16:19], a[108:111], v[24:27], v[16:19]
    ds_read_b128 v[24:27], v8 offset:16384
    s_cmp_eq_u32 s24, 0
    s_cbranch_scc1 L_nod_105
    s_add_u32 m0, s38, 16384
    s_nop 0
    buffer_load_dwordx4 v3, s[4:7], s39 offen sc1 lds
    s_add_u32 s39, s39, 8192
L_nod_105:
    s_waitcnt lgkmcnt(2)
    v_mfma_f32_16x16x32_bf16 v[12:15], a[112:115], v[28:31], v[12:15]
    v_mfma_f32_16x16x32_bf16 v[16:19], a[116:119], v[28:31], v[16:19]
    ds_read_b128 v[28:31], v8 offset:17408
    s_cmp_eq_u32 s24, 0
    s_cbranch_scc1 L_nod_106
    s_add_u32 m0, s38, 20480
    s_nop 0
    buffer_load_dwordx4 v3, s[4:7], s39 offen sc1 lds
    s_add_u32 s39, s39, 8192
L_nod_106:
    s_waitcnt lgkmcnt(2)
    v_mfma_f32_16x16x32_bf16 v[12:15], a[120:123], v[20:23], v[12:15]
    v_mfma_f32_16x16x32_bf16 v[16:19], a[124:127], v[20:23], v[16:19]
    ds_read_b128 v[20:23], v8 offset:18432
    s_cmp_eq_u32 s24, 0
    s_cbranch_scc1 L_nod_107
    s_add_u32 m0, s38, 24576
    s_nop 0
    buffer_load_dwordx4 v3, s[4:7], s39 offen sc1 lds
    s_add_u32 s39, s39, 8192
L_nod_107:
    s_waitcnt lgkmcnt(2)
    v_mfma_f32_16x16x32_bf16 v[12:15], a[128:131], v[24:27], v[12:15]
    v_mfma_f32_16x16x32_bf16 v[16:19], a[132:135], v[24:27], v[16:19]
    ds_read_b128 v[24:27], v8 offset:19456
    s_cmp_eq_u32 s24, 0
    s_cbranch_scc1 L_nod_108
    s_add_u32 m0, s38, 28672
    s_nop 0
    buffer_load_dwordx4 v3, s[4:7], s39 offen sc1 lds
    s_add_u32 s39, s39, 8192
L_nod_108:
    s_waitcnt lgkmcnt(2)
    v_mfma_f32_16x16x32_bf16 v[12:15], a[136:139], v[28:31], v[12:15]
    v_mfma_f32_16x16x32_bf16 v[16:19], a[140:143], v[28:31], v[16:19]
    ds_read_b128 v[28:31], v8 offset:20480
    s_waitcnt lgkmcnt(2)
    v_mfma_f32_16x16x32_bf16 v[12:15], a[144:147], v[20:23], v[12:15]
    v_mfma_f32_16x16x32_bf16 v[16:19], a[148:151], v[20:23], v[16:19]
    ds_read_b128 v[20:23], v8 offset:21504
    s_waitcnt lgkmcnt(2)
    v_mfma_f32_16x16x32_bf16 v[12:15], a[152:155], v[24:27], v[12:15]
    v_mfma_f32_16x16x32_bf16 v[16:19], a[156:159], v[24:27], v[16:19]
    ds_read_b128 v[24:27], v8 offset:22528
    s_waitcnt lgkmcnt(2)
    v_mfma_f32_16x16x32_bf16 v[12:15], a[160:163], v[28:31], v[12:15]
    v_mfma_f32_16x16x32_bf16 v[16:19], a[164:167], v[28:31], v[16:19]
    ds_read_b128 v[28:31], v8 offset:23552
    s_waitcnt lgkmcnt(2)
    v_mfma_f32_16x16x32_bf16 v[12:15], a[168:171], v[20:23], v[12:15]
    v_mfma_f32_16x16x32_bf16 v[16:19], a[172:175], v[20:23], v[16:19]
    ds_read_b128 v[20:23], v8 offset:24576
    s_waitcnt lgkmcnt(2)
    v_mfma_f32_16x16x32_bf16 v[12:15], a[176:179], v[24:27], v[12:15]
    v_mfma_f32_16x16x32_bf16 v[16:19], a[180:183], v[24:27], v[16:19]
    ds_read_b128 v[24:27], v8 offset:25600
    s_waitcnt lgkmcnt(2)
    v_mfma_f32_16x16x32_bf16 v[12:15], a[184:187], v[28:31], v[12:15]
    v_mfma_f32_16x16x32_bf16 v[16:19], a[188:191], v[28:31], v[16:19]
    ds_read_b128 v[28:31], v8 offset:26624
    s_waitcnt lgkmcnt(2)
    v_mfma_f32_16x16x32_bf16 v[12:15], a[192:195], v[20:23], v[12:15]
    v_mfma_f32_16x16x32_bf16 v[16:19], a[196:199], v[20:23], v[16:19]
    ds_read_b128 v[20:23], v8 offset:27648
    s_waitcnt lgkmcnt(2)
    v_mfma_f32_16x16x32_bf16 v[12:15], a[200:203], v[24:27], v[12:15]
    v_mfma_f32_16x16x32_bf16 v[16:19], a[204:207], v[24:27], v[16:19]
    ds_read_b128 v[24:27], v8 offset:28672
    s_waitcnt lgkmcnt(2)
    v_mfma_f32_16x16x32_bf16 v[12:15], a[208:211], v[28:31], v[12:15]
    v_mfma_f32_16x16x32_bf16 v[16:19], a[212:215], v[28:31], v[16:19]
    ds_read_b128 v[28:31], v8 offset:29696
    s_waitcnt lgkmcnt(2)
    v_mfma_f32_16x16x32_bf16 v[12:15], a[216:219], v[20:23], v[12:15]
    v_mfma_f32_16x16x32_bf16 v[16:19], a[220:223], v[20:23], v[16:19]
    ds_read_b128 v[20:23], v8 offset:30720
    s_waitcnt lgkmcnt(2)
    v_mfma_f32_16x16x32_bf16 v[12:15], a[224:227], v[24:27], v[12:15]
    v_mfma_f32_16x16x32_bf16 v[16:19], a[228:231], v[24:27], v[16:19]
    ds_read_b128 v[24:27], v8 offset:31744
    s_waitcnt lgkmcnt(2)
    v_mfma_f32_16x16x32_bf16 v[12:15], a[232:235], v[28:31], v[12:15]
    v_mfma_f32_16x16x32_bf16 v[16:19], a[236:239], v[28:31], v[16:19]
    s_waitcnt lgkmcnt(1)
    v_mfma_f32_16x16x32_bf16 v[12:15], a[240:243], v[20:23], v[12:15]
    v_mfma_f32_16x16x32_bf16 v[16:19], a[244:247], v[20:23], v[16:19]
    s_waitcnt lgkmcnt(0)
    v_mfma_f32_16x16x32_bf16 v[12:15], a[248:251], v[24:27], v[12:15]
    v_mfma_f32_16x16x32_bf16 v[16:19], a[252:255], v[24:27], v[16:19]
    s_nop 6
    buffer_store_dwordx4 v[12:15], v3, s[4:7], s23 offen offset:0 sc1
    buffer_store_dwordx4 v[16:19], v3, s[4:7], s23 offen offset:2048 sc1
    s_add_u32 s23, s23, 327680
    buffer_load_dword v11, v10, s[4:7], s21 offen sc1
    s_mov_b32 s19, s27
    s_mov_b32 s37, 1
    s_cmp_eq_u32 s24, 1
    s_cbranch_scc1 L_gtop_91
    s_waitcnt vmcnt(0) lgkmcnt(0)
    s_barrier
    s_cmp_lg_u32 s18, 0
    s_cbranch_scc1 L_sig_109
    v_mov_b32 v5, 1
    s_mov_b64 exec, 1
    buffer_store_dword v5, off, s[4:7], s22 sc1
    s_mov_b64 exec, -1
L_sig_109:
    s_add_u32 s22, s22, 128
    s_cmp_lt_u32 s19, s40
    s_cbranch_scc1 L_gload_93
L_gend_92:
    s_branch L_end
L_ln2r:
    s_sub_u32 s16, s99, 20
    v_bfe_u32 v8, v0, 3, 1
    v_and_b32 v9, 7, v0
    v_lshl_add_u32 v6, v1, 4, v9
    v_lshlrev_b32 v6, 4, v6
    v_mul_u32_u24 v4, 10240, v8
    v_add_u32 v180, v4, v6
    v_mul_u32_u24 v4, 1280, v9
    v_mul_u32_u24 v5, 160, v8
    v_add_u32 v4, v4, v5
    v_lshl_add_u32 v181, v1, 3, v4
    v_mul_u32_u24 v4, 5, v8
    v_add_u32 v4, 0, v4
    v_lshrrev_b32 v5, 1, v4
    v_lshlrev_b32 v5, 11, v5
    v_and_b32 v4, 1, v4
    v_lshl_add_u32 v4, v4, 3, v5
    v_add_u32 v182, v4, v6
    v_mul_u32_u24 v4, 5, v8
    v_add_u32 v4, 1, v4
    v_lshrrev_b32 v5, 1, v4
    v_lshlrev_b32 v5, 11, v5
    v_and_b32 v4, 1, v4
    v_lshl_add_u32 v4, v4, 3, v5
    v_add_u32 v183, v4, v6
    v_mul_u32_u24 v4, 5, v8
    v_add_u32 v4, 2, v4
    v_lshrrev_b32 v5, 1, v4
    v_lshlrev_b32 v5, 11, v5
    v_and_b32 v4, 1, v4
    v_lshl_add_u32 v4, v4, 3, v5
    v_add_u32 v184, v4, v6
    v_mul_u32_u24 v4, 5, v8
    v_add_u32 v4, 3, v4
    v_lshrrev_b32 v5, 1, v4
    v_lshlrev_b32 v5, 11, v5
    v_and_b32 v4, 1, v4
    v_lshl_add_u32 v4, v4, 3, v5
    v_add_u32 v185, v4, v6
    v_mul_u32_u24 v4, 5, v8
    v_add_u32 v4, 4, v4
    v_lshrrev_b32 v5, 1, v4
    v_lshlrev_b32 v5, 11, v5
    v_and_b32 v4, 1, v4
    v_lshl_add_u32 v4, v4, 3, v5
    v_add_u32 v186, v4, v6
    s_lshl_b32 s41, s18, 5
    v_lshlrev_b32 v188, 2, v9
    v_add_u32 v187, s41, v188
    v_mul_u32_u24 v4, 320, v8
    v_lshl_add_u32 v4, v1, 4, v4
    s_mul_i32 s41, s18, 640
    s_add_u32 s42, s41, 0x5f1400
    buffer_load_dwordx4 v[20:23], v4, s[4:7], s42 offen offset:0 sc1
    buffer_load_dwordx4 v[24:27], v4, s[4:7], s42 offen offset:64 sc1
    buffer_load_dwordx4 v[28:31], v4, s[4:7], s42 offen offset:128 sc1
    buffer_load_dwordx4 v[32:35], v4, s[4:7], s42 offen offset:192 sc1
    buffer_load_dwordx4 v[36:39], v4, s[4:7], s42 offen offset:256 sc1
    s_add_u32 s42, s41, 0x5f2800
    buffer_load_dwordx4 v[40:43], v4, s[4:7], s42 offen offset:0 sc1
    buffer_load_dwordx4 v[44:47], v4, s[4:7], s42 offen offset:64 sc1
    buffer_load_dwordx4 v[48:51], v4, s[4:7], s42 offen offset:128 sc1
    buffer_load_dwordx4 v[52:55], v4, s[4:7], s42 offen offset:192 sc1
    buffer_load_dwordx4 v[56:59], v4, s[4:7], s42 offen offset:256 sc1
    s_add_u32 s42, s41, 0x5f1e00
    buffer_load_dwordx4 v[60:63], v4, s[4:7], s42 offen offset:0 sc1
    buffer_load_dwordx4 v[64:67], v4, s[4:7], s42 offen offset:64 sc1
    buffer_load_dwordx4 v[68:71], v4, s[4:7], s42 offen offset:128 sc1
    buffer_load_dwordx4 v[72:75], v4, s[4:7], s42 offen offset:192 sc1
    buffer_load_dwordx4 v[76:79], v4, s[4:7], s42 offen offset:256 sc1
    s_waitcnt vmcnt(0)
    v_add_f32 v40, 1.0, v40
    v_add_f32 v41, 1.0, v41
    v_cvt_pk_bf16_f32 v4, v40, v41
    v_lshlrev_b32 v40, 16, v4
    v_and_b32 v41, 0xffff0000, v4
    v_add_f32 v42, 1.0, v42
    v_add_f32 v43, 1.0, v43
    v_cvt_pk_bf16_f32 v4, v42, v43
    v_lshlrev_b32 v42, 16, v4
    v_and_b32 v43, 0xffff0000, v4
    v_add_f32 v44, 1.0, v44
    v_add_f32 v45, 1.0, v45
    v_cvt_pk_bf16_f32 v4, v44, v45
    v_lshlrev_b32 v44, 16, v4
    v_and_b32 v45, 0xffff0000, v4
    v_add_f32 v46, 1.0, v46
    v_add_f32 v47, 1.0, v47
    v_cvt_pk_bf16_f32 v4, v46, v47
    v_lshlrev_b32 v46, 16, v4
    v_and_b32 v47, 0xffff0000, v4
    v_add_f32 v48, 1.0, v48
    v_add_f32 v49, 1.0, v49
    v_cvt_pk_bf16_f32 v4, v48, v49
    v_lshlrev_b32 v48, 16, v4
    v_and_b32 v49, 0xffff0000, v4
    v_add_f32 v50, 1.0, v50
    v_add_f32 v51, 1.0, v51
    v_cvt_pk_bf16_f32 v4, v50, v51
    v_lshlrev_b32 v50, 16, v4
    v_and_b32 v51, 0xffff0000, v4
    v_add_f32 v52, 1.0, v52
    v_add_f32 v53, 1.0, v53
    v_cvt_pk_bf16_f32 v4, v52, v53
    v_lshlrev_b32 v52, 16, v4
    v_and_b32 v53, 0xffff0000, v4
    v_add_f32 v54, 1.0, v54
    v_add_f32 v55, 1.0, v55
    v_cvt_pk_bf16_f32 v4, v54, v55
    v_lshlrev_b32 v54, 16, v4
    v_and_b32 v55, 0xffff0000, v4
    v_add_f32 v56, 1.0, v56
    v_add_f32 v57, 1.0, v57
    v_cvt_pk_bf16_f32 v4, v56, v57
    v_lshlrev_b32 v56, 16, v4
    v_and_b32 v57, 0xffff0000, v4
    v_add_f32 v58, 1.0, v58
    v_add_f32 v59, 1.0, v59
    v_cvt_pk_bf16_f32 v4, v58, v59
    v_lshlrev_b32 v58, 16, v4
    v_and_b32 v59, 0xffff0000, v4
    s_load_dwordx2 s[44:45], s[0:1], 0
    s_waitcnt lgkmcnt(0)
    s_mov_b32 s8, s44
    s_mov_b32 s9, s45
    s_mov_b32 s10, 0x280000
    s_mov_b32 s11, 0x20000
L_ln2_110:
    v_mov_b32 v4, 1024
    s_cmp_lg_u32 s18, 0
    s_cbranch_scc1 L_lq_111
    v_mov_b32 v5, 1
    s_mov_b64 exec, 1
    buffer_atomic_add v5, off, s[12:15], 0 offset:24 sc0 sc1
    s_waitcnt vmcnt(0)
    ds_write_b32 v4, v5
    s_mov_b64 exec, -1
    s_waitcnt lgkmcnt(0)
L_lq_111:
    s_barrier
    ds_read_b32 v5, v4
    s_waitcnt lgkmcnt(0)
    v_readfirstlane_b32 s28, v5
    s_cmp_ge_u32 s28, 256
    s_cbranch_scc1 L_end
    s_lshr_b32 s29, s28, 2
    s_lshl_b32 s21, s29, 7
    s_and_b32 s22, s28, 3
    s_lshl_b32 s22, s22, 2
    s_add_u32 s22, s22, s21
    s_add_u32 s22, s22, 0x528000
    s_add_u32 s21, s21, 0x524000
    s_bfe_u32 s41, s28, 0x10001
    s_lshl_b32 s41, s41, 13
    s_cmp_ge_u32 s28, 168
    s_cselect_b32 s41, s41, 0
    s_add_u32 s21, s21, s41
    s_mul_i32 s30, s28, 10240
    s_mul_i32 s41, s18, 320
    s_add_u32 s30, s30, s41
    buffer_load_dwordx2 v[160:161], v181, s[8:11], s30 offen offset:0
    buffer_load_dwordx2 v[162:163], v181, s[8:11], s30 offen offset:32
    buffer_load_dwordx2 v[164:165], v181, s[8:11], s30 offen offset:64
    buffer_load_dwordx2 v[166:167], v181, s[8:11], s30 offen offset:96
    buffer_load_dwordx2 v[168:169], v181, s[8:11], s30 offen offset:128
    s_bfe_u32 s31, s28, 0x10001
    s_lshl_b32 s31, s31, 10
    s_and_b32 s41, s28, 1
    s_lshl_b32 s41, s41, 7
    s_add_u32 s31, s31, s41
    s_mul_i32 s30, s29, 327680
    s_add_u32 s30, s30, s31
    s_mul_i32 s41, s18, 20480
    s_add_u32 s30, s30, s41
    s_add_u32 s30, s30, 0x4100000
    v_min_u32 v4, 19, v0
    v_lshlrev_b32 v4, 2, v4
L_wf_112:
    buffer_load_dword v5, v4, s[4:7], s21 offen sc1
    s_waitcnt vmcnt(0)
    v_cmp_ne_u32 vcc, 1, v5
    s_cbranch_vccz L_wfd_113
    s_sleep 2
    s_add_u32 s46, s46, 1
    s_cmp_lt_u32 s46, 131072
    s_cbranch_scc1 L_wf_112
    s_branch L_end
L_wfd_113:
    s_add_u32 s41, s30, 0
    buffer_load_dwordx4 v[80:83], v180, s[4:7], s41 offen sc1
    s_add_u32 s41, s30, 81920
    buffer_load_dwordx4 v[100:103], v180, s[4:7], s41 offen sc1
    s_add_u32 s41, s30, 163840
    buffer_load_dwordx4 v[120:123], v180, s[4:7], s41 offen sc1
    s_add_u32 s41, s30, 245760
    buffer_load_dwordx4 v[140:143], v180, s[4:7], s41 offen sc1
    s_add_u32 s41, s30, 2048
    buffer_load_dwordx4 v[84:87], v180, s[4:7], s41 offen sc1
    s_add_u32 s41, s30, 83968
    buffer_load_dwordx4 v[104:107], v180, s[4:7], s41 offen sc1
    s_add_u32 s41, s30, 165888
    buffer_load_dwordx4 v[124:127], v180, s[4:7], s41 offen sc1
    s_add_u32 s41, s30, 247808
    buffer_load_dwordx4 v[144:147], v180, s[4:7], s41 offen sc1
    s_add_u32 s41, s30, 4096
    buffer_load_dwordx4 v[88:91], v180, s[4:7], s41 offen sc1
    s_add_u32 s41, s30, 86016
    buffer_load_dwordx4 v[108:111], v180, s[4:7], s41 offen sc1
    s_add_u32 s41, s30, 167936
    buffer_load_dwordx4 v[128:131], v180, s[4:7], s41 offen sc1
    s_add_u32 s41, s30, 249856
    buffer_load_dwordx4 v[148:151], v180, s[4:7], s41 offen sc1
    s_add_u32 s41, s30, 6144
    buffer_load_dwordx4 v[92:95], v180, s[4:7], s41 offen sc1
    s_add_u32 s41, s30, 88064
    buffer_load_dwordx4 v[112:115], v180, s[4:7], s41 offen sc1
    s_add_u32 s41, s30, 169984
    buffer_load_dwordx4 v[132:135], v180, s[4:7], s41 offen sc1
    s_add_u32 s41, s30, 251904
    buffer_load_dwordx4 v[152:155], v180, s[4:7], s41 offen sc1
    s_add_u32 s41, s30, 8192
    buffer_load_dwordx4 v[96:99], v180, s[4:7], s41 offen sc1
    s_add_u32 s41, s30, 90112
    buffer_load_dwordx4 v[116:119], v180, s[4:7], s41 offen sc1
    s_add_u32 s41, s30, 172032
    buffer_load_dwordx4 v[136:139], v180, s[4:7], s41 offen sc1
    s_add_u32 s41, s30, 253952
    buffer_load_dwordx4 v[156:159], v180, s[4:7], s41 offen sc1
    s_mul_i32 s30, s29, 40960
    s_add_u32 s30, s30, s31
    s_mul_i32 s41, s18, 10240
    s_add_u32 s30, s30, s41
    s_add_u32 s31, s30, 0x5500000
    s_add_u32 s30, s30, 0x5800000
    v_mov_b64 v[6:7], 0
    s_waitcnt vmcnt(16)
    v_pk_add_f32 v[80:81], v[80:81], v[100:101]
    v_pk_add_f32 v[120:121], v[120:121], v[140:141]
    v_pk_add_f32 v[80:81], v[80:81], v[120:121]
    v_cvt_pk_bf16_f32 v4, v80, v81
    v_lshlrev_b32 v80, 16, v4
    v_and_b32 v81, 0xffff0000, v4
    v_pk_mul_f32 v[80:81], v[80:81], v[20:21]
    v_cvt_pk_bf16_f32 v4, v80, v81
    v_lshlrev_b32 v80, 16, v4
    v_and_b32 v81, 0xffff0000, v4
    v_lshlrev_b32 v4, 16, v160
    v_and_b32 v5, 0xffff0000, v160
    v_pk_add_f32 v[80:81], v[80:81], v[4:5]
    v_cvt_pk_bf16_f32 v160, v80, v81
    v_lshlrev_b32 v80, 16, v160
    v_and_b32 v81, 0xffff0000, v160
    v_pk_add_f32 v[6:7], v[6:7], v[80:81]
    v_pk_add_f32 v[82:83], v[82:83], v[102:103]
    v_pk_add_f32 v[122:123], v[122:123], v[142:143]
    v_pk_add_f32 v[82:83], v[82:83], v[122:123]
    v_cvt_pk_bf16_f32 v4, v82, v83
    v_lshlrev_b32 v82, 16, v4
    v_and_b32 v83, 0xffff0000, v4
    v_pk_mul_f32 v[82:83], v[82:83], v[22:23]
    v_cvt_pk_bf16_f32 v4, v82, v83
    v_lshlrev_b32 v82, 16, v4
    v_and_b32 v83, 0xffff0000, v4
    v_lshlrev_b32 v4, 16, v161
    v_and_b32 v5, 0xffff0000, v161
    v_pk_add_f32 v[82:83], v[82:83], v[4:5]
    v_cvt_pk_bf16_f32 v161, v82, v83
    v_lshlrev_b32 v82, 16, v161
    v_and_b32 v83, 0xffff0000, v161
    v_pk_add_f32 v[6:7], v[6:7], v[82:83]
    buffer_store_dwordx2 v[160:161], v182, s[4:7], s31 offen sc1
    s_waitcnt vmcnt(13)
    v_pk_add_f32 v[84:85], v[84:85], v[104:105]
    v_pk_add_f32 v[124:125], v[124:125], v[144:145]
    v_pk_add_f32 v[84:85], v[84:85], v[124:125]
    v_cvt_pk_bf16_f32 v4, v84, v85
    v_lshlrev_b32 v84, 16, v4
    v_and_b32 v85, 0xffff0000, v4
    v_pk_mul_f32 v[84:85], v[84:85], v[24:25]
    v_cvt_pk_bf16_f32 v4, v84, v85
    v_lshlrev_b32 v84, 16, v4
    v_and_b32 v85, 0xffff0000, v4
    v_lshlrev_b32 v4, 16, v162
    v_and_b32 v5, 0xffff0000, v162
    v_pk_add_f32 v[84:85], v[84:85], v[4:5]
    v_cvt_pk_bf16_f32 v162, v84, v85
    v_lshlrev_b32 v84, 16, v162
    v_and_b32 v85, 0xffff0000, v162
    v_pk_add_f32 v[6:7], v[6:7], v[84:85]
    v_pk_add_f32 v[86:87], v[86:87], v[106:107]
    v_pk_add_f32 v[126:127], v[126:127], v[146:147]
    v_pk_add_f32 v[86:87], v[86:87], v[126:127]
    v_cvt_pk_bf16_f32 v4, v86, v87
    v_lshlrev_b32 v86, 16, v4
    v_and_b32 v87, 0xffff0000, v4
    v_pk_mul_f32 v[86:87], v[86:87], v[26:27]
    v_cvt_pk_bf16_f32 v4, v86, v87
    v_lshlrev_b32 v86, 16, v4
    v_and_b32 v87, 0xffff0000, v4
    v_lshlrev_b32 v4, 16, v163
    v_and_b32 v5, 0xffff0000, v163
    v_pk_add_f32 v[86:87], v[86:87], v[4:5]
    v_cvt_pk_bf16_f32 v163, v86, v87
    v_lshlrev_b32 v86, 16, v163
    v_and_b32 v87, 0xffff0000, v163
    v_pk_add_f32 v[6:7], v[6:7], v[86:87]
    buffer_store_dwordx2 v[162:163], v183, s[4:7], s31 offen sc1
    s_waitcnt vmcnt(10)
    v_pk_add_f32 v[88:89], v[88:89], v[108:109]
    v_pk_add_f32 v[128:129], v[128:129], v[148:149]
    v_pk_add_f32 v[88:89], v[88:89], v[128:129]
    v_cvt_pk_bf16_f32 v4, v88, v89
    v_lshlrev_b32 v88, 16, v4
    v_and_b32 v89, 0xffff0000, v4
    v_pk_mul_f32 v[88:89], v[88:89], v[28:29]
    v_cvt_pk_bf16_f32 v4, v88, v89
    v_lshlrev_b32 v88, 16, v4
    v_and_b32 v89, 0xffff0000, v4
    v_lshlrev_b32 v4, 16, v164
    v_and_b32 v5, 0xffff0000, v164
    v_pk_add_f32 v[88:89], v[88:89], v[4:5]
    v_cvt_pk_bf16_f32 v164, v88, v89
    v_lshlrev_b32 v88, 16, v164
    v_and_b32 v89, 0xffff0000, v164
    v_pk_add_f32 v[6:7], v[6:7], v[88:89]
    v_pk_add_f32 v[90:91], v[90:91], v[110:111]
    v_pk_add_f32 v[130:131], v[130:131], v[150:151]
    v_pk_add_f32 v[90:91], v[90:91], v[130:131]
    v_cvt_pk_bf16_f32 v4, v90, v91
    v_lshlrev_b32 v90, 16, v4
    v_and_b32 v91, 0xffff0000, v4
    v_pk_mul_f32 v[90:91], v[90:91], v[30:31]
    v_cvt_pk_bf16_f32 v4, v90, v91
    v_lshlrev_b32 v90, 16, v4
    v_and_b32 v91, 0xffff0000, v4
    v_lshlrev_b32 v4, 16, v165
    v_and_b32 v5, 0xffff0000, v165
    v_pk_add_f32 v[90:91], v[90:91], v[4:5]
    v_cvt_pk_bf16_f32 v165, v90, v91
    v_lshlrev_b32 v90, 16, v165
    v_and_b32 v91, 0xffff0000, v165
    v_pk_add_f32 v[6:7], v[6:7], v[90:91]
    buffer_store_dwordx2 v[164:165], v184, s[4:7], s31 offen sc1
    s_waitcnt vmcnt(7)
    v_pk_add_f32 v[92:93], v[92:93], v[112:113]
    v_pk_add_f32 v[132:133], v[132:133], v[152:153]
    v_pk_add_f32 v[92:93], v[92:93], v[132:133]
    v_cvt_pk_bf16_f32 v4, v92, v93
    v_lshlrev_b32 v92, 16, v4
    v_and_b32 v93, 0xffff0000, v4
    v_pk_mul_f32 v[92:93], v[92:93], v[32:33]
    v_cvt_pk_bf16_f32 v4, v92, v93
    v_lshlrev_b32 v92, 16, v4
    v_and_b32 v93, 0xffff0000, v4
    v_lshlrev_b32 v4, 16, v166
    v_and_b32 v5, 0xffff0000, v166
    v_pk_add_f32 v[92:93], v[92:93], v[4:5]
    v_cvt_pk_bf16_f32 v166, v92, v93
    v_lshlrev_b32 v92, 16, v166
    v_and_b32 v93, 0xffff0000, v166
    v_pk_add_f32 v[6:7], v[6:7], v[92:93]
    v_pk_add_f32 v[94:95], v[94:95], v[114:115]
    v_pk_add_f32 v[134:135], v[134:135], v[154:155]
    v_pk_add_f32 v[94:95], v[94:95], v[134:135]
    v_cvt_pk_bf16_f32 v4, v94, v95
    v_lshlrev_b32 v94, 16, v4
    v_and_b32 v95, 0xffff0000, v4
    v_pk_mul_f32 v[94:95], v[94:95], v[34:35]
    v_cvt_pk_bf16_f32 v4, v94, v95
    v_lshlrev_b32 v94, 16, v4
    v_and_b32 v95, 0xffff0000, v4
    v_lshlrev_b32 v4, 16, v167
    v_and_b32 v5, 0xffff0000, v167
    v_pk_add_f32 v[94:95], v[94:95], v[4:5]
    v_cvt_pk_bf16_f32 v167, v94, v95
    v_lshlrev_b32 v94, 16, v167
    v_and_b32 v95, 0xffff0000, v167
    v_pk_add_f32 v[6:7], v[6:7], v[94:95]
    buffer_store_dwordx2 v[166:167], v185, s[4:7], s31 offen sc1
    s_waitcnt vmcnt(4)
    v_pk_add_f32 v[96:97], v[96:97], v[116:117]
    v_pk_add_f32 v[136:137], v[136:137], v[156:157]
    v_pk_add_f32 v[96:97], v[96:97], v[136:137]
    v_cvt_pk_bf16_f32 v4, v96, v97
    v_lshlrev_b32 v96, 16, v4
    v_and_b32 v97, 0xffff0000, v4
    v_pk_mul_f32 v[96:97], v[96:97], v[36:37]
    v_cvt_pk_bf16_f32 v4, v96, v97
    v_lshlrev_b32 v96, 16, v4
    v_and_b32 v97, 0xffff0000, v4
    v_lshlrev_b32 v4, 16, v168
    v_and_b32 v5, 0xffff0000, v168
    v_pk_add_f32 v[96:97], v[96:97], v[4:5]
    v_cvt_pk_bf16_f32 v168, v96, v97
    v_lshlrev_b32 v96, 16, v168
    v_and_b32 v97, 0xffff0000, v168
    v_pk_add_f32 v[6:7], v[6:7], v[96:97]
    v_pk_add_f32 v[98:99], v[98:99], v[118:119]
    v_pk_add_f32 v[138:139], v[138:139], v[158:159]
    v_pk_add_f32 v[98:99], v[98:99], v[138:139]
    v_cvt_pk_bf16_f32 v4, v98, v99
    v_lshlrev_b32 v98, 16, v4
    v_and_b32 v99, 0xffff0000, v4
    v_pk_mul_f32 v[98:99], v[98:99], v[38:39]
    v_cvt_pk_bf16_f32 v4, v98, v99
    v_lshlrev_b32 v98, 16, v4
    v_and_b32 v99, 0xffff0000, v4
    v_lshlrev_b32 v4, 16, v169
    v_and_b32 v5, 0xffff0000, v169
    v_pk_add_f32 v[98:99], v[98:99], v[4:5]
    v_cvt_pk_bf16_f32 v169, v98, v99
    v_lshlrev_b32 v98, 16, v169
    v_and_b32 v99, 0xffff0000, v169
    v_pk_add_f32 v[6:7], v[6:7], v[98:99]
    buffer_store_dwordx2 v[168:169], v186, s[4:7], s31 offen sc1
    v_add_f32 v4, v6, v7
    v_mov_b32 v5, v4
    s_nop 1
    v_permlane16_swap_b32 v4, v5
    v_add_f32 v4, v4, v5
    v_mov_b32 v5, v4
    s_nop 1
    v_permlane32_swap_b32 v4, v5
    v_add_f32 v4, v4, v5
    s_nop 1
    v_add_f32_dpp v5, v4, v4 row_ror:8 row_mask:0xf bank_mask:0xf
    ds_write_b32 v187, v5 offset:0
    s_waitcnt lgkmcnt(0)
    s_barrier
    ds_read_b32 v12, v188 offset:0
    ds_read_b32 v13, v188 offset:32
    ds_read_b32 v14, v188 offset:64
    ds_read_b32 v15, v188 offset:96
    s_waitcnt lgkmcnt(0)
    v_add_f32 v12, v12, v13
    v_add_f32 v14, v14, v15
    v_add_f32 v12, v12, v14
    v_mul_f32 v190, 0x3acccccd, v12
    v_sub_f32 v190, 0, v190
    v_mov_b32 v191, v190
    v_mov_b64 v[6:7], 0
    v_pk_add_f32 v[4:5], v[80:81], v[190:191]
    v_pk_fma_f32 v[6:7], v[4:5], v[4:5], v[6:7]
    v_pk_add_f32 v[4:5], v[82:83], v[190:191]
    v_pk_fma_f32 v[6:7], v[4:5], v[4:5], v[6:7]
    v_pk_add_f32 v[4:5], v[84:85], v[190:191]
    v_pk_fma_f32 v[6:7], v[4:5], v[4:5], v[6:7]
    v_pk_add_f32 v[4:5], v[86:87], v[190:191]
    v_pk_fma_f32 v[6:7], v[4:5], v[4:5], v[6:7]
    v_pk_add_f32 v[4:5], v[88:89], v[190:191]
    v_pk_fma_f32 v[6:7], v[4:5], v[4:5], v[6:7]
    v_pk_add_f32 v[4:5], v[90:91], v[190:191]
    v_pk_fma_f32 v[6:7], v[4:5], v[4:5], v[6:7]
    v_pk_add_f32 v[4:5], v[92:93], v[190:191]
    v_pk_fma_f32 v[6:7], v[4:5], v[4:5], v[6:7]
    v_pk_add_f32 v[4:5], v[94:95], v[190:191]
    v_pk_fma_f32 v[6:7], v[4:5], v[4:5], v[6:7]
    v_pk_add_f32 v[4:5], v[96:97], v[190:191]
    v_pk_fma_f32 v[6:7], v[4:5], v[4:5], v[6:7]
    v_pk_add_f32 v[4:5], v[98:99], v[190:191]
    v_pk_fma_f32 v[6:7], v[4:5], v[4:5], v[6:7]
    v_add_f32 v4, v6, v7
    v_mov_b32 v5, v4
    s_nop 1
    v_permlane16_swap_b32 v4, v5
    v_add_f32 v4, v4, v5
    v_mov_b32 v5, v4
    s_nop 1
    v_permlane32_swap_b32 v4, v5
    v_add_f32 v4, v4, v5
    s_nop 1
    v_add_f32_dpp v5, v4, v4 row_ror:8 row_mask:0xf bank_mask:0xf
    ds_write_b32 v187, v5 offset:256
    s_waitcnt lgkmcnt(0)
    s_barrier
    ds_read_b32 v12, v188 offset:256
    ds_read_b32 v13, v188 offset:288
    ds_read_b32 v14, v188 offset:320
    ds_read_b32 v15, v188 offset:352
    s_waitcnt lgkmcnt(0)
    v_add_f32 v12, v12, v13
    v_add_f32 v14, v14, v15
    v_add_f32 v12, v12, v14
    v_mul_f32 v192, 0x3acccccd, v12
    v_cvt_pk_bf16_f32 v4, v190, v192
    v_lshlrev_b32 v190, 16, v4
    v_and_b32 v192, 0xffff0000, v4
    v_mov_b32 v191, v190
    v_add_f32 v192, 0x3727c5ac, v192
    v_cvt_pk_bf16_f32 v192, v192, v192
    v_and_b32 v192, 0xffff0000, v192
    v_sqrt_f32 v192, v192
    s_nop 0
    v_cvt_pk_bf16_f32 v192, v192, v192
    v_and_b32 v192, 0xffff0000, v192
    v_rcp_f32 v192, v192
    s_nop 0
    v_mov_b32 v193, v192
    v_pk_add_f32 v[80:81], v[80:81], v[190:191]
    v_cvt_pk_bf16_f32 v4, v80, v81
    v_lshlrev_b32 v80, 16, v4
    v_and_b32 v81, 0xffff0000, v4
    v_pk_mul_f32 v[80:81], v[80:81], v[192:193]
    v_cvt_pk_bf16_f32 v4, v80, v81
    v_lshlrev_b32 v80, 16, v4
    v_and_b32 v81, 0xffff0000, v4
    v_pk_mul_f32 v[80:81], v[80:81], v[40:41]
    v_cvt_pk_bf16_f32 v4, v80, v81
    v_lshlrev_b32 v80, 16, v4
    v_and_b32 v81, 0xffff0000, v4
    v_pk_add_f32 v[80:81], v[80:81], v[60:61]
    v_cvt_pk_bf16_f32 v170, v80, v81
    v_pk_add_f32 v[82:83], v[82:83], v[190:191]
    v_cvt_pk_bf16_f32 v4, v82, v83
    v_lshlrev_b32 v82, 16, v4
    v_and_b32 v83, 0xffff0000, v4
    v_pk_mul_f32 v[82:83], v[82:83], v[192:193]
    v_cvt_pk_bf16_f32 v4, v82, v83
    v_lshlrev_b32 v82, 16, v4
    v_and_b32 v83, 0xffff0000, v4
    v_pk_mul_f32 v[82:83], v[82:83], v[42:43]
    v_cvt_pk_bf16_f32 v4, v82, v83
    v_lshlrev_b32 v82, 16, v4
    v_and_b32 v83, 0xffff0000, v4
    v_pk_add_f32 v[82:83], v[82:83], v[62:63]
    v_cvt_pk_bf16_f32 v171, v82, v83
    buffer_store_dwordx2 v[170:171], v182, s[4:7], s30 offen sc1
    v_pk_add_f32 v[84:85], v[84:85], v[190:191]
    v_cvt_pk_bf16_f32 v4, v84, v85
    v_lshlrev_b32 v84, 16, v4
    v_and_b32 v85, 0xffff0000, v4
    v_pk_mul_f32 v[84:85], v[84:85], v[192:193]
    v_cvt_pk_bf16_f32 v4, v84, v85
    v_lshlrev_b32 v84, 16, v4
    v_and_b32 v85, 0xffff0000, v4
    v_pk_mul_f32 v[84:85], v[84:85], v[44:45]
    v_cvt_pk_bf16_f32 v4, v84, v85
    v_lshlrev_b32 v84, 16, v4
    v_and_b32 v85, 0xffff0000, v4
    v_pk_add_f32 v[84:85], v[84:85], v[64:65]
    v_cvt_pk_bf16_f32 v172, v84, v85
    v_pk_add_f32 v[86:87], v[86:87], v[190:191]
    v_cvt_pk_bf16_f32 v4, v86, v87
    v_lshlrev_b32 v86, 16, v4
    v_and_b32 v87, 0xffff0000, v4
    v_pk_mul_f32 v[86:87], v[86:87], v[192:193]
    v_cvt_pk_bf16_f32 v4, v86, v87
    v_lshlrev_b32 v86, 16, v4
    v_and_b32 v87, 0xffff0000, v4
    v_pk_mul_f32 v[86:87], v[86:87], v[46:47]
    v_cvt_pk_bf16_f32 v4, v86, v87
    v_lshlrev_b32 v86, 16, v4
    v_and_b32 v87, 0xffff0000, v4
    v_pk_add_f32 v[86:87], v[86:87], v[66:67]
    v_cvt_pk_bf16_f32 v173, v86, v87
    buffer_store_dwordx2 v[172:173], v183, s[4:7], s30 offen sc1
    v_pk_add_f32 v[88:89], v[88:89], v[190:191]
    v_cvt_pk_bf16_f32 v4, v88, v89
    v_lshlrev_b32 v88, 16, v4
    v_and_b32 v89, 0xffff0000, v4
    v_pk_mul_f32 v[88:89], v[88:89], v[192:193]
    v_cvt_pk_bf16_f32 v4, v88, v89
    v_lshlrev_b32 v88, 16, v4
    v_and_b32 v89, 0xffff0000, v4
    v_pk_mul_f32 v[88:89], v[88:89], v[48:49]
    v_cvt_pk_bf16_f32 v4, v88, v89
    v_lshlrev_b32 v88, 16, v4
    v_and_b32 v89, 0xffff0000, v4
    v_pk_add_f32 v[88:89], v[88:89], v[68:69]
    v_cvt_pk_bf16_f32 v174, v88, v89
    v_pk_add_f32 v[90:91], v[90:91], v[190:191]
    v_cvt_pk_bf16_f32 v4, v90, v91
    v_lshlrev_b32 v90, 16, v4
    v_and_b32 v91, 0xffff0000, v4
    v_pk_mul_f32 v[90:91], v[90:91], v[192:193]
    v_cvt_pk_bf16_f32 v4, v90, v91
    v_lshlrev_b32 v90, 16, v4
    v_and_b32 v91, 0xffff0000, v4
    v_pk_mul_f32 v[90:91], v[90:91], v[50:51]
    v_cvt_pk_bf16_f32 v4, v90, v91
    v_lshlrev_b32 v90, 16, v4
    v_and_b32 v91, 0xffff0000, v4
    v_pk_add_f32 v[90:91], v[90:91], v[70:71]
    v_cvt_pk_bf16_f32 v175, v90, v91
    buffer_store_dwordx2 v[174:175], v184, s[4:7], s30 offen sc1
    v_pk_add_f32 v[92:93], v[92:93], v[190:191]
    v_cvt_pk_bf16_f32 v4, v92, v93
    v_lshlrev_b32 v92, 16, v4
    v_and_b32 v93, 0xffff0000, v4
    v_pk_mul_f32 v[92:93], v[92:93], v[192:193]
    v_cvt_pk_bf16_f32 v4, v92, v93
    v_lshlrev_b32 v92, 16, v4
    v_and_b32 v93, 0xffff0000, v4
    v_pk_mul_f32 v[92:93], v[92:93], v[52:53]
    v_cvt_pk_bf16_f32 v4, v92, v93
    v_lshlrev_b32 v92, 16, v4
    v_and_b32 v93, 0xffff0000, v4
    v_pk_add_f32 v[92:93], v[92:93], v[72:73]
    v_cvt_pk_bf16_f32 v176, v92, v93
    v_pk_add_f32 v[94:95], v[94:95], v[190:191]
    v_cvt_pk_bf16_f32 v4, v94, v95
    v_lshlrev_b32 v94, 16, v4
    v_and_b32 v95, 0xffff0000, v4
    v_pk_mul_f32 v[94:95], v[94:95], v[192:193]
    v_cvt_pk_bf16_f32 v4, v94, v95
    v_lshlrev_b32 v94, 16, v4
    v_and_b32 v95, 0xffff0000, v4
    v_pk_mul_f32 v[94:95], v[94:95], v[54:55]
    v_cvt_pk_bf16_f32 v4, v94, v95
    v_lshlrev_b32 v94, 16, v4
    v_and_b32 v95, 0xffff0000, v4
    v_pk_add_f32 v[94:95], v[94:95], v[74:75]
    v_cvt_pk_bf16_f32 v177, v94, v95
    buffer_store_dwordx2 v[176:177], v185, s[4:7], s30 offen sc1
    v_pk_add_f32 v[96:97], v[96:97], v[190:191]
    v_cvt_pk_bf16_f32 v4, v96, v97
    v_lshlrev_b32 v96, 16, v4
    v_and_b32 v97, 0xffff0000, v4
    v_pk_mul_f32 v[96:97], v[96:97], v[192:193]
    v_cvt_pk_bf16_f32 v4, v96, v97
    v_lshlrev_b32 v96, 16, v4
    v_and_b32 v97, 0xffff0000, v4
    v_pk_mul_f32 v[96:97], v[96:97], v[56:57]
    v_cvt_pk_bf16_f32 v4, v96, v97
    v_lshlrev_b32 v96, 16, v4
    v_and_b32 v97, 0xffff0000, v4
    v_pk_add_f32 v[96:97], v[96:97], v[76:77]
    v_cvt_pk_bf16_f32 v178, v96, v97
    v_pk_add_f32 v[98:99], v[98:99], v[190:191]
    v_cvt_pk_bf16_f32 v4, v98, v99
    v_lshlrev_b32 v98, 16, v4
    v_and_b32 v99, 0xffff0000, v4
    v_pk_mul_f32 v[98:99], v[98:99], v[192:193]
    v_cvt_pk_bf16_f32 v4, v98, v99
    v_lshlrev_b32 v98, 16, v4
    v_and_b32 v99, 0xffff0000, v4
    v_pk_mul_f32 v[98:99], v[98:99], v[58:59]
    v_cvt_pk_bf16_f32 v4, v98, v99
    v_lshlrev_b32 v98, 16, v4
    v_and_b32 v99, 0xffff0000, v4
    v_pk_add_f32 v[98:99], v[98:99], v[78:79]
    v_cvt_pk_bf16_f32 v179, v98, v99
    buffer_store_dwordx2 v[178:179], v186, s[4:7], s30 offen sc1
    s_waitcnt vmcnt(0) lgkmcnt(0)
    s_barrier
    s_cmp_lg_u32 s18, 0
    s_cbranch_scc1 L_sig_114
    v_mov_b32 v4, 0
    v_mov_b32 v5, 1
    s_mov_b64 exec, 1
    buffer_store_dword v5, v4, s[4:7], s22 offen sc1
    s_mov_b64 exec, -1
L_sig_114:
    s_branch L_ln2_110
    s_branch L_end
L_q:
    s_mov_b32 s16, s99
    s_mov_b32 s41, 8192
    v_lshrrev_b32 v4, 2, v0
    v_mul_lo_u32 v4, v4, s41
    v_and_b32 v5, 3, v0
    v_lshl_add_u32 v8, v5, 4, v4
    v_lshrrev_b32 v4, 1, v0
    v_mul_lo_u32 v4, v4, s41
    v_and_b32 v5, 1, v0
    v_lshl_add_u32 v9, v5, 4, v4
    v_lshrrev_b32 v4, 2, v0
    v_and_b32 v5, 3, v0
    v_lshlrev_b32 v5, 3, v5
    v_lshl_add_u32 v10, v4, 6, v5
    v_add_u32 v10, s47, v10
    v_lshl_add_u32 v11, v4, 5, v5
    v_add_u32 v11, s47, v11
    s_load_dwordx2 s[44:45], s[0:1], 16
    s_waitcnt lgkmcnt(0)
    s_mov_b32 s8, s44
    s_mov_b32 s9, s45
    s_mov_b32 s10, 0x500000
    s_mov_b32 s11, 0x20000
    s_lshl_b32 s20, s16, 8
    s_mov_b32 s41, 8192
    v_or_b32 v4, 0, v1
    v_lshlrev_b32 v4, 1, v4
    v_xor_b32 v4, v4, v2
    v_mul_lo_u32 v5, v1, s41
    v_lshl_add_u32 v8, v4, 4, v5
    v_or_b32 v4, 4, v1
    v_lshlrev_b32 v4, 1, v4
    v_xor_b32 v4, v4, v2
    v_mul_lo_u32 v5, v1, s41
    v_lshl_add_u32 v9, v4, 4, v5
    v_bfe_u32 v4, v0, 2, 3
    v_lshlrev_b32 v4, 1, v4
    v_bfe_u32 v5, v0, 1, 1
    s_lshl_b32 s41, s18, 2
    v_or_b32 v5, s41, v5
    v_xor_b32 v4, v4, v5
    v_lshlrev_b32 v4, 4, v4
    v_lshrrev_b32 v5, 2, v0
    v_lshl_add_u32 v4, v5, 8, v4
    v_and_b32 v5, 1, v0
    v_lshl_add_u32 v6, v5, 3, v4
    s_mul_i32 s41, s18, 131072
    s_add_u32 s20, s20, s41
    s_lshl_b32 s42, s18, 12
    s_waitcnt lgkmcnt(0)
    s_barrier
    s_add_u32 m0, s42, 0
    s_nop 0
    buffer_load_dwordx4 v8, s[8:11], s20 offen lds
    s_add_u32 s20, s20, 32768
    s_add_u32 m0, s42, 1024
    s_nop 0
    buffer_load_dwordx4 v9, s[8:11], s20 offen lds
    s_add_u32 s20, s20, 32768
    s_add_u32 m0, s42, 2048
    s_nop 0
    buffer_load_dwordx4 v8, s[8:11], s20 offen lds
    s_add_u32 s20, s20, 32768
    s_add_u32 m0, s42, 3072
    s_nop 0
    buffer_load_dwordx4 v9, s[8:11], s20 offen lds
    s_add_u32 s20, s20, 425984
    s_add_u32 m0, s42, 16384
    s_nop 0
    buffer_load_dwordx4 v8, s[8:11], s20 offen lds
    s_add_u32 s20, s20, 32768
    s_add_u32 m0, s42, 17408
    s_nop 0
    buffer_load_dwordx4 v9, s[8:11], s20 offen lds
    s_add_u32 s20, s20, 32768
    s_add_u32 m0, s42, 18432
    s_nop 0
    buffer_load_dwordx4 v8, s[8:11], s20 offen lds
    s_add_u32 s20, s20, 32768
    s_add_u32 m0, s42, 19456
    s_nop 0
    buffer_load_dwordx4 v9, s[8:11], s20 offen lds
    s_add_u32 s20, s20, 425984
    s_add_u32 m0, s42, 32768
    s_nop 0
    buffer_load_dwordx4 v8, s[8:11], s20 offen lds
    s_add_u32 s20, s20, 32768
    s_add_u32 m0, s42, 33792
    s_nop 0
    buffer_load_dwordx4 v9, s[8:11], s20 offen lds
    s_add_u32 s20, s20, 32768
    s_add_u32 m0, s42, 34816
    s_nop 0
    buffer_load_dwordx4 v8, s[8:11], s20 offen lds
    s_add_u32 s20, s20, 32768
    s_add_u32 m0, s42, 35840
    s_nop 0
    buffer_load_dwordx4 v9, s[8:11], s20 offen lds
    s_add_u32 s20, s20, 425984
    s_add_u32 m0, s42, 49152
    s_nop 0
    buffer_load_dwordx4 v8, s[8:11], s20 offen lds
    s_add_u32 s20, s20, 32768
    s_add_u32 m0, s42, 50176
    s_nop 0
    buffer_load_dwordx4 v9, s[8:11], s20 offen lds
    s_add_u32 s20, s20, 32768
    s_add_u32 m0, s42, 51200
    s_nop 0
    buffer_load_dwordx4 v8, s[8:11], s20 offen lds
    s_add_u32 s20, s20, 32768
    s_add_u32 m0, s42, 52224
    s_nop 0
    buffer_load_dwordx4 v9, s[8:11], s20 offen lds
    s_add_u32 s20, s20, 425984
    s_add_u32 m0, s42, 65536
    s_nop 0
    buffer_load_dwordx4 v8, s[8:11], s20 offen lds
    s_add_u32 s20, s20, 32768
    s_add_u32 m0, s42, 66560
    s_nop 0
    buffer_load_dwordx4 v9, s[8:11], s20 offen lds
    s_add_u32 s20, s20, 32768
    s_add_u32 m0, s42, 67584
    s_nop 0
    buffer_load_dwordx4 v8, s[8:11], s20 offen lds
    s_add_u32 s20, s20, 32768
    s_add_u32 m0, s42, 68608
    s_nop 0
    buffer_load_dwordx4 v9, s[8:11], s20 offen lds
    s_add_u32 s20, s20, 425984
    s_add_u32 m0, s42, 81920
    s_nop 0
    buffer_load_dwordx4 v8, s[8:11], s20 offen lds
    s_add_u32 s20, s20, 32768
    s_add_u32 m0, s42, 82944
    s_nop 0
    buffer_load_dwordx4 v9, s[8:11], s20 offen lds
    s_add_u32 s20, s20, 32768
    s_add_u32 m0, s42, 83968
    s_nop 0
    buffer_load_dwordx4 v8, s[8:11], s20 offen lds
    s_add_u32 s20, s20, 32768
    s_add_u32 m0, s42, 84992
    s_nop 0
    buffer_load_dwordx4 v9, s[8:11], s20 offen lds
    s_add_u32 s20, s20, 425984
    s_add_u32 m0, s42, 98304
    s_nop 0
    buffer_load_dwordx4 v8, s[8:11], s20 offen lds
    s_add_u32 s20, s20, 32768
    s_add_u32 m0, s42, 99328
    s_nop 0
    buffer_load_dwordx4 v9, s[8:11], s20 offen lds
    s_add_u32 s20, s20, 32768
    s_add_u32 m0, s42, 100352
    s_nop 0
    buffer_load_dwordx4 v8, s[8:11], s20 offen lds
    s_add_u32 s20, s20, 32768
    s_add_u32 m0, s42, 101376
    s_nop 0
    buffer_load_dwordx4 v9, s[8:11], s20 offen lds
    s_add_u32 s20, s20, 425984
    s_add_u32 m0, s42, 114688
    s_nop 0
    buffer_load_dwordx4 v8, s[8:11], s20 offen lds
    s_add_u32 s20, s20, 32768
    s_add_u32 m0, s42, 115712
    s_nop 0
    buffer_load_dwordx4 v9, s[8:11], s20 offen lds
    s_add_u32 s20, s20, 32768
    s_add_u32 m0, s42, 116736
    s_nop 0
    buffer_load_dwordx4 v8, s[8:11], s20 offen lds
    s_add_u32 s20, s20, 32768
    s_add_u32 m0, s42, 117760
    s_nop 0
    buffer_load_dwordx4 v9, s[8:11], s20 offen lds
    s_add_u32 s20, s20, 425984
    s_add_u32 m0, s42, 131072
    s_nop 0
    buffer_load_dwordx4 v8, s[8:11], s20 offen lds
    s_add_u32 s20, s20, 32768
    s_add_u32 m0, s42, 132096
    s_nop 0
    buffer_load_dwordx4 v9, s[8:11], s20 offen lds
    s_add_u32 s20, s20, 32768
    s_add_u32 m0, s42, 133120
    s_nop 0
    buffer_load_dwordx4 v8, s[8:11], s20 offen lds
    s_add_u32 s20, s20, 32768
    s_add_u32 m0, s42, 134144
    s_nop 0
    buffer_load_dwordx4 v9, s[8:11], s20 offen lds
    s_add_u32 s20, s20, 425984
    s_add_u32 m0, s42, 147456
    s_nop 0
    buffer_load_dwordx4 v8, s[8:11], s20 offen lds
    s_add_u32 s20, s20, 32768
    s_add_u32 m0, s42, 148480
    s_nop 0
    buffer_load_dwordx4 v9, s[8:11], s20 offen lds
    s_add_u32 s20, s20, 32768
    s_add_u32 m0, s42, 149504
    s_nop 0
    buffer_load_dwordx4 v8, s[8:11], s20 offen lds
    s_add_u32 s20, s20, 32768
    s_add_u32 m0, s42, 150528
    s_nop 0
    buffer_load_dwordx4 v9, s[8:11], s20 offen lds
    s_add_u32 s20, s20, 425984
    v_add_u32 v10, 0, v6
    v_xor_b32 v11, 32, v10
    s_waitcnt vmcnt(36)
    s_barrier
    ds_read_b64_tr_b16 a[0:1], v10 offset:0
    ds_read_b64_tr_b16 a[2:3], v10 offset:4096
    ds_read_b64_tr_b16 a[4:5], v11 offset:0
    ds_read_b64_tr_b16 a[6:7], v11 offset:4096
    ds_read_b64_tr_b16 a[8:9], v10 offset:8192
    ds_read_b64_tr_b16 a[10:11], v10 offset:12288
    ds_read_b64_tr_b16 a[12:13], v11 offset:8192
    ds_read_b64_tr_b16 a[14:15], v11 offset:12288
    s_waitcnt vmcnt(32)
    s_barrier
    ds_read_b64_tr_b16 a[16:17], v10 offset:16384
    ds_read_b64_tr_b16 a[18:19], v10 offset:20480
    ds_read_b64_tr_b16 a[20:21], v11 offset:16384
    ds_read_b64_tr_b16 a[22:23], v11 offset:20480
    ds_read_b64_tr_b16 a[24:25], v10 offset:24576
    ds_read_b64_tr_b16 a[26:27], v10 offset:28672
    ds_read_b64_tr_b16 a[28:29], v11 offset:24576
    ds_read_b64_tr_b16 a[30:31], v11 offset:28672
    s_waitcnt vmcnt(28)
    s_barrier
    ds_read_b64_tr_b16 a[32:33], v10 offset:32768
    ds_read_b64_tr_b16 a[34:35], v10 offset:36864
    ds_read_b64_tr_b16 a[36:37], v11 offset:32768
    ds_read_b64_tr_b16 a[38:39], v11 offset:36864
    ds_read_b64_tr_b16 a[40:41], v10 offset:40960
    ds_read_b64_tr_b16 a[42:43], v10 offset:45056
    ds_read_b64_tr_b16 a[44:45], v11 offset:40960
    ds_read_b64_tr_b16 a[46:47], v11 offset:45056
    s_waitcnt vmcnt(24)
    s_barrier
    ds_read_b64_tr_b16 a[48:49], v10 offset:49152
    ds_read_b64_tr_b16 a[50:51], v10 offset:53248
    ds_read_b64_tr_b16 a[52:53], v11 offset:49152
    ds_read_b64_tr_b16 a[54:55], v11 offset:53248
    ds_read_b64_tr_b16 a[56:57], v10 offset:57344
    ds_read_b64_tr_b16 a[58:59], v10 offset:61440
    ds_read_b64_tr_b16 a[60:61], v11 offset:57344
    ds_read_b64_tr_b16 a[62:63], v11 offset:61440
    v_add_u32 v10, 65536, v6
    v_xor_b32 v11, 32, v10
    s_waitcnt vmcnt(20)
    s_barrier
    ds_read_b64_tr_b16 a[64:65], v10 offset:0
    ds_read_b64_tr_b16 a[66:67], v10 offset:4096
    ds_read_b64_tr_b16 a[68:69], v11 offset:0
    ds_read_b64_tr_b16 a[70:71], v11 offset:4096
    ds_read_b64_tr_b16 a[72:73], v10 offset:8192
    ds_read_b64_tr_b16 a[74:75], v10 offset:12288
    ds_read_b64_tr_b16 a[76:77], v11 offset:8192
    ds_read_b64_tr_b16 a[78:79], v11 offset:12288
    s_waitcnt vmcnt(16)
    s_barrier
    ds_read_b64_tr_b16 a[80:81], v10 offset:16384
    ds_read_b64_tr_b16 a[82:83], v10 offset:20480
    ds_read_b64_tr_b16 a[84:85], v11 offset:16384
    ds_read_b64_tr_b16 a[86:87], v11 offset:20480
    ds_read_b64_tr_b16 a[88:89], v10 offset:24576
    ds_read_b64_tr_b16 a[90:91], v10 offset:28672
    ds_read_b64_tr_b16 a[92:93], v11 offset:24576
    ds_read_b64_tr_b16 a[94:95], v11 offset:28672
    s_waitcnt vmcnt(12)
    s_barrier
    ds_read_b64_tr_b16 a[96:97], v10 offset:32768
    ds_read_b64_tr_b16 a[98:99], v10 offset:36864
    ds_read_b64_tr_b16 a[100:101], v11 offset:32768
    ds_read_b64_tr_b16 a[102:103], v11 offset:36864
    ds_read_b64_tr_b16 a[104:105], v10 offset:40960
    ds_read_b64_tr_b16 a[106:107], v10 offset:45056
    ds_read_b64_tr_b16 a[108:109], v11 offset:40960
    ds_read_b64_tr_b16 a[110:111], v11 offset:45056
    s_waitcnt vmcnt(8)
    s_barrier
    ds_read_b64_tr_b16 a[112:113], v10 offset:49152
    ds_read_b64_tr_b16 a[114:115], v10 offset:53248
    ds_read_b64_tr_b16 a[116:117], v11 offset:49152
    ds_read_b64_tr_b16 a[118:119], v11 offset:53248
    ds_read_b64_tr_b16 a[120:121], v10 offset:57344
    ds_read_b64_tr_b16 a[122:123], v10 offset:61440
    ds_read_b64_tr_b16 a[124:125], v11 offset:57344
    ds_read_b64_tr_b16 a[126:127], v11 offset:61440
    v_add_u32 v10, 131072, v6
    v_xor_b32 v11, 32, v10
    s_waitcnt vmcnt(4)
    s_barrier
    ds_read_b64_tr_b16 a[128:129], v10 offset:0
    ds_read_b64_tr_b16 a[130:131], v10 offset:4096
    ds_read_b64_tr_b16 a[132:133], v11 offset:0
    ds_read_b64_tr_b16 a[134:135], v11 offset:4096
    ds_read_b64_tr_b16 a[136:137], v10 offset:8192
    ds_read_b64_tr_b16 a[138:139], v10 offset:12288
    ds_read_b64_tr_b16 a[140:141], v11 offset:8192
    ds_read_b64_tr_b16 a[142:143], v11 offset:12288
    s_waitcnt vmcnt(0)
    s_barrier
    ds_read_b64_tr_b16 a[144:145], v10 offset:16384
    ds_read_b64_tr_b16 a[146:147], v10 offset:20480
    ds_read_b64_tr_b16 a[148:149], v11 offset:16384
    ds_read_b64_tr_b16 a[150:151], v11 offset:20480
    ds_read_b64_tr_b16 a[152:153], v10 offset:24576
    ds_read_b64_tr_b16 a[154:155], v10 offset:28672
    ds_read_b64_tr_b16 a[156:157], v11 offset:24576
    ds_read_b64_tr_b16 a[158:159], v11 offset:28672
    s_waitcnt lgkmcnt(0)
    s_barrier
    s_mov_b32 s19, 0
    s_mov_b32 s40, 64
    s_mov_b32 s20, 0x600000
    s_mov_b32 s21, 0x500000
    s_lshl_b32 s22, s16, 4
    s_add_u32 s22, s22, 0x518008
    s_lshl_b32 s23, s16, 13
    s_lshl_b32 s41, s18, 10
    s_add_u32 s23, s23, s41
    s_add_u32 s23, s23, 0x6300000
    v_min_u32 v10, 1, v0
    v_lshlrev_b32 v10, 2, v10
    s_mov_b32 s25, 0
    s_mul_i32 s41, s19, 40960
    s_add_u32 s20, s20, s41
    s_mul_i32 s41, s19, 8
    s_add_u32 s21, s21, s41
    s_mul_i32 s41, s19, 512
    s_add_u32 s22, s22, s41
L_gload_117:
    v_min_u32 v4, 1, v0
    v_lshlrev_b32 v4, 2, v4
L_wf_119:
    buffer_load_dword v5, v4, s[4:7], s21 offen sc1
    s_waitcnt vmcnt(0)
    v_cmp_ne_u32 vcc, 1, v5
    s_cbranch_vccz L_wfd_120
    s_sleep 1
    s_add_u32 s46, s46, 1
    s_cmp_lt_u32 s46, 131072
    s_cbranch_scc1 L_wf_119
    s_branch L_end
L_wfd_120:
    s_lshl_b32 s38, s18, 10
    s_add_u32 s38, s38, s25
    s_lshl_b32 s39, s18, 10
    s_add_u32 s39, s39, s20
    s_add_u32 s20, s20, 40960
    s_add_u32 s21, s21, 8
    s_add_u32 m0, s38, 0
    s_nop 0
    buffer_load_dwordx4 v3, s[4:7], s39 offen sc1 lds
    s_add_u32 s39, s39, 4096
    s_add_u32 m0, s38, 4096
    s_nop 0
    buffer_load_dwordx4 v3, s[4:7], s39 offen sc1 lds
    s_add_u32 s39, s39, 4096
    s_add_u32 m0, s38, 8192
    s_nop 0
    buffer_load_dwordx4 v3, s[4:7], s39 offen sc1 lds
    s_add_u32 s39, s39, 4096
    s_add_u32 m0, s38, 12288
    s_nop 0
    buffer_load_dwordx4 v3, s[4:7], s39 offen sc1 lds
    s_add_u32 s39, s39, 4096
    s_add_u32 m0, s38, 16384
    s_nop 0
    buffer_load_dwordx4 v3, s[4:7], s39 offen sc1 lds
    s_add_u32 s39, s39, 4096
    s_add_u32 m0, s38, 20480
    s_nop 0
    buffer_load_dwordx4 v3, s[4:7], s39 offen sc1 lds
    s_add_u32 s39, s39, 4096
    s_add_u32 m0, s38, 24576
    s_nop 0
    buffer_load_dwordx4 v3, s[4:7], s39 offen sc1 lds
    s_add_u32 s39, s39, 4096
    s_add_u32 m0, s38, 28672
    s_nop 0
    buffer_load_dwordx4 v3, s[4:7], s39 offen sc1 lds
    s_add_u32 s39, s39, 4096
    s_add_u32 m0, s38, 32768
    s_nop 0
    buffer_load_dwordx4 v3, s[4:7], s39 offen sc1 lds
    s_add_u32 s39, s39, 4096
    s_add_u32 m0, s38, 36864
    s_nop 0
    buffer_load_dwordx4 v3, s[4:7], s39 offen sc1 lds
    s_add_u32 s39, s39, 4096
    buffer_load_dword v11, v10, s[4:7], s21 offen sc1
    s_mov_b32 s37, 0
    s_waitcnt vmcnt(0) lgkmcnt(0)
    s_branch L_ggo_118
L_gtop_115:
    s_waitcnt vmcnt(3)
L_ggo_118:
    s_barrier
    v_add_u32 v8, s25, v3
    s_add_u32 s27, s19, 1
    s_sub_u32 s25, 40960, s25
    ds_read_b128 v[28:31], v8 offset:0
    ds_read_b128 v[32:35], v8 offset:1024
    ds_read_b128 v[36:39], v8 offset:2048
    ds_read_b128 v[40:43], v8 offset:3072
    ds_read_b128 v[44:47], v8 offset:4096
    ds_read_b128 v[48:51], v8 offset:5120
    s_waitcnt lgkmcnt(4)
    v_mfma_f32_16x16x32_bf16 v[12:15], a[0:3], v[28:31], 0
    v_mfma_f32_16x16x32_bf16 v[16:19], a[0:3], v[32:35], 0
    v_mfma_f32_16x16x32_bf16 v[20:23], a[4:7], v[28:31], 0
    v_mfma_f32_16x16x32_bf16 v[24:27], a[4:7], v[32:35], 0
    ds_read_b128 v[28:31], v8 offset:6144
    ds_read_b128 v[32:35], v8 offset:7168
    s_waitcnt lgkmcnt(4)
    v_mfma_f32_16x16x32_bf16 v[12:15], a[8:11], v[36:39], v[12:15]
    v_mfma_f32_16x16x32_bf16 v[16:19], a[8:11], v[40:43], v[16:19]
    v_mfma_f32_16x16x32_bf16 v[20:23], a[12:15], v[36:39], v[20:23]
    v_mfma_f32_16x16x32_bf16 v[24:27], a[12:15], v[40:43], v[24:27]
    ds_read_b128 v[36:39], v8 offset:8192
    ds_read_b128 v[40:43], v8 offset:9216
    s_waitcnt lgkmcnt(4)
    v_mfma_f32_16x16x32_bf16 v[12:15], a[16:19], v[44:47], v[12:15]
    v_mfma_f32_16x16x32_bf16 v[16:19], a[16:19], v[48:51], v[16:19]
    v_mfma_f32_16x16x32_bf16 v[20:23], a[20:23], v[44:47], v[20:23]
    v_mfma_f32_16x16x32_bf16 v[24:27], a[20:23], v[48:51], v[24:27]
    ds_read_b128 v[44:47], v8 offset:10240
    ds_read_b128 v[48:51], v8 offset:11264
    s_waitcnt lgkmcnt(4)
    v_mfma_f32_16x16x32_bf16 v[12:15], a[24:27], v[28:31], v[12:15]
    v_mfma_f32_16x16x32_bf16 v[16:19], a[24:27], v[32:35], v[16:19]
    v_mfma_f32_16x16x32_bf16 v[20:23], a[28:31], v[28:31], v[20:23]
    v_mfma_f32_16x16x32_bf16 v[24:27], a[28:31], v[32:35], v[24:27]
    ds_read_b128 v[28:31], v8 offset:12288
    ds_read_b128 v[32:35], v8 offset:13312
    s_waitcnt lgkmcnt(4)
    v_mfma_f32_16x16x32_bf16 v[12:15], a[32:35], v[36:39], v[12:15]
    v_mfma_f32_16x16x32_bf16 v[16:19], a[32:35], v[40:43], v[16:19]
    v_mfma_f32_16x16x32_bf16 v[20:23], a[36:39], v[36:39], v[20:23]
    v_mfma_f32_16x16x32_bf16 v[24:27], a[36:39], v[40:43], v[24:27]
    ds_read_b128 v[36:39], v8 offset:14336
    ds_read_b128 v[40:43], v8 offset:15360
    s_waitcnt lgkmcnt(4)
    v_mfma_f32_16x16x32_bf16 v[12:15], a[40:43], v[44:47], v[12:15]
    v_mfma_f32_16x16x32_bf16 v[16:19], a[40:43], v[48:51], v[16:19]
    v_mfma_f32_16x16x32_bf16 v[20:23], a[44:47], v[44:47], v[20:23]
    v_mfma_f32_16x16x32_bf16 v[24:27], a[44:47], v[48:51], v[24:27]
    ds_read_b128 v[44:47], v8 offset:16384
    ds_read_b128 v[48:51], v8 offset:17408
    s_waitcnt vmcnt(0)
    v_cmp_ne_u32 vcc, 1, v11
    s_cmp_eq_u64 vcc, 0
    s_cselect_b32 s24, 1, 0
    s_cmp_ge_u32 s27, s40
    s_cselect_b32 s24, 0, s24
    v_mov_b32 v4, 81920
    s_cmp_lg_u32 s18, 0
    s_cbranch_scc1 L_dec_121
    v_mov_b32 v5, s24
    ds_write_b32 v4, v5
L_dec_121:
    s_waitcnt lgkmcnt(0)
    s_barrier
    ds_read_b32 v5, v4
    s_cmp_eq_u32 s37, 0
    s_cbranch_scc1 L_pend_122
    v_mov_b32 v6, 1
    s_cmp_lg_u32 s18, 0
    s_cbranch_scc1 L_sig_123
    s_mov_b64 exec, 1
    buffer_store_dword v6, off, s[4:7], s22 sc1
    s_mov_b64 exec, -1
L_sig_123:
    s_add_u32 s22, s22, 512
L_pend_122:
    s_waitcnt lgkmcnt(0)
    v_readfirstlane_b32 s24, v5
    s_cmp_eq_u32 s24, 0
    s_cbranch_scc1 L_nos_124
    s_lshl_b32 s38, s18, 10
    s_add_u32 s38, s38, s25
    s_lshl_b32 s39, s18, 10
    s_add_u32 s39, s39, s20
    s_add_u32 s20, s20, 40960
    s_add_u32 s21, s21, 8
L_nos_124:
    v_mfma_f32_16x16x32_bf16 v[12:15], a[48:51], v[28:31], v[12:15]
    v_mfma_f32_16x16x32_bf16 v[16:19], a[48:51], v[32:35], v[16:19]
    v_mfma_f32_16x16x32_bf16 v[20:23], a[52:55], v[28:31], v[20:23]
    v_mfma_f32_16x16x32_bf16 v[24:27], a[52:55], v[32:35], v[24:27]
    ds_read_b128 v[28:31], v8 offset:18432
    ds_read_b128 v[32:35], v8 offset:19456
    s_cmp_eq_u32 s24, 0
    s_cbranch_scc1 L_nod_125
    s_add_u32 m0, s38, 0
    s_nop 0
    buffer_load_dwordx4 v3, s[4:7], s39 offen sc1 lds
    s_add_u32 s39, s39, 4096
L_nod_125:
    v_mfma_f32_16x16x32_bf16 v[12:15], a[56:59], v[36:39], v[12:15]
    v_mfma_f32_16x16x32_bf16 v[16:19], a[56:59], v[40:43], v[16:19]
    v_mfma_f32_16x16x32_bf16 v[20:23], a[60:63], v[36:39], v[20:23]
    v_mfma_f32_16x16x32_bf16 v[24:27], a[60:63], v[40:43], v[24:27]
    ds_read_b128 v[36:39], v8 offset:20480
    ds_read_b128 v[40:43], v8 offset:21504
    s_cmp_eq_u32 s24, 0
    s_cbranch_scc1 L_nod_126
    s_add_u32 m0, s38, 4096
    s_nop 0
    buffer_load_dwordx4 v3, s[4:7], s39 offen sc1 lds
    s_add_u32 s39, s39, 4096
L_nod_126:
    v_mfma_f32_16x16x32_bf16 v[12:15], a[64:67], v[44:47], v[12:15]
    v_mfma_f32_16x16x32_bf16 v[16:19], a[64:67], v[48:51], v[16:19]
    v_mfma_f32_16x16x32_bf16 v[20:23], a[68:71], v[44:47], v[20:23]
    v_mfma_f32_16x16x32_bf16 v[24:27], a[68:71], v[48:51], v[24:27]
    ds_read_b128 v[44:47], v8 offset:22528
    ds_read_b128 v[48:51], v8 offset:23552
    s_cmp_eq_u32 s24, 0
    s_cbranch_scc1 L_nod_127
    s_add_u32 m0, s38, 8192
    s_nop 0
    buffer_load_dwordx4 v3, s[4:7], s39 offen sc1 lds
    s_add_u32 s39, s39, 4096
L_nod_127:
    s_waitcnt lgkmcnt(4)
    v_mfma_f32_16x16x32_bf16 v[12:15], a[72:75], v[28:31], v[12:15]
    v_mfma_f32_16x16x32_bf16 v[16:19], a[72:75], v[32:35], v[16:19]
    v_mfma_f32_16x16x32_bf16 v[20:23], a[76:79], v[28:31], v[20:23]
    v_mfma_f32_16x16x32_bf16 v[24:27], a[76:79], v[32:35], v[24:27]
    ds_read_b128 v[28:31], v8 offset:24576
    ds_read_b128 v[32:35], v8 offset:25600
    s_cmp_eq_u32 s24, 0
    s_cbranch_scc1 L_nod_128
    s_add_u32 m0, s38, 12288
    s_nop 0
    buffer_load_dwordx4 v3, s[4:7], s39 offen sc1 lds
    s_add_u32 s39, s39, 4096
L_nod_128:
    s_waitcnt lgkmcnt(4)
    v_mfma_f32_16x16x32_bf16 v[12:15], a[80:83], v[36:39], v[12:15]
    v_mfma_f32_16x16x32_bf16 v[16:19], a[80:83], v[40:43], v[16:19]
    v_mfma_f32_16x16x32_bf16 v[20:23], a[84:87], v[36:39], v[20:23]
    v_mfma_f32_16x16x32_bf16 v[24:27], a[84:87], v[40:43], v[24:27]
    ds_read_b128 v[36:39], v8 offset:26624
    ds_read_b128 v[40:43], v8 offset:27648
    s_cmp_eq_u32 s24, 0
    s_cbranch_scc1 L_nod_129
    s_add_u32 m0, s38, 16384
    s_nop 0
    buffer_load_dwordx4 v3, s[4:7], s39 offen sc1 lds
    s_add_u32 s39, s39, 4096
L_nod_129:
    s_waitcnt lgkmcnt(4)
    v_mfma_f32_16x16x32_bf16 v[12:15], a[88:91], v[44:47], v[12:15]
    v_mfma_f32_16x16x32_bf16 v[16:19], a[88:91], v[48:51], v[16:19]
    v_mfma_f32_16x16x32_bf16 v[20:23], a[92:95], v[44:47], v[20:23]
    v_mfma_f32_16x16x32_bf16 v[24:27], a[92:95], v[48:51], v[24:27]
    ds_read_b128 v[44:47], v8 offset:28672
    ds_read_b128 v[48:51], v8 offset:29696
    s_cmp_eq_u32 s24, 0
    s_cbranch_scc1 L_nod_130
    s_add_u32 m0, s38, 20480
    s_nop 0
    buffer_load_dwordx4 v3, s[4:7], s39 offen sc1 lds
    s_add_u32 s39, s39, 4096
L_nod_130:
    s_waitcnt lgkmcnt(4)
    v_mfma_f32_16x16x32_bf16 v[12:15], a[96:99], v[28:31], v[12:15]
    v_mfma_f32_16x16x32_bf16 v[16:19], a[96:99], v[32:35], v[16:19]
    v_mfma_f32_16x16x32_bf16 v[20:23], a[100:103], v[28:31], v[20:23]
    v_mfma_f32_16x16x32_bf16 v[24:27], a[100:103], v[32:35], v[24:27]
    ds_read_b128 v[28:31], v8 offset:30720
    ds_read_b128 v[32:35], v8 offset:31744
    s_cmp_eq_u32 s24, 0
    s_cbranch_scc1 L_nod_131
    s_add_u32 m0, s38, 24576
    s_nop 0
    buffer_load_dwordx4 v3, s[4:7], s39 offen sc1 lds
    s_add_u32 s39, s39, 4096
L_nod_131:
    s_waitcnt lgkmcnt(4)
    v_mfma_f32_16x16x32_bf16 v[12:15], a[104:107], v[36:39], v[12:15]
    v_mfma_f32_16x16x32_bf16 v[16:19], a[104:107], v[40:43], v[16:19]
    v_mfma_f32_16x16x32_bf16 v[20:23], a[108:111], v[36:39], v[20:23]
    v_mfma_f32_16x16x32_bf16 v[24:27], a[108:111], v[40:43], v[24:27]
    ds_read_b128 v[36:39], v8 offset:32768
    ds_read_b128 v[40:43], v8 offset:33792
    s_cmp_eq_u32 s24, 0
    s_cbranch_scc1 L_nod_132
    s_add_u32 m0, s38, 28672
    s_nop 0
    buffer_load_dwordx4 v3, s[4:7], s39 offen sc1 lds
    s_add_u32 s39, s39, 4096
L_nod_132:
    s_waitcnt lgkmcnt(4)
    v_mfma_f32_16x16x32_bf16 v[12:15], a[112:115], v[44:47], v[12:15]
    v_mfma_f32_16x16x32_bf16 v[16:19], a[112:115], v[48:51], v[16:19]
    v_mfma_f32_16x16x32_bf16 v[20:23], a[116:119], v[44:47], v[20:23]
    v_mfma_f32_16x16x32_bf16 v[24:27], a[116:119], v[48:51], v[24:27]
    ds_read_b128 v[44:47], v8 offset:34816
    ds_read_b128 v[48:51], v8 offset:35840
    s_cmp_eq_u32 s24, 0
    s_cbranch_scc1 L_nod_133
    s_add_u32 m0, s38, 32768
    s_nop 0
    buffer_load_dwordx4 v3, s[4:7], s39 offen sc1 lds
    s_add_u32 s39, s39, 4096
L_nod_133:
    s_waitcnt lgkmcnt(4)
    v_mfma_f32_16x16x32_bf16 v[12:15], a[120:123], v[28:31], v[12:15]
    v_mfma_f32_16x16x32_bf16 v[16:19], a[120:123], v[32:35], v[16:19]
    v_mfma_f32_16x16x32_bf16 v[20:23], a[124:127], v[28:31], v[20:23]
    v_mfma_f32_16x16x32_bf16 v[24:27], a[124:127], v[32:35], v[24:27]
    ds_read_b128 v[28:31], v8 offset:36864
    ds_read_b128 v[32:35], v8 offset:37888
    s_cmp_eq_u32 s24, 0
    s_cbranch_scc1 L_nod_134
    s_add_u32 m0, s38, 36864
    s_nop 0
    buffer_load_dwordx4 v3, s[4:7], s39 offen sc1 lds
    s_add_u32 s39, s39, 4096
L_nod_134:
    s_waitcnt lgkmcnt(4)
    v_mfma_f32_16x16x32_bf16 v[12:15], a[128:131], v[36:39], v[12:15]
    v_mfma_f32_16x16x32_bf16 v[16:19], a[128:131], v[40:43], v[16:19]
    v_mfma_f32_16x16x32_bf16 v[20:23], a[132:135], v[36:39], v[20:23]
    v_mfma_f32_16x16x32_bf16 v[24:27], a[132:135], v[40:43], v[24:27]
    ds_read_b128 v[36:39], v8 offset:38912
    ds_read_b128 v[40:43], v8 offset:39936
    s_waitcnt lgkmcnt(4)
    v_mfma_f32_16x16x32_bf16 v[12:15], a[136:139], v[44:47], v[12:15]
    v_mfma_f32_16x16x32_bf16 v[16:19], a[136:139], v[48:51], v[16:19]
    v_mfma_f32_16x16x32_bf16 v[20:23], a[140:143], v[44:47], v[20:23]
    v_mfma_f32_16x16x32_bf16 v[24:27], a[140:143], v[48:51], v[24:27]
    s_waitcnt lgkmcnt(2)
    v_mfma_f32_16x16x32_bf16 v[12:15], a[144:147], v[28:31], v[12:15]
    v_mfma_f32_16x16x32_bf16 v[16:19], a[144:147], v[32:35], v[16:19]
    v_mfma_f32_16x16x32_bf16 v[20:23], a[148:151], v[28:31], v[20:23]
    v_mfma_f32_16x16x32_bf16 v[24:27], a[148:151], v[32:35], v[24:27]
    s_waitcnt lgkmcnt(0)
    v_mfma_f32_16x16x32_bf16 v[12:15], a[152:155], v[36:39], v[12:15]
    v_mfma_f32_16x16x32_bf16 v[16:19], a[152:155], v[40:43], v[16:19]
    v_mfma_f32_16x16x32_bf16 v[20:23], a[156:159], v[36:39], v[20:23]
    v_mfma_f32_16x16x32_bf16 v[24:27], a[156:159], v[40:43], v[24:27]
    s_nop 4
    v_cvt_pk_bf16_f32 v68, v12, v13
    v_cvt_pk_bf16_f32 v69, v14, v15
    v_cvt_pk_bf16_f32 v70, v20, v21
    v_cvt_pk_bf16_f32 v71, v22, v23
    s_add_u32 s41, s23, 0
    buffer_store_dwordx4 v[68:71], v3, s[4:7], s41 offen sc1
    v_cvt_pk_bf16_f32 v72, v16, v17
    v_cvt_pk_bf16_f32 v73, v18, v19
    v_cvt_pk_bf16_f32 v74, v24, v25
    v_cvt_pk_bf16_f32 v75, v26, v27
    s_add_u32 s41, s23, 4096
    buffer_store_dwordx4 v[72:75], v3, s[4:7], s41 offen sc1
    s_add_u32 s23, s23, 262144
    buffer_load_dword v11, v10, s[4:7], s21 offen sc1
    s_mov_b32 s19, s27
    s_mov_b32 s37, 1
    s_cmp_eq_u32 s24, 1
    s_cbranch_scc1 L_gtop_115
    s_waitcnt vmcnt(0) lgkmcnt(0)
    s_barrier
    s_cmp_lg_u32 s18, 0
    s_cbranch_scc1 L_sig_135
    v_mov_b32 v5, 1
    s_mov_b64 exec, 1
    buffer_store_dword v5, off, s[4:7], s22 sc1
    s_mov_b64 exec, -1
L_sig_135:
    s_add_u32 s22, s22, 512
    s_cmp_lt_u32 s19, s40
    s_cbranch_scc1 L_gload_117
L_gend_116:
    s_branch L_att
L_att:
    s_lshl_b32 s28, s16, 2
    s_add_u32 s28, s28, s18
    s_mov_b32 s31, 0x3db504f3
    s_mov_b32 s32, 0x3fb8aa3b
    v_and_b32 v4, 7, v2
    v_lshl_add_u32 v4, v1, 3, v4
    v_lshlrev_b32 v168, 4, v4
    v_and_b32 v4, 31, v0
    v_lshlrev_b32 v169, 4, v4
    v_lshlrev_b32 v4, 2, v1
    v_sub_u32 v171, v2, v4
    s_nop 1
L_att_136:
    v_mov_b32 v5, 1
    s_mov_b64 exec, 1
    buffer_atomic_add v5, off, s[12:15], 0 offset:20 sc0 sc1
    s_mov_b64 exec, -1
    s_waitcnt vmcnt(0)
    v_readfirstlane_b32 s28, v5
    s_cmp_ge_u32 s28, 4096
    s_cbranch_scc1 L_end
    s_lshr_b32 s29, s28, 1
    s_and_b32 s30, s28, 1
    s_lshl_b32 s41, s30, 4
    v_add_u32 v170, s41, v171
    s_lshl_b32 s33, s29, 4
    s_add_u32 s34, s33, 0x518000
    v_min_u32 v4, 2, v0
    v_lshlrev_b32 v4, 2, v4
L_wf_137:
    buffer_load_dword v5, v4, s[4:7], s34 offen sc1
    s_waitcnt vmcnt(0)
    v_cmp_ne_u32 vcc, 1, v5
    s_cbranch_vccz L_wfd_138
    s_sleep 2
    s_add_u32 s46, s46, 1
    s_cmp_lt_u32 s46, 131072
    s_cbranch_scc1 L_wf_137
    s_branch L_end
L_wfd_138:
    s_lshl_b32 s33, s29, 13
    s_lshl_b32 s41, s30, 12
    s_add_u32 s34, s33, s41
    s_add_u32 s34, s34, 0x6300000
    buffer_load_dwordx4 v[108:111], v3, s[4:7], s34 offen offset:0 sc1
    buffer_load_dwordx4 v[112:115], v3, s[4:7], s34 offen offset:1024 sc1
    buffer_load_dwordx4 v[116:119], v3, s[4:7], s34 offen offset:2048 sc1
    buffer_load_dwordx4 v[120:123], v3, s[4:7], s34 offen offset:3072 sc1
    s_add_u32 s34, s33, 0x1100000
    buffer_load_dwordx4 v[12:15], v3, s[4:7], s34 offen offset:0 sc1
    s_add_u32 s34, s33, 0x1100000
    buffer_load_dwordx4 v[16:19], v3, s[4:7], s34 offen offset:1024 sc1
    s_add_u32 s34, s33, 0x1100000
    buffer_load_dwordx4 v[20:23], v3, s[4:7], s34 offen offset:2048 sc1
    s_add_u32 s34, s33, 0x1100000
    buffer_load_dwordx4 v[24:27], v3, s[4:7], s34 offen offset:3072 sc1
    s_add_u32 s34, s33, 0x1101000
    buffer_load_dwordx4 v[28:31], v3, s[4:7], s34 offen offset:0 sc1
    s_add_u32 s34, s33, 0x1101000
    buffer_load_dwordx4 v[32:35], v3, s[4:7], s34 offen offset:1024 sc1
    s_add_u32 s34, s33, 0x1101000
    buffer_load_dwordx4 v[36:39], v3, s[4:7], s34 offen offset:2048 sc1
    s_add_u32 s34, s33, 0x1101000
    buffer_load_dwordx4 v[40:43], v3, s[4:7], s34 offen offset:3072 sc1
    s_add_u32 s34, s33, 0x2100000
    buffer_load_dwordx4 v[44:47], v3, s[4:7], s34 offen offset:0 sc1
    s_add_u32 s34, s33, 0x2100000
    buffer_load_dwordx4 v[48:51], v3, s[4:7], s34 offen offset:1024 sc1
    s_add_u32 s34, s33, 0x2100000
    buffer_load_dwordx4 v[52:55], v3, s[4:7], s34 offen offset:2048 sc1
    s_add_u32 s34, s33, 0x2100000
    buffer_load_dwordx4 v[56:59], v3, s[4:7], s34 offen offset:3072 sc1
    s_add_u32 s34, s33, 0x2101000
    buffer_load_dwordx4 v[60:63], v3, s[4:7], s34 offen offset:0 sc1
    s_add_u32 s34, s33, 0x2101000
    buffer_load_dwordx4 v[64:67], v3, s[4:7], s34 offen offset:1024 sc1
    s_add_u32 s34, s33, 0x2101000
    buffer_load_dwordx4 v[68:71], v3, s[4:7], s34 offen offset:2048 sc1
    s_add_u32 s34, s33, 0x2101000
    buffer_load_dwordx4 v[72:75], v3, s[4:7], s34 offen offset:3072 sc1
    s_waitcnt vmcnt(15)
    v_mfma_f32_16x16x32_bf16 v[128:131], v[12:15], v[108:111], 0
    s_waitcnt vmcnt(14)
    v_mfma_f32_16x16x32_bf16 v[128:131], v[16:19], v[112:115], v[128:131]
    s_waitcnt vmcnt(13)
    v_mfma_f32_16x16x32_bf16 v[128:131], v[20:23], v[116:119], v[128:131]
    s_waitcnt vmcnt(12)
    v_mfma_f32_16x16x32_bf16 v[128:131], v[24:27], v[120:123], v[128:131]
    s_waitcnt vmcnt(11)
    v_mfma_f32_16x16x32_bf16 v[132:135], v[28:31], v[108:111], 0
    s_waitcnt vmcnt(10)
    v_mfma_f32_16x16x32_bf16 v[132:135], v[32:35], v[112:115], v[132:135]
    s_waitcnt vmcnt(9)
    v_mfma_f32_16x16x32_bf16 v[132:135], v[36:39], v[116:119], v[132:135]
    s_waitcnt vmcnt(8)
    v_mfma_f32_16x16x32_bf16 v[132:135], v[40:43], v[120:123], v[132:135]
    v_mov_b32 v6, 0xce6e6b28
    v_cvt_pk_bf16_f32 v4, v128, v129
    v_lshlrev_b32 v128, 16, v4
    v_and_b32 v129, 0xffff0000, v4
    v_mul_f32 v128, s31, v128
    v_mul_f32 v129, s31, v129
    v_cvt_pk_bf16_f32 v4, v128, v129
    v_lshlrev_b32 v128, 16, v4
    v_and_b32 v129, 0xffff0000, v4
    v_cvt_pk_bf16_f32 v4, v130, v131
    v_lshlrev_b32 v130, 16, v4
    v_and_b32 v131, 0xffff0000, v4
    v_mul_f32 v130, s31, v130
    v_mul_f32 v131, s31, v131
    v_cvt_pk_bf16_f32 v4, v130, v131
    v_lshlrev_b32 v130, 16, v4
    v_and_b32 v131, 0xffff0000, v4
    v_cmp_le_i32 vcc, 0, v170
    s_nop 1
    v_cndmask_b32 v128, v6, v128, vcc
    v_cmp_le_i32 vcc, 1, v170
    s_nop 1
    v_cndmask_b32 v129, v6, v129, vcc
    v_cmp_le_i32 vcc, 2, v170
    s_nop 1
    v_cndmask_b32 v130, v6, v130, vcc
    v_cmp_le_i32 vcc, 3, v170
    s_nop 1
    v_cndmask_b32 v131, v6, v131, vcc
    v_cvt_pk_bf16_f32 v4, v132, v133
    v_lshlrev_b32 v132, 16, v4
    v_and_b32 v133, 0xffff0000, v4
    v_mul_f32 v132, s31, v132
    v_mul_f32 v133, s31, v133
    v_cvt_pk_bf16_f32 v4, v132, v133
    v_lshlrev_b32 v132, 16, v4
    v_and_b32 v133, 0xffff0000, v4
    v_cvt_pk_bf16_f32 v4, v134, v135
    v_lshlrev_b32 v134, 16, v4
    v_and_b32 v135, 0xffff0000, v4
    v_mul_f32 v134, s31, v134
    v_mul_f32 v135, s31, v135
    v_cvt_pk_bf16_f32 v4, v134, v135
    v_lshlrev_b32 v134, 16, v4
    v_and_b32 v135, 0xffff0000, v4
    v_cmp_le_i32 vcc, 16, v170
    s_nop 1
    v_cndmask_b32 v132, v6, v132, vcc
    v_cmp_le_i32 vcc, 17, v170
    s_nop 1
    v_cndmask_b32 v133, v6, v133, vcc
    v_cmp_le_i32 vcc, 18, v170
    s_nop 1
    v_cndmask_b32 v134, v6, v134, vcc
    v_cmp_le_i32 vcc, 19, v170
    s_nop 1
    v_cndmask_b32 v135, v6, v135, vcc
    v_max3_f32 v7, v128, v129, v130
    v_max3_f32 v7, v7, v131, v132
    v_max3_f32 v7, v7, v133, v134
    v_max_f32 v7, v7, v135
    s_lshl_b32 s34, s29, 5
    s_add_u32 s34, s34, 0x504000
    v_min_u32 v4, 1, v0
    v_lshlrev_b32 v4, 2, v4
L_wf_139:
    buffer_load_dword v5, v4, s[4:7], s34 offen sc1
    s_waitcnt vmcnt(0)
    v_cmp_ne_u32 vcc, 1, v5
    s_cbranch_vccz L_wfd_140
    s_sleep 3
    s_add_u32 s46, s46, 1
    s_cmp_lt_u32 s46, 131072
    s_cbranch_scc1 L_wf_139
    s_branch L_end
L_wfd_140:
    s_lshl_b32 s33, s29, 11
    s_lshl_b32 s34, s29, 12
    s_add_u32 s34, s34, 0x7400000
    buffer_load_dwordx4 v[76:79], v3, s[4:7], s34 offen offset:0 sc1
    buffer_load_dwordx4 v[80:83], v3, s[4:7], s34 offen offset:1024 sc1
    buffer_load_dwordx4 v[84:87], v3, s[4:7], s34 offen offset:2048 sc1
    buffer_load_dwordx4 v[88:91], v3, s[4:7], s34 offen offset:3072 sc1
    s_sub_u32 s34, s34, 0x6b00000
    buffer_load_dwordx2 v[92:93], v169, s[4:7], s34 offen offset:0 sc1
    buffer_load_dwordx2 v[94:95], v169, s[4:7], s34 offen offset:512 sc1
    buffer_load_dwordx2 v[96:97], v169, s[4:7], s34 offen offset:1024 sc1
    buffer_load_dwordx2 v[98:99], v169, s[4:7], s34 offen offset:1536 sc1
    buffer_load_dwordx2 v[100:101], v169, s[4:7], s34 offen offset:2048 sc1
    buffer_load_dwordx2 v[102:103], v169, s[4:7], s34 offen offset:2560 sc1
    buffer_load_dwordx2 v[104:105], v169, s[4:7], s34 offen offset:3072 sc1
    buffer_load_dwordx2 v[106:107], v169, s[4:7], s34 offen offset:3584 sc1
    s_waitcnt vmcnt(11)
    v_mfma_f32_16x16x32_bf16 v[124:127], v[76:79], v[108:111], 0
    s_waitcnt vmcnt(10)
    v_mfma_f32_16x16x32_bf16 v[124:127], v[80:83], v[112:115], v[124:127]
    s_waitcnt vmcnt(9)
    v_mfma_f32_16x16x32_bf16 v[124:127], v[84:87], v[116:119], v[124:127]
    s_waitcnt vmcnt(8)
    v_mfma_f32_16x16x32_bf16 v[124:127], v[88:91], v[120:123], v[124:127]
    v_cmp_gt_u32 vcc, 2, v1
    s_nop 6
    v_cvt_pk_bf16_f32 v4, v124, v125
    v_lshlrev_b32 v124, 16, v4
    v_and_b32 v125, 0xffff0000, v4
    v_mul_f32 v124, s31, v124
    v_mul_f32 v125, s31, v125
    v_cvt_pk_bf16_f32 v4, v124, v125
    v_lshlrev_b32 v124, 16, v4
    v_and_b32 v125, 0xffff0000, v4
    v_cvt_pk_bf16_f32 v4, v126, v127
    v_lshlrev_b32 v126, 16, v4
    v_and_b32 v127, 0xffff0000, v4
    v_mul_f32 v126, s31, v126
    v_mul_f32 v127, s31, v127
    v_cvt_pk_bf16_f32 v4, v126, v127
    v_lshlrev_b32 v126, 16, v4
    v_and_b32 v127, 0xffff0000, v4
    v_cndmask_b32 v124, v6, v124, vcc
    v_cndmask_b32 v125, v6, v125, vcc
    v_cndmask_b32 v126, v6, v126, vcc
    v_cndmask_b32 v127, v6, v127, vcc
    v_max3_f32 v4, v7, v124, v125
    v_max3_f32 v4, v4, v126, v127
    v_mov_b32 v5, v4
    s_nop 1
    v_permlane16_swap_b32 v4, v5
    v_max_f32 v4, v4, v5
    v_mov_b32 v5, v4
    s_nop 1
    v_permlane32_swap_b32 v4, v5
    v_max_f32 v4, v4, v5
    v_sub_f32 v124, v124, v4
    v_sub_f32 v125, v125, v4
    v_sub_f32 v126, v126, v4
    v_sub_f32 v127, v127, v4
    v_sub_f32 v128, v128, v4
    v_sub_f32 v129, v129, v4
    v_sub_f32 v130, v130, v4
    v_sub_f32 v131, v131, v4
    v_sub_f32 v132, v132, v4
    v_sub_f32 v133, v133, v4
    v_sub_f32 v134, v134, v4
    v_sub_f32 v135, v135, v4
    v_mul_f32 v124, s32, v124
    v_mul_f32 v125, s32, v125
    v_mul_f32 v126, s32, v126
    v_mul_f32 v127, s32, v127
    v_mul_f32 v128, s32, v128
    v_mul_f32 v129, s32, v129
    v_mul_f32 v130, s32, v130
    v_mul_f32 v131, s32, v131
    v_mul_f32 v132, s32, v132
    v_mul_f32 v133, s32, v133
    v_mul_f32 v134, s32, v134
    v_mul_f32 v135, s32, v135
    v_exp_f32 v124, v124
    v_exp_f32 v125, v125
    v_exp_f32 v126, v126
    v_exp_f32 v127, v127
    v_exp_f32 v128, v128
    v_exp_f32 v129, v129
    v_exp_f32 v130, v130
    v_exp_f32 v131, v131
    v_exp_f32 v132, v132
    v_exp_f32 v133, v133
    v_exp_f32 v134, v134
    v_exp_f32 v135, v135
    v_add_f32 v4, v124, v125
    v_add_f32 v5, v126, v127
    v_add_f32 v4, v4, v128
    v_add_f32 v5, v5, v129
    v_add_f32 v4, v4, v130
    v_add_f32 v5, v5, v131
    v_add_f32 v4, v4, v132
    v_add_f32 v5, v5, v133
    v_add_f32 v4, v4, v134
    v_add_f32 v5, v5, v135
    v_add_f32 v4, v4, v5
    v_mov_b32 v5, v4
    s_nop 1
    v_permlane16_swap_b32 v4, v5
    v_add_f32 v4, v4, v5
    v_mov_b32 v5, v4
    s_nop 1
    v_permlane32_swap_b32 v4, v5
    v_add_f32 v4, v4, v5
    v_rcp_f32 v4, v4
    s_nop 0
    v_mul_f32 v124, v124, v4
    v_mul_f32 v125, v125, v4
    v_mul_f32 v126, v126, v4
    v_mul_f32 v127, v127, v4
    v_mul_f32 v128, v128, v4
    v_mul_f32 v129, v129, v4
    v_mul_f32 v130, v130, v4
    v_mul_f32 v131, v131, v4
    v_mul_f32 v132, v132, v4
    v_mul_f32 v133, v133, v4
    v_mul_f32 v134, v134, v4
    v_mul_f32 v135, v135, v4
    v_cvt_pk_bf16_f32 v172, v128, v129
    v_cvt_pk_bf16_f32 v173, v130, v131
    v_cvt_pk_bf16_f32 v174, v132, v133
    v_cvt_pk_bf16_f32 v175, v134, v135
    v_cvt_pk_bf16_f32 v176, v124, v125
    v_cvt_pk_bf16_f32 v177, v126, v127
    s_waitcnt vmcnt(0)
    v_mfma_f32_16x16x32_bf16 v[136:139], v[44:47], v[172:175], 0
    v_mfma_f32_16x16x32_bf16 v[140:143], v[48:51], v[172:175], 0
    v_mfma_f32_16x16x32_bf16 v[144:147], v[52:55], v[172:175], 0
    v_mfma_f32_16x16x32_bf16 v[148:151], v[56:59], v[172:175], 0
    v_mfma_f32_16x16x32_bf16 v[152:155], v[60:63], v[172:175], 0
    v_mfma_f32_16x16x32_bf16 v[156:159], v[64:67], v[172:175], 0
    v_mfma_f32_16x16x32_bf16 v[160:163], v[68:71], v[172:175], 0
    v_mfma_f32_16x16x32_bf16 v[164:167], v[72:75], v[172:175], 0
    v_mfma_f32_16x16x16_bf16 v[136:139], v[92:93], v[176:177], v[136:139]
    v_mfma_f32_16x16x16_bf16 v[140:143], v[94:95], v[176:177], v[140:143]
    v_mfma_f32_16x16x16_bf16 v[144:147], v[96:97], v[176:177], v[144:147]
    v_mfma_f32_16x16x16_bf16 v[148:151], v[98:99], v[176:177], v[148:151]
    v_mfma_f32_16x16x16_bf16 v[152:155], v[100:101], v[176:177], v[152:155]
    v_mfma_f32_16x16x16_bf16 v[156:159], v[102:103], v[176:177], v[156:159]
    v_mfma_f32_16x16x16_bf16 v[160:163], v[104:105], v[176:177], v[160:163]
    v_mfma_f32_16x16x16_bf16 v[164:167], v[106:107], v[176:177], v[164:167]
    s_lshl_b32 s33, s29, 13
    s_lshl_b32 s41, s30, 10
    s_add_u32 s33, s33, s41
    s_add_u32 s33, s33, 0x3100000
    v_cvt_pk_bf16_f32 v108, v136, v137
    v_cvt_pk_bf16_f32 v109, v138, v139
    v_cvt_pk_bf16_f32 v110, v140, v141
    v_cvt_pk_bf16_f32 v111, v142, v143
    s_add_u32 s34, s33, 0
    buffer_store_dwordx4 v[108:111], v3, s[4:7], s34 offen sc1
    v_cvt_pk_bf16_f32 v112, v144, v145
    v_cvt_pk_bf16_f32 v113, v146, v147
    v_cvt_pk_bf16_f32 v114, v148, v149
    v_cvt_pk_bf16_f32 v115, v150, v151
    s_add_u32 s34, s33, 2048
    buffer_store_dwordx4 v[112:115], v3, s[4:7], s34 offen sc1
    v_cvt_pk_bf16_f32 v116, v152, v153
    v_cvt_pk_bf16_f32 v117, v154, v155
    v_cvt_pk_bf16_f32 v118, v156, v157
    v_cvt_pk_bf16_f32 v119, v158, v159
    s_add_u32 s34, s33, 4096
    buffer_store_dwordx4 v[116:119], v3, s[4:7], s34 offen sc1
    v_cvt_pk_bf16_f32 v120, v160, v161
    v_cvt_pk_bf16_f32 v121, v162, v163
    v_cvt_pk_bf16_f32 v122, v164, v165
    v_cvt_pk_bf16_f32 v123, v166, v167
    s_add_u32 s34, s33, 6144
    buffer_store_dwordx4 v[120:123], v3, s[4:7], s34 offen sc1
    s_waitcnt vmcnt(0)
    s_lshl_b32 s34, s28, 2
    s_add_u32 s34, s34, 0x520000
    v_mov_b32 v5, 1
    s_mov_b64 exec, 1
    buffer_store_dword v5, off, s[4:7], s34 sc1
    s_mov_b64 exec, -1
    s_branch L_att_136
    s_branch L_end
L_kv:
    s_mov_b32 s16, s99
    s_sub_u32 s17, s98, 2
    s_cmp_eq_u32 s98, 3
    s_cbranch_scc1 L_vp
    s_mov_b32 s41, 8192
    v_lshrrev_b32 v4, 2, v0
    v_mul_lo_u32 v4, v4, s41
    v_and_b32 v5, 3, v0
    v_lshl_add_u32 v8, v5, 4, v4
    v_lshrrev_b32 v4, 1, v0
    v_mul_lo_u32 v4, v4, s41
    v_and_b32 v5, 1, v0
    v_lshl_add_u32 v9, v5, 4, v4
    v_lshrrev_b32 v4, 2, v0
    v_and_b32 v5, 3, v0
    v_lshlrev_b32 v5, 3, v5
    v_lshl_add_u32 v10, v4, 6, v5
    v_add_u32 v10, s47, v10
    v_lshl_add_u32 v11, v4, 5, v5
    v_add_u32 v11, s47, v11
    s_load_dwordx2 s[44:45], s[0:1], 24
    s_waitcnt lgkmcnt(0)
    s_mov_b32 s8, s44
    s_mov_b32 s9, s45
    s_mov_b32 s10, 0x500000
    s_mov_b32 s11, 0x20000
    s_lshl_b32 s20, s16, 8
    s_mov_b32 s41, 8192
    v_or_b32 v4, 0, v1
    v_lshlrev_b32 v4, 1, v4
    v_xor_b32 v4, v4, v2
    v_mul_lo_u32 v5, v1, s41
    v_lshl_add_u32 v8, v4, 4, v5
    v_or_b32 v4, 4, v1
    v_lshlrev_b32 v4, 1, v4
    v_xor_b32 v4, v4, v2
    v_mul_lo_u32 v5, v1, s41
    v_lshl_add_u32 v9, v4, 4, v5
    v_bfe_u32 v4, v0, 2, 3
    v_lshlrev_b32 v4, 1, v4
    v_bfe_u32 v5, v0, 1, 1
    s_lshl_b32 s41, s18, 2
    v_or_b32 v5, s41, v5
    v_xor_b32 v4, v4, v5
    v_lshlrev_b32 v4, 4, v4
    v_lshrrev_b32 v5, 2, v0
    v_lshl_add_u32 v4, v5, 8, v4
    v_and_b32 v5, 1, v0
    v_lshl_add_u32 v6, v5, 3, v4
    s_mul_i32 s41, s18, 131072
    s_add_u32 s20, s20, s41
    s_lshl_b32 s42, s18, 12
    s_waitcnt lgkmcnt(0)
    s_barrier
    s_add_u32 m0, s42, 0
    s_nop 0
    buffer_load_dwordx4 v8, s[8:11], s20 offen lds
    s_add_u32 s20, s20, 32768
    s_add_u32 m0, s42, 1024
    s_nop 0
    buffer_load_dwordx4 v9, s[8:11], s20 offen lds
    s_add_u32 s20, s20, 32768
    s_add_u32 m0, s42, 2048
    s_nop 0
    buffer_load_dwordx4 v8, s[8:11], s20 offen lds
    s_add_u32 s20, s20, 32768
    s_add_u32 m0, s42, 3072
    s_nop 0
    buffer_load_dwordx4 v9, s[8:11], s20 offen lds
    s_add_u32 s20, s20, 425984
    s_add_u32 m0, s42, 16384
    s_nop 0
    buffer_load_dwordx4 v8, s[8:11], s20 offen lds
    s_add_u32 s20, s20, 32768
    s_add_u32 m0, s42, 17408
    s_nop 0
    buffer_load_dwordx4 v9, s[8:11], s20 offen lds
    s_add_u32 s20, s20, 32768
    s_add_u32 m0, s42, 18432
    s_nop 0
    buffer_load_dwordx4 v8, s[8:11], s20 offen lds
    s_add_u32 s20, s20, 32768
    s_add_u32 m0, s42, 19456
    s_nop 0
    buffer_load_dwordx4 v9, s[8:11], s20 offen lds
    s_add_u32 s20, s20, 425984
    s_add_u32 m0, s42, 32768
    s_nop 0
    buffer_load_dwordx4 v8, s[8:11], s20 offen lds
    s_add_u32 s20, s20, 32768
    s_add_u32 m0, s42, 33792
    s_nop 0
    buffer_load_dwordx4 v9, s[8:11], s20 offen lds
    s_add_u32 s20, s20, 32768
    s_add_u32 m0, s42, 34816
    s_nop 0
    buffer_load_dwordx4 v8, s[8:11], s20 offen lds
    s_add_u32 s20, s20, 32768
    s_add_u32 m0, s42, 35840
    s_nop 0
    buffer_load_dwordx4 v9, s[8:11], s20 offen lds
    s_add_u32 s20, s20, 425984
    s_add_u32 m0, s42, 49152
    s_nop 0
    buffer_load_dwordx4 v8, s[8:11], s20 offen lds
    s_add_u32 s20, s20, 32768
    s_add_u32 m0, s42, 50176
    s_nop 0
    buffer_load_dwordx4 v9, s[8:11], s20 offen lds
    s_add_u32 s20, s20, 32768
    s_add_u32 m0, s42, 51200
    s_nop 0
    buffer_load_dwordx4 v8, s[8:11], s20 offen lds
    s_add_u32 s20, s20, 32768
    s_add_u32 m0, s42, 52224
    s_nop 0
    buffer_load_dwordx4 v9, s[8:11], s20 offen lds
    s_add_u32 s20, s20, 425984
    s_add_u32 m0, s42, 65536
    s_nop 0
    buffer_load_dwordx4 v8, s[8:11], s20 offen lds
    s_add_u32 s20, s20, 32768
    s_add_u32 m0, s42, 66560
    s_nop 0
    buffer_load_dwordx4 v9, s[8:11], s20 offen lds
    s_add_u32 s20, s20, 32768
    s_add_u32 m0, s42, 67584
    s_nop 0
    buffer_load_dwordx4 v8, s[8:11], s20 offen lds
    s_add_u32 s20, s20, 32768
    s_add_u32 m0, s42, 68608
    s_nop 0
    buffer_load_dwordx4 v9, s[8:11], s20 offen lds
    s_add_u32 s20, s20, 425984
    s_add_u32 m0, s42, 81920
    s_nop 0
    buffer_load_dwordx4 v8, s[8:11], s20 offen lds
    s_add_u32 s20, s20, 32768
    s_add_u32 m0, s42, 82944
    s_nop 0
    buffer_load_dwordx4 v9, s[8:11], s20 offen lds
    s_add_u32 s20, s20, 32768
    s_add_u32 m0, s42, 83968
    s_nop 0
    buffer_load_dwordx4 v8, s[8:11], s20 offen lds
    s_add_u32 s20, s20, 32768
    s_add_u32 m0, s42, 84992
    s_nop 0
    buffer_load_dwordx4 v9, s[8:11], s20 offen lds
    s_add_u32 s20, s20, 425984
    s_add_u32 m0, s42, 98304
    s_nop 0
    buffer_load_dwordx4 v8, s[8:11], s20 offen lds
    s_add_u32 s20, s20, 32768
    s_add_u32 m0, s42, 99328
    s_nop 0
    buffer_load_dwordx4 v9, s[8:11], s20 offen lds
    s_add_u32 s20, s20, 32768
    s_add_u32 m0, s42, 100352
    s_nop 0
    buffer_load_dwordx4 v8, s[8:11], s20 offen lds
    s_add_u32 s20, s20, 32768
    s_add_u32 m0, s42, 101376
    s_nop 0
    buffer_load_dwordx4 v9, s[8:11], s20 offen lds
    s_add_u32 s20, s20, 425984
    s_add_u32 m0, s42, 114688
    s_nop 0
    buffer_load_dwordx4 v8, s[8:11], s20 offen lds
    s_add_u32 s20, s20, 32768
    s_add_u32 m0, s42, 115712
    s_nop 0
    buffer_load_dwordx4 v9, s[8:11], s20 offen lds
    s_add_u32 s20, s20, 32768
    s_add_u32 m0, s42, 116736
    s_nop 0
    buffer_load_dwordx4 v8, s[8:11], s20 offen lds
    s_add_u32 s20, s20, 32768
    s_add_u32 m0, s42, 117760
    s_nop 0
    buffer_load_dwordx4 v9, s[8:11], s20 offen lds
    s_add_u32 s20, s20, 425984
    s_add_u32 m0, s42, 131072
    s_nop 0
    buffer_load_dwordx4 v8, s[8:11], s20 offen lds
    s_add_u32 s20, s20, 32768
    s_add_u32 m0, s42, 132096
    s_nop 0
    buffer_load_dwordx4 v9, s[8:11], s20 offen lds
    s_add_u32 s20, s20, 32768
    s_add_u32 m0, s42, 133120
    s_nop 0
    buffer_load_dwordx4 v8, s[8:11], s20 offen lds
    s_add_u32 s20, s20, 32768
    s_add_u32 m0, s42, 134144
    s_nop 0
    buffer_load_dwordx4 v9, s[8:11], s20 offen lds
    s_add_u32 s20, s20, 425984
    s_add_u32 m0, s42, 147456
    s_nop 0
    buffer_load_dwordx4 v8, s[8:11], s20 offen lds
    s_add_u32 s20, s20, 32768
    s_add_u32 m0, s42, 148480
    s_nop 0
    buffer_load_dwordx4 v9, s[8:11], s20 offen lds
    s_add_u32 s20, s20, 32768
    s_add_u32 m0, s42, 149504
    s_nop 0
    buffer_load_dwordx4 v8, s[8:11], s20 offen lds
    s_add_u32 s20, s20, 32768
    s_add_u32 m0, s42, 150528
    s_nop 0
    buffer_load_dwordx4 v9, s[8:11], s20 offen lds
    s_add_u32 s20, s20, 425984
    v_add_u32 v10, 0, v6
    v_xor_b32 v11, 32, v10
    s_waitcnt vmcnt(36)
    s_barrier
    ds_read_b64_tr_b16 a[0:1], v10 offset:0
    ds_read_b64_tr_b16 a[2:3], v10 offset:4096
    ds_read_b64_tr_b16 a[4:5], v11 offset:0
    ds_read_b64_tr_b16 a[6:7], v11 offset:4096
    ds_read_b64_tr_b16 a[8:9], v10 offset:8192
    ds_read_b64_tr_b16 a[10:11], v10 offset:12288
    ds_read_b64_tr_b16 a[12:13], v11 offset:8192
    ds_read_b64_tr_b16 a[14:15], v11 offset:12288
    s_waitcnt vmcnt(32)
    s_barrier
    ds_read_b64_tr_b16 a[16:17], v10 offset:16384
    ds_read_b64_tr_b16 a[18:19], v10 offset:20480
    ds_read_b64_tr_b16 a[20:21], v11 offset:16384
    ds_read_b64_tr_b16 a[22:23], v11 offset:20480
    ds_read_b64_tr_b16 a[24:25], v10 offset:24576
    ds_read_b64_tr_b16 a[26:27], v10 offset:28672
    ds_read_b64_tr_b16 a[28:29], v11 offset:24576
    ds_read_b64_tr_b16 a[30:31], v11 offset:28672
    s_waitcnt vmcnt(28)
    s_barrier
    ds_read_b64_tr_b16 a[32:33], v10 offset:32768
    ds_read_b64_tr_b16 a[34:35], v10 offset:36864
    ds_read_b64_tr_b16 a[36:37], v11 offset:32768
    ds_read_b64_tr_b16 a[38:39], v11 offset:36864
    ds_read_b64_tr_b16 a[40:41], v10 offset:40960
    ds_read_b64_tr_b16 a[42:43], v10 offset:45056
    ds_read_b64_tr_b16 a[44:45], v11 offset:40960
    ds_read_b64_tr_b16 a[46:47], v11 offset:45056
    s_waitcnt vmcnt(24)
    s_barrier
    ds_read_b64_tr_b16 a[48:49], v10 offset:49152
    ds_read_b64_tr_b16 a[50:51], v10 offset:53248
    ds_read_b64_tr_b16 a[52:53], v11 offset:49152
    ds_read_b64_tr_b16 a[54:55], v11 offset:53248
    ds_read_b64_tr_b16 a[56:57], v10 offset:57344
    ds_read_b64_tr_b16 a[58:59], v10 offset:61440
    ds_read_b64_tr_b16 a[60:61], v11 offset:57344
    ds_read_b64_tr_b16 a[62:63], v11 offset:61440
    v_add_u32 v10, 65536, v6
    v_xor_b32 v11, 32, v10
    s_waitcnt vmcnt(20)
    s_barrier
    ds_read_b64_tr_b16 a[64:65], v10 offset:0
    ds_read_b64_tr_b16 a[66:67], v10 offset:4096
    ds_read_b64_tr_b16 a[68:69], v11 offset:0
    ds_read_b64_tr_b16 a[70:71], v11 offset:4096
    ds_read_b64_tr_b16 a[72:73], v10 offset:8192
    ds_read_b64_tr_b16 a[74:75], v10 offset:12288
    ds_read_b64_tr_b16 a[76:77], v11 offset:8192
    ds_read_b64_tr_b16 a[78:79], v11 offset:12288
    s_waitcnt vmcnt(16)
    s_barrier
    ds_read_b64_tr_b16 a[80:81], v10 offset:16384
    ds_read_b64_tr_b16 a[82:83], v10 offset:20480
    ds_read_b64_tr_b16 a[84:85], v11 offset:16384
    ds_read_b64_tr_b16 a[86:87], v11 offset:20480
    ds_read_b64_tr_b16 a[88:89], v10 offset:24576
    ds_read_b64_tr_b16 a[90:91], v10 offset:28672
    ds_read_b64_tr_b16 a[92:93], v11 offset:24576
    ds_read_b64_tr_b16 a[94:95], v11 offset:28672
    s_waitcnt vmcnt(12)
    s_barrier
    ds_read_b64_tr_b16 a[96:97], v10 offset:32768
    ds_read_b64_tr_b16 a[98:99], v10 offset:36864
    ds_read_b64_tr_b16 a[100:101], v11 offset:32768
    ds_read_b64_tr_b16 a[102:103], v11 offset:36864
    ds_read_b64_tr_b16 a[104:105], v10 offset:40960
    ds_read_b64_tr_b16 a[106:107], v10 offset:45056
    ds_read_b64_tr_b16 a[108:109], v11 offset:40960
    ds_read_b64_tr_b16 a[110:111], v11 offset:45056
    s_waitcnt vmcnt(8)
    s_barrier
    ds_read_b64_tr_b16 a[112:113], v10 offset:49152
    ds_read_b64_tr_b16 a[114:115], v10 offset:53248
    ds_read_b64_tr_b16 a[116:117], v11 offset:49152
    ds_read_b64_tr_b16 a[118:119], v11 offset:53248
    ds_read_b64_tr_b16 a[120:121], v10 offset:57344
    ds_read_b64_tr_b16 a[122:123], v10 offset:61440
    ds_read_b64_tr_b16 a[124:125], v11 offset:57344
    ds_read_b64_tr_b16 a[126:127], v11 offset:61440
    v_add_u32 v10, 131072, v6
    v_xor_b32 v11, 32, v10
    s_waitcnt vmcnt(4)
    s_barrier
    ds_read_b64_tr_b16 a[128:129], v10 offset:0
    ds_read_b64_tr_b16 a[130:131], v10 offset:4096
    ds_read_b64_tr_b16 a[132:133], v11 offset:0
    ds_read_b64_tr_b16 a[134:135], v11 offset:4096
    ds_read_b64_tr_b16 a[136:137], v10 offset:8192
    ds_read_b64_tr_b16 a[138:139], v10 offset:12288
    ds_read_b64_tr_b16 a[140:141], v11 offset:8192
    ds_read_b64_tr_b16 a[142:143], v11 offset:12288
    s_waitcnt vmcnt(0)
    s_barrier
    ds_read_b64_tr_b16 a[144:145], v10 offset:16384
    ds_read_b64_tr_b16 a[146:147], v10 offset:20480
    ds_read_b64_tr_b16 a[148:149], v11 offset:16384
    ds_read_b64_tr_b16 a[150:151], v11 offset:20480
    ds_read_b64_tr_b16 a[152:153], v10 offset:24576
    ds_read_b64_tr_b16 a[154:155], v10 offset:28672
    ds_read_b64_tr_b16 a[156:157], v11 offset:24576
    ds_read_b64_tr_b16 a[158:159], v11 offset:28672
    s_waitcnt lgkmcnt(0)
    s_barrier
    s_add_u32 s23, s16, 0
    s_cmp_lg_u32 s18, 0
    s_cbranch_scc1 L_cal_141
    v_mov_b32 v4, -1
    s_mov_b64 exec, 1
    s_waitcnt vmcnt(0)
    s_mov_b32 s60, -1
    s_mov_b32 s61, -1
    s_lshl_b32 s41, s23, 15
    s_add_u32 s41, s41, 0x201800
    s_memtime s[56:57]
    s_waitcnt lgkmcnt(0)
    buffer_store_dword v4, off, s[4:7], s41 sc1
    s_waitcnt vmcnt(0)
    s_memtime s[58:59]
    s_waitcnt lgkmcnt(0)
    s_sub_u32 s58, s58, s56
    s_min_u32 s60, s60, s58
    s_lshl_b32 s41, s23, 15
    s_add_u32 s41, s41, 0x203800
    s_memtime s[56:57]
    s_waitcnt lgkmcnt(0)
    buffer_store_dword v4, off, s[4:7], s41 sc1
    s_waitcnt vmcnt(0)
    s_memtime s[58:59]
    s_waitcnt lgkmcnt(0)
    s_sub_u32 s58, s58, s56
    s_min_u32 s61, s61, s58
    s_lshl_b32 s41, s23, 15
    s_add_u32 s41, s41, 0x201800
    s_memtime s[56:57]
    s_waitcnt lgkmcnt(0)
    buffer_store_dword v4, off, s[4:7], s41 sc1
    s_waitcnt vmcnt(0)
    s_memtime s[58:59]
    s_waitcnt lgkmcnt(0)
    s_sub_u32 s58, s58, s56
    s_min_u32 s60, s60, s58
    s_lshl_b32 s41, s23, 15
    s_add_u32 s41, s41, 0x203800
    s_memtime s[56:57]
    s_waitcnt lgkmcnt(0)
    buffer_store_dword v4, off, s[4:7], s41 sc1
    s_waitcnt vmcnt(0)
    s_memtime s[58:59]
    s_waitcnt lgkmcnt(0)
    s_sub_u32 s58, s58, s56
    s_min_u32 s61, s61, s58
    s_lshl_b32 s41, s23, 15
    s_add_u32 s41, s41, 0x201800
    s_memtime s[56:57]
    s_waitcnt lgkmcnt(0)
    buffer_store_dword v4, off, s[4:7], s41 sc1
    s_waitcnt vmcnt(0)
    s_memtime s[58:59]
    s_waitcnt lgkmcnt(0)
    s_sub_u32 s58, s58, s56
    s_min_u32 s60, s60, s58
    s_lshl_b32 s41, s23, 15
    s_add_u32 s41, s41, 0x203800
    s_memtime s[56:57]
    s_waitcnt lgkmcnt(0)
    buffer_store_dword v4, off, s[4:7], s41 sc1
    s_waitcnt vmcnt(0)
    s_memtime s[58:59]
    s_waitcnt lgkmcnt(0)
    s_sub_u32 s58, s58, s56
    s_min_u32 s61, s61, s58
    s_cmp_lt_u32 s61, s60
    s_cselect_b32 s62, 1, 0
    s_mov_b32 s60, -1
    s_mov_b32 s61, -1
    s_lshl_b32 s41, s23, 15
    s_add_u32 s41, s41, 0x205800
    s_memtime s[56:57]
    s_waitcnt lgkmcnt(0)
    buffer_store_dword v4, off, s[4:7], s41 sc1
    s_waitcnt vmcnt(0)
    s_memtime s[58:59]
    s_waitcnt lgkmcnt(0)
    s_sub_u32 s58, s58, s56
    s_min_u32 s60, s60, s58
    s_lshl_b32 s41, s23, 15
    s_add_u32 s41, s41, 0x207800
    s_memtime s[56:57]
    s_waitcnt lgkmcnt(0)
    buffer_store_dword v4, off, s[4:7], s41 sc1
    s_waitcnt vmcnt(0)
    s_memtime s[58:59]
    s_waitcnt lgkmcnt(0)
    s_sub_u32 s58, s58, s56
    s_min_u32 s61, s61, s58
    s_lshl_b32 s41, s23, 15
    s_add_u32 s41, s41, 0x205800
    s_memtime s[56:57]
    s_waitcnt lgkmcnt(0)
    buffer_store_dword v4, off, s[4:7], s41 sc1
    s_waitcnt vmcnt(0)
    s_memtime s[58:59]
    s_waitcnt lgkmcnt(0)
    s_sub_u32 s58, s58, s56
    s_min_u32 s60, s60, s58
    s_lshl_b32 s41, s23, 15
    s_add_u32 s41, s41, 0x207800
    s_memtime s[56:57]
    s_waitcnt lgkmcnt(0)
    buffer_store_dword v4, off, s[4:7], s41 sc1
    s_waitcnt vmcnt(0)
    s_memtime s[58:59]
    s_waitcnt lgkmcnt(0)
    s_sub_u32 s58, s58, s56
    s_min_u32 s61, s61, s58
    s_lshl_b32 s41, s23, 15
    s_add_u32 s41, s41, 0x205800
    s_memtime s[56:57]
    s_waitcnt lgkmcnt(0)
    buffer_store_dword v4, off, s[4:7], s41 sc1
    s_waitcnt vmcnt(0)
    s_memtime s[58:59]
    s_waitcnt lgkmcnt(0)
    s_sub_u32 s58, s58, s56
    s_min_u32 s60, s60, s58
    s_lshl_b32 s41, s23, 15
    s_add_u32 s41, s41, 0x207800
    s_memtime s[56:57]
    s_waitcnt lgkmcnt(0)
    buffer_store_dword v4, off, s[4:7], s41 sc1
    s_waitcnt vmcnt(0)
    s_memtime s[58:59]
    s_waitcnt lgkmcnt(0)
    s_sub_u32 s58, s58, s56
    s_min_u32 s61, s61, s58
    s_cmp_lt_u32 s61, s60
    s_cselect_b32 s63, 1, 0
    s_and_b32 s41, s23, 31
    s_lshl_b32 s62, s62, s41
    v_mov_b32 v5, s62
    s_lshr_b32 s41, s23, 5
    s_lshl_b32 s41, s41, 2
    buffer_atomic_or v5, off, s[12:15], s41 offset:144 sc1
    s_and_b32 s41, s23, 31
    s_lshl_b32 s63, s63, s41
    v_mov_b32 v5, s63
    s_lshr_b32 s41, s23, 5
    s_lshl_b32 s41, s41, 2
    buffer_atomic_or v5, off, s[12:15], s41 offset:152 sc1
    s_waitcnt vmcnt(0)
    v_mov_b32 v5, 1
    buffer_atomic_add v5, off, s[12:15], 0 offset:160 sc1
    s_mov_b64 exec, -1
L_cal_141:
    s_cmp_lg_u32 s18, 0
    s_cbranch_scc1 L_wi_142
    s_mov_b32 s41, 16
    v_min_u32 v4, 0, v0
    v_lshlrev_b32 v4, 2, v4
L_wf_143:
    buffer_load_dword v5, v4, s[12:15], s41 offen sc1
    s_waitcnt vmcnt(0)
    v_cmp_gt_u32 vcc, 128, v5
    s_cbranch_vccz L_wfd_144
    s_sleep 6
    s_add_u32 s46, s46, 1
    s_cmp_lt_u32 s46, 131072
    s_cbranch_scc1 L_wf_143
    s_branch L_end
L_wfd_144:
L_wi_142:
    s_barrier
    s_mov_b32 s19, 0
    s_mov_b32 s40, 64
    s_mov_b32 s20, 0x600000
    s_mov_b32 s21, 0x500000
    s_lshl_b32 s22, s16, 4
    s_add_u32 s22, s22, 0x518000
    s_lshl_b32 s26, s16, 12
    s_lshl_b32 s41, s18, 10
    s_add_u32 s26, s26, s41
    s_add_u32 s26, s26, 0x7400000
    s_lshl_b32 s23, s16, 13
    s_lshl_b32 s41, s18, 10
    s_add_u32 s23, s23, s41
    s_add_u32 s23, s23, 0x1100000
    v_min_u32 v10, 1, v0
    v_lshlrev_b32 v10, 2, v10
    s_mov_b32 s25, 0
    s_mul_i32 s41, s19, 40960
    s_add_u32 s20, s20, s41
    s_mul_i32 s41, s19, 8
    s_add_u32 s21, s21, s41
    s_mul_i32 s41, s19, 512
    s_add_u32 s22, s22, s41
L_gload_147:
    v_min_u32 v4, 1, v0
    v_lshlrev_b32 v4, 2, v4
L_wf_149:
    buffer_load_dword v5, v4, s[4:7], s21 offen sc1
    s_waitcnt vmcnt(0)
    v_cmp_ne_u32 vcc, 1, v5
    s_cbranch_vccz L_wfd_150
    s_sleep 1
    s_add_u32 s46, s46, 1
    s_cmp_lt_u32 s46, 131072
    s_cbranch_scc1 L_wf_149
    s_branch L_end
L_wfd_150:
    s_lshl_b32 s38, s18, 10
    s_add_u32 s38, s38, s25
    s_lshl_b32 s39, s18, 10
    s_add_u32 s39, s39, s20
    s_add_u32 s20, s20, 40960
    s_add_u32 s21, s21, 8
    s_add_u32 m0, s38, 0
    s_nop 0
    buffer_load_dwordx4 v3, s[4:7], s39 offen sc1 lds
    s_add_u32 s39, s39, 4096
    s_add_u32 m0, s38, 4096
    s_nop 0
    buffer_load_dwordx4 v3, s[4:7], s39 offen sc1 lds
    s_add_u32 s39, s39, 4096
    s_add_u32 m0, s38, 8192
    s_nop 0
    buffer_load_dwordx4 v3, s[4:7], s39 offen sc1 lds
    s_add_u32 s39, s39, 4096
    s_add_u32 m0, s38, 12288
    s_nop 0
    buffer_load_dwordx4 v3, s[4:7], s39 offen sc1 lds
    s_add_u32 s39, s39, 4096
    s_add_u32 m0, s38, 16384
    s_nop 0
    buffer_load_dwordx4 v3, s[4:7], s39 offen sc1 lds
    s_add_u32 s39, s39, 4096
    s_add_u32 m0, s38, 20480
    s_nop 0
    buffer_load_dwordx4 v3, s[4:7], s39 offen sc1 lds
    s_add_u32 s39, s39, 4096
    s_add_u32 m0, s38, 24576
    s_nop 0
    buffer_load_dwordx4 v3, s[4:7], s39 offen sc1 lds
    s_add_u32 s39, s39, 4096
    s_add_u32 m0, s38, 28672
    s_nop 0
    buffer_load_dwordx4 v3, s[4:7], s39 offen sc1 lds
    s_add_u32 s39, s39, 4096
    s_add_u32 m0, s38, 32768
    s_nop 0
    buffer_load_dwordx4 v3, s[4:7], s39 offen sc1 lds
    s_add_u32 s39, s39, 4096
    s_add_u32 m0, s38, 36864
    s_nop 0
    buffer_load_dwordx4 v3, s[4:7], s39 offen sc1 lds
    s_add_u32 s39, s39, 4096
    buffer_load_dword v11, v10, s[4:7], s21 offen sc1
    s_mov_b32 s37, 0
    s_waitcnt vmcnt(0) lgkmcnt(0)
    s_branch L_ggo_148
L_gtop_145:
    s_waitcnt vmcnt(4)
L_ggo_148:
    s_barrier
    v_add_u32 v8, s25, v3
    s_add_u32 s27, s19, 1
    s_sub_u32 s25, 40960, s25
    ds_read_b128 v[28:31], v8 offset:0
    ds_read_b128 v[32:35], v8 offset:1024
    ds_read_b128 v[36:39], v8 offset:2048
    ds_read_b128 v[40:43], v8 offset:3072
    ds_read_b128 v[44:47], v8 offset:4096
    ds_read_b128 v[48:51], v8 offset:5120
    s_waitcnt lgkmcnt(4)
    v_mfma_f32_16x16x32_bf16 v[12:15], a[0:3], v[28:31], 0
    v_mfma_f32_16x16x32_bf16 v[16:19], a[0:3], v[32:35], 0
    v_mfma_f32_16x16x32_bf16 v[20:23], a[4:7], v[28:31], 0
    v_mfma_f32_16x16x32_bf16 v[24:27], a[4:7], v[32:35], 0
    ds_read_b128 v[28:31], v8 offset:6144
    ds_read_b128 v[32:35], v8 offset:7168
    s_waitcnt lgkmcnt(4)
    v_mfma_f32_16x16x32_bf16 v[12:15], a[8:11], v[36:39], v[12:15]
    v_mfma_f32_16x16x32_bf16 v[16:19], a[8:11], v[40:43], v[16:19]
    v_mfma_f32_16x16x32_bf16 v[20:23], a[12:15], v[36:39], v[20:23]
    v_mfma_f32_16x16x32_bf16 v[24:27], a[12:15], v[40:43], v[24:27]
    ds_read_b128 v[36:39], v8 offset:8192
    ds_read_b128 v[40:43], v8 offset:9216
    s_waitcnt lgkmcnt(4)
    v_mfma_f32_16x16x32_bf16 v[12:15], a[16:19], v[44:47], v[12:15]
    v_mfma_f32_16x16x32_bf16 v[16:19], a[16:19], v[48:51], v[16:19]
    v_mfma_f32_16x16x32_bf16 v[20:23], a[20:23], v[44:47], v[20:23]
    v_mfma_f32_16x16x32_bf16 v[24:27], a[20:23], v[48:51], v[24:27]
    ds_read_b128 v[44:47], v8 offset:10240
    ds_read_b128 v[48:51], v8 offset:11264
    s_waitcnt lgkmcnt(4)
    v_mfma_f32_16x16x32_bf16 v[12:15], a[24:27], v[28:31], v[12:15]
    v_mfma_f32_16x16x32_bf16 v[16:19], a[24:27], v[32:35], v[16:19]
    v_mfma_f32_16x16x32_bf16 v[20:23], a[28:31], v[28:31], v[20:23]
    v_mfma_f32_16x16x32_bf16 v[24:27], a[28:31], v[32:35], v[24:27]
    ds_read_b128 v[28:31], v8 offset:12288
    ds_read_b128 v[32:35], v8 offset:13312
    s_waitcnt lgkmcnt(4)
    v_mfma_f32_16x16x32_bf16 v[12:15], a[32:35], v[36:39], v[12:15]
    v_mfma_f32_16x16x32_bf16 v[16:19], a[32:35], v[40:43], v[16:19]
    v_mfma_f32_16x16x32_bf16 v[20:23], a[36:39], v[36:39], v[20:23]
    v_mfma_f32_16x16x32_bf16 v[24:27], a[36:39], v[40:43], v[24:27]
    ds_read_b128 v[36:39], v8 offset:14336
    ds_read_b128 v[40:43], v8 offset:15360
    s_waitcnt lgkmcnt(4)
    v_mfma_f32_16x16x32_bf16 v[12:15], a[40:43], v[44:47], v[12:15]
    v_mfma_f32_16x16x32_bf16 v[16:19], a[40:43], v[48:51], v[16:19]
    v_mfma_f32_16x16x32_bf16 v[20:23], a[44:47], v[44:47], v[20:23]
    v_mfma_f32_16x16x32_bf16 v[24:27], a[44:47], v[48:51], v[24:27]
    ds_read_b128 v[44:47], v8 offset:16384
    ds_read_b128 v[48:51], v8 offset:17408
    s_waitcnt vmcnt(0)
    v_cmp_ne_u32 vcc, 1, v11
    s_cmp_eq_u64 vcc, 0
    s_cselect_b32 s24, 1, 0
    s_cmp_ge_u32 s27, s40
    s_cselect_b32 s24, 0, s24
    v_mov_b32 v4, 81920
    s_cmp_lg_u32 s18, 0
    s_cbranch_scc1 L_dec_151
    v_mov_b32 v5, s24
    ds_write_b32 v4, v5
L_dec_151:
    s_waitcnt lgkmcnt(0)
    s_barrier
    ds_read_b32 v5, v4
    s_cmp_eq_u32 s37, 0
    s_cbranch_scc1 L_pend_152
    v_mov_b32 v6, 1
    s_cmp_lg_u32 s18, 0
    s_cbranch_scc1 L_sig_153
    s_mov_b64 exec, 1
    buffer_store_dword v6, off, s[4:7], s22 sc1
    s_mov_b64 exec, -1
L_sig_153:
    s_add_u32 s22, s22, 512
L_pend_152:
    s_waitcnt lgkmcnt(0)
    v_readfirstlane_b32 s24, v5
    s_cmp_eq_u32 s24, 0
    s_cbranch_scc1 L_nos_154
    s_lshl_b32 s38, s18, 10
    s_add_u32 s38, s38, s25
    s_lshl_b32 s39, s18, 10
    s_add_u32 s39, s39, s20
    s_add_u32 s20, s20, 40960
    s_add_u32 s21, s21, 8
L_nos_154:
    v_mfma_f32_16x16x32_bf16 v[12:15], a[48:51], v[28:31], v[12:15]
    v_mfma_f32_16x16x32_bf16 v[16:19], a[48:51], v[32:35], v[16:19]
    v_mfma_f32_16x16x32_bf16 v[20:23], a[52:55], v[28:31], v[20:23]
    v_mfma_f32_16x16x32_bf16 v[24:27], a[52:55], v[32:35], v[24:27]
    ds_read_b128 v[28:31], v8 offset:18432
    ds_read_b128 v[32:35], v8 offset:19456
    s_cmp_eq_u32 s24, 0
    s_cbranch_scc1 L_nod_155
    s_add_u32 m0, s38, 0
    s_nop 0
    buffer_load_dwordx4 v3, s[4:7], s39 offen sc1 lds
    s_add_u32 s39, s39, 4096
L_nod_155:
    v_mfma_f32_16x16x32_bf16 v[12:15], a[56:59], v[36:39], v[12:15]
    v_mfma_f32_16x16x32_bf16 v[16:19], a[56:59], v[40:43], v[16:19]
    v_mfma_f32_16x16x32_bf16 v[20:23], a[60:63], v[36:39], v[20:23]
    v_mfma_f32_16x16x32_bf16 v[24:27], a[60:63], v[40:43], v[24:27]
    ds_read_b128 v[36:39], v8 offset:20480
    ds_read_b128 v[40:43], v8 offset:21504
    s_cmp_eq_u32 s24, 0
    s_cbranch_scc1 L_nod_156
    s_add_u32 m0, s38, 4096
    s_nop 0
    buffer_load_dwordx4 v3, s[4:7], s39 offen sc1 lds
    s_add_u32 s39, s39, 4096
L_nod_156:
    v_mfma_f32_16x16x32_bf16 v[12:15], a[64:67], v[44:47], v[12:15]
    v_mfma_f32_16x16x32_bf16 v[16:19], a[64:67], v[48:51], v[16:19]
    v_mfma_f32_16x16x32_bf16 v[20:23], a[68:71], v[44:47], v[20:23]
    v_mfma_f32_16x16x32_bf16 v[24:27], a[68:71], v[48:51], v[24:27]
    ds_read_b128 v[44:47], v8 offset:22528
    ds_read_b128 v[48:51], v8 offset:23552
    s_cmp_eq_u32 s24, 0
    s_cbranch_scc1 L_nod_157
    s_add_u32 m0, s38, 8192
    s_nop 0
    buffer_load_dwordx4 v3, s[4:7], s39 offen sc1 lds
    s_add_u32 s39, s39, 4096
L_nod_157:
    s_waitcnt lgkmcnt(4)
    v_mfma_f32_16x16x32_bf16 v[12:15], a[72:75], v[28:31], v[12:15]
    v_mfma_f32_16x16x32_bf16 v[16:19], a[72:75], v[32:35], v[16:19]
    v_mfma_f32_16x16x32_bf16 v[20:23], a[76:79], v[28:31], v[20:23]
    v_mfma_f32_16x16x32_bf16 v[24:27], a[76:79], v[32:35], v[24:27]
    ds_read_b128 v[28:31], v8 offset:24576
    ds_read_b128 v[32:35], v8 offset:25600
    s_cmp_eq_u32 s24, 0
    s_cbranch_scc1 L_nod_158
    s_add_u32 m0, s38, 12288
    s_nop 0
    buffer_load_dwordx4 v3, s[4:7], s39 offen sc1 lds
    s_add_u32 s39, s39, 4096
L_nod_158:
    s_waitcnt lgkmcnt(4)
    v_mfma_f32_16x16x32_bf16 v[12:15], a[80:83], v[36:39], v[12:15]
    v_mfma_f32_16x16x32_bf16 v[16:19], a[80:83], v[40:43], v[16:19]
    v_mfma_f32_16x16x32_bf16 v[20:23], a[84:87], v[36:39], v[20:23]
    v_mfma_f32_16x16x32_bf16 v[24:27], a[84:87], v[40:43], v[24:27]
    ds_read_b128 v[36:39], v8 offset:26624
    ds_read_b128 v[40:43], v8 offset:27648
    s_cmp_eq_u32 s24, 0
    s_cbranch_scc1 L_nod_159
    s_add_u32 m0, s38, 16384
    s_nop 0
    buffer_load_dwordx4 v3, s[4:7], s39 offen sc1 lds
    s_add_u32 s39, s39, 4096
L_nod_159:
    s_waitcnt lgkmcnt(4)
    v_mfma_f32_16x16x32_bf16 v[12:15], a[88:91], v[44:47], v[12:15]
    v_mfma_f32_16x16x32_bf16 v[16:19], a[88:91], v[48:51], v[16:19]
    v_mfma_f32_16x16x32_bf16 v[20:23], a[92:95], v[44:47], v[20:23]
    v_mfma_f32_16x16x32_bf16 v[24:27], a[92:95], v[48:51], v[24:27]
    ds_read_b128 v[44:47], v8 offset:28672
    ds_read_b128 v[48:51], v8 offset:29696
    s_cmp_eq_u32 s24, 0
    s_cbranch_scc1 L_nod_160
    s_add_u32 m0, s38, 20480
    s_nop 0
    buffer_load_dwordx4 v3, s[4:7], s39 offen sc1 lds
    s_add_u32 s39, s39, 4096
L_nod_160:
    s_waitcnt lgkmcnt(4)
    v_mfma_f32_16x16x32_bf16 v[12:15], a[96:99], v[28:31], v[12:15]
    v_mfma_f32_16x16x32_bf16 v[16:19], a[96:99], v[32:35], v[16:19]
    v_mfma_f32_16x16x32_bf16 v[20:23], a[100:103], v[28:31], v[20:23]
    v_mfma_f32_16x16x32_bf16 v[24:27], a[100:103], v[32:35], v[24:27]
    ds_read_b128 v[28:31], v8 offset:30720
    ds_read_b128 v[32:35], v8 offset:31744
    s_cmp_eq_u32 s24, 0
    s_cbranch_scc1 L_nod_161
    s_add_u32 m0, s38, 24576
    s_nop 0
    buffer_load_dwordx4 v3, s[4:7], s39 offen sc1 lds
    s_add_u32 s39, s39, 4096
L_nod_161:
    s_waitcnt lgkmcnt(4)
    v_mfma_f32_16x16x32_bf16 v[12:15], a[104:107], v[36:39], v[12:15]
    v_mfma_f32_16x16x32_bf16 v[16:19], a[104:107], v[40:43], v[16:19]
    v_mfma_f32_16x16x32_bf16 v[20:23], a[108:111], v[36:39], v[20:23]
    v_mfma_f32_16x16x32_bf16 v[24:27], a[108:111], v[40:43], v[24:27]
    ds_read_b128 v[36:39], v8 offset:32768
    ds_read_b128 v[40:43], v8 offset:33792
    s_cmp_eq_u32 s24, 0
    s_cbranch_scc1 L_nod_162
    s_add_u32 m0, s38, 28672
    s_nop 0
    buffer_load_dwordx4 v3, s[4:7], s39 offen sc1 lds
    s_add_u32 s39, s39, 4096
L_nod_162:
    s_waitcnt lgkmcnt(4)
    v_mfma_f32_16x16x32_bf16 v[12:15], a[112:115], v[44:47], v[12:15]
    v_mfma_f32_16x16x32_bf16 v[16:19], a[112:115], v[48:51], v[16:19]
    v_mfma_f32_16x16x32_bf16 v[20:23], a[116:119], v[44:47], v[20:23]
    v_mfma_f32_16x16x32_bf16 v[24:27], a[116:119], v[48:51], v[24:27]
    ds_read_b128 v[44:47], v8 offset:34816
    ds_read_b128 v[48:51], v8 offset:35840
    s_cmp_eq_u32 s24, 0
    s_cbranch_scc1 L_nod_163
    s_add_u32 m0, s38, 32768
    s_nop 0
    buffer_load_dwordx4 v3, s[4:7], s39 offen sc1 lds
    s_add_u32 s39, s39, 4096
L_nod_163:
    s_waitcnt lgkmcnt(4)
    v_mfma_f32_16x16x32_bf16 v[12:15], a[120:123], v[28:31], v[12:15]
    v_mfma_f32_16x16x32_bf16 v[16:19], a[120:123], v[32:35], v[16:19]
    v_mfma_f32_16x16x32_bf16 v[20:23], a[124:127], v[28:31], v[20:23]
    v_mfma_f32_16x16x32_bf16 v[24:27], a[124:127], v[32:35], v[24:27]
    ds_read_b128 v[28:31], v8 offset:36864
    ds_read_b128 v[32:35], v8 offset:37888
    s_cmp_eq_u32 s24, 0
    s_cbranch_scc1 L_nod_164
    s_add_u32 m0, s38, 36864
    s_nop 0
    buffer_load_dwordx4 v3, s[4:7], s39 offen sc1 lds
    s_add_u32 s39, s39, 4096
L_nod_164:
    s_waitcnt lgkmcnt(4)
    v_mfma_f32_16x16x32_bf16 v[12:15], a[128:131], v[36:39], v[12:15]
    v_mfma_f32_16x16x32_bf16 v[16:19], a[128:131], v[40:43], v[16:19]
    v_mfma_f32_16x16x32_bf16 v[20:23], a[132:135], v[36:39], v[20:23]
    v_mfma_f32_16x16x32_bf16 v[24:27], a[132:135], v[40:43], v[24:27]
    ds_read_b128 v[36:39], v8 offset:38912
    ds_read_b128 v[40:43], v8 offset:39936
    s_waitcnt lgkmcnt(4)
    v_mfma_f32_16x16x32_bf16 v[12:15], a[136:139], v[44:47], v[12:15]
    v_mfma_f32_16x16x32_bf16 v[16:19], a[136:139], v[48:51], v[16:19]
    v_mfma_f32_16x16x32_bf16 v[20:23], a[140:143], v[44:47], v[20:23]
    v_mfma_f32_16x16x32_bf16 v[24:27], a[140:143], v[48:51], v[24:27]
    s_waitcnt lgkmcnt(2)
    v_mfma_f32_16x16x32_bf16 v[12:15], a[144:147], v[28:31], v[12:15]
    v_mfma_f32_16x16x32_bf16 v[16:19], a[144:147], v[32:35], v[16:19]
    v_mfma_f32_16x16x32_bf16 v[20:23], a[148:151], v[28:31], v[20:23]
    v_mfma_f32_16x16x32_bf16 v[24:27], a[148:151], v[32:35], v[24:27]
    s_waitcnt lgkmcnt(0)
    v_mfma_f32_16x16x32_bf16 v[12:15], a[152:155], v[36:39], v[12:15]
    v_mfma_f32_16x16x32_bf16 v[16:19], a[152:155], v[40:43], v[16:19]
    v_mfma_f32_16x16x32_bf16 v[20:23], a[156:159], v[36:39], v[20:23]
    v_mfma_f32_16x16x32_bf16 v[24:27], a[156:159], v[40:43], v[24:27]
    s_nop 4
    v_cvt_pk_bf16_f32 v68, v12, v13
    v_cvt_pk_bf16_f32 v69, v14, v15
    v_cvt_pk_bf16_f32 v70, v20, v21
    v_cvt_pk_bf16_f32 v71, v22, v23
    s_add_u32 s41, s23, 0
    buffer_store_dwordx4 v[68:71], v3, s[4:7], s41 offen sc1
    v_cvt_pk_bf16_f32 v72, v16, v17
    v_cvt_pk_bf16_f32 v73, v18, v19
    v_cvt_pk_bf16_f32 v74, v24, v25
    v_cvt_pk_bf16_f32 v75, v26, v27
    s_add_u32 s41, s23, 4096
    buffer_store_dwordx4 v[72:75], v3, s[4:7], s41 offen sc1
    s_add_u32 s23, s23, 262144
    buffer_store_dwordx4 v[68:71], v3, s[4:7], s26 offen sc1
    s_add_u32 s26, s26, 131072
    buffer_load_dword v11, v10, s[4:7], s21 offen sc1
    s_mov_b32 s19, s27
    s_mov_b32 s37, 1
    s_cmp_eq_u32 s24, 1
    s_cbranch_scc1 L_gtop_145
    s_waitcnt vmcnt(0) lgkmcnt(0)
    s_barrier
    s_cmp_lg_u32 s18, 0
    s_cbranch_scc1 L_sig_165
    v_mov_b32 v5, 1
    s_mov_b64 exec, 1
    buffer_store_dword v5, off, s[4:7], s22 sc1
    s_mov_b64 exec, -1
L_sig_165:
    s_add_u32 s22, s22, 512
    s_cmp_lt_u32 s19, s40
    s_cbranch_scc1 L_gload_147
L_gend_146:
    s_branch L_kvd
L_vp:
    s_mov_b32 s41, 8192
    v_lshrrev_b32 v4, 2, v0
    v_mul_lo_u32 v4, v4, s41
    v_and_b32 v5, 3, v0
    v_lshl_add_u32 v8, v5, 4, v4
    v_lshrrev_b32 v4, 1, v0
    v_mul_lo_u32 v4, v4, s41
    v_and_b32 v5, 1, v0
    v_lshl_add_u32 v9, v5, 4, v4
    v_lshrrev_b32 v4, 2, v0
    v_and_b32 v5, 3, v0
    v_lshlrev_b32 v5, 3, v5
    v_lshl_add_u32 v10, v4, 6, v5
    v_add_u32 v10, s47, v10
    v_lshl_add_u32 v11, v4, 5, v5
    v_add_u32 v11, s47, v11
    s_load_dwordx2 s[44:45], s[0:1], 32
    s_waitcnt lgkmcnt(0)
    s_mov_b32 s8, s44
    s_mov_b32 s9, s45
    s_mov_b32 s10, 0x500000
    s_mov_b32 s11, 0x20000
    s_lshl_b32 s20, s16, 8
    s_mov_b32 s41, 8192
    v_or_b32 v4, 0, v1
    v_lshlrev_b32 v4, 1, v4
    v_xor_b32 v4, v4, v2
    v_mul_lo_u32 v5, v1, s41
    v_lshl_add_u32 v8, v4, 4, v5
    v_or_b32 v4, 4, v1
    v_lshlrev_b32 v4, 1, v4
    v_xor_b32 v4, v4, v2
    v_mul_lo_u32 v5, v1, s41
    v_lshl_add_u32 v9, v4, 4, v5
    v_bfe_u32 v4, v0, 2, 3
    v_lshlrev_b32 v4, 1, v4
    v_bfe_u32 v5, v0, 1, 1
    s_lshl_b32 s41, s18, 2
    v_or_b32 v5, s41, v5
    v_xor_b32 v4, v4, v5
    v_lshlrev_b32 v4, 4, v4
    v_lshrrev_b32 v5, 2, v0
    v_lshl_add_u32 v4, v5, 8, v4
    v_and_b32 v5, 1, v0
    v_lshl_add_u32 v6, v5, 3, v4
    s_mul_i32 s41, s18, 131072
    s_add_u32 s20, s20, s41
    s_lshl_b32 s42, s18, 12
    s_waitcnt lgkmcnt(0)
    s_barrier
    s_add_u32 m0, s42, 0
    s_nop 0
    buffer_load_dwordx4 v8, s[8:11], s20 offen lds
    s_add_u32 s20, s20, 32768
    s_add_u32 m0, s42, 1024
    s_nop 0
    buffer_load_dwordx4 v9, s[8:11], s20 offen lds
    s_add_u32 s20, s20, 32768
    s_add_u32 m0, s42, 2048
    s_nop 0
    buffer_load_dwordx4 v8, s[8:11], s20 offen lds
    s_add_u32 s20, s20, 32768
    s_add_u32 m0, s42, 3072
    s_nop 0
    buffer_load_dwordx4 v9, s[8:11], s20 offen lds
    s_add_u32 s20, s20, 425984
    s_add_u32 m0, s42, 16384
    s_nop 0
    buffer_load_dwordx4 v8, s[8:11], s20 offen lds
    s_add_u32 s20, s20, 32768
    s_add_u32 m0, s42, 17408
    s_nop 0
    buffer_load_dwordx4 v9, s[8:11], s20 offen lds
    s_add_u32 s20, s20, 32768
    s_add_u32 m0, s42, 18432
    s_nop 0
    buffer_load_dwordx4 v8, s[8:11], s20 offen lds
    s_add_u32 s20, s20, 32768
    s_add_u32 m0, s42, 19456
    s_nop 0
    buffer_load_dwordx4 v9, s[8:11], s20 offen lds
    s_add_u32 s20, s20, 425984
    s_add_u32 m0, s42, 32768
    s_nop 0
    buffer_load_dwordx4 v8, s[8:11], s20 offen lds
    s_add_u32 s20, s20, 32768
    s_add_u32 m0, s42, 33792
    s_nop 0
    buffer_load_dwordx4 v9, s[8:11], s20 offen lds
    s_add_u32 s20, s20, 32768
    s_add_u32 m0, s42, 34816
    s_nop 0
    buffer_load_dwordx4 v8, s[8:11], s20 offen lds
    s_add_u32 s20, s20, 32768
    s_add_u32 m0, s42, 35840
    s_nop 0
    buffer_load_dwordx4 v9, s[8:11], s20 offen lds
    s_add_u32 s20, s20, 425984
    s_add_u32 m0, s42, 49152
    s_nop 0
    buffer_load_dwordx4 v8, s[8:11], s20 offen lds
    s_add_u32 s20, s20, 32768
    s_add_u32 m0, s42, 50176
    s_nop 0
    buffer_load_dwordx4 v9, s[8:11], s20 offen lds
    s_add_u32 s20, s20, 32768
    s_add_u32 m0, s42, 51200
    s_nop 0
    buffer_load_dwordx4 v8, s[8:11], s20 offen lds
    s_add_u32 s20, s20, 32768
    s_add_u32 m0, s42, 52224
    s_nop 0
    buffer_load_dwordx4 v9, s[8:11], s20 offen lds
    s_add_u32 s20, s20, 425984
    s_add_u32 m0, s42, 65536
    s_nop 0
    buffer_load_dwordx4 v8, s[8:11], s20 offen lds
    s_add_u32 s20, s20, 32768
    s_add_u32 m0, s42, 66560
    s_nop 0
    buffer_load_dwordx4 v9, s[8:11], s20 offen lds
    s_add_u32 s20, s20, 32768
    s_add_u32 m0, s42, 67584
    s_nop 0
    buffer_load_dwordx4 v8, s[8:11], s20 offen lds
    s_add_u32 s20, s20, 32768
    s_add_u32 m0, s42, 68608
    s_nop 0
    buffer_load_dwordx4 v9, s[8:11], s20 offen lds
    s_add_u32 s20, s20, 425984
    s_add_u32 m0, s42, 81920
    s_nop 0
    buffer_load_dwordx4 v8, s[8:11], s20 offen lds
    s_add_u32 s20, s20, 32768
    s_add_u32 m0, s42, 82944
    s_nop 0
    buffer_load_dwordx4 v9, s[8:11], s20 offen lds
    s_add_u32 s20, s20, 32768
    s_add_u32 m0, s42, 83968
    s_nop 0
    buffer_load_dwordx4 v8, s[8:11], s20 offen lds
    s_add_u32 s20, s20, 32768
    s_add_u32 m0, s42, 84992
    s_nop 0
    buffer_load_dwordx4 v9, s[8:11], s20 offen lds
    s_add_u32 s20, s20, 425984
    s_add_u32 m0, s42, 98304
    s_nop 0
    buffer_load_dwordx4 v8, s[8:11], s20 offen lds
    s_add_u32 s20, s20, 32768
    s_add_u32 m0, s42, 99328
    s_nop 0
    buffer_load_dwordx4 v9, s[8:11], s20 offen lds
    s_add_u32 s20, s20, 32768
    s_add_u32 m0, s42, 100352
    s_nop 0
    buffer_load_dwordx4 v8, s[8:11], s20 offen lds
    s_add_u32 s20, s20, 32768
    s_add_u32 m0, s42, 101376
    s_nop 0
    buffer_load_dwordx4 v9, s[8:11], s20 offen lds
    s_add_u32 s20, s20, 425984
    s_add_u32 m0, s42, 114688
    s_nop 0
    buffer_load_dwordx4 v8, s[8:11], s20 offen lds
    s_add_u32 s20, s20, 32768
    s_add_u32 m0, s42, 115712
    s_nop 0
    buffer_load_dwordx4 v9, s[8:11], s20 offen lds
    s_add_u32 s20, s20, 32768
    s_add_u32 m0, s42, 116736
    s_nop 0
    buffer_load_dwordx4 v8, s[8:11], s20 offen lds
    s_add_u32 s20, s20, 32768
    s_add_u32 m0, s42, 117760
    s_nop 0
    buffer_load_dwordx4 v9, s[8:11], s20 offen lds
    s_add_u32 s20, s20, 425984
    s_add_u32 m0, s42, 131072
    s_nop 0
    buffer_load_dwordx4 v8, s[8:11], s20 offen lds
    s_add_u32 s20, s20, 32768
    s_add_u32 m0, s42, 132096
    s_nop 0
    buffer_load_dwordx4 v9, s[8:11], s20 offen lds
    s_add_u32 s20, s20, 32768
    s_add_u32 m0, s42, 133120
    s_nop 0
    buffer_load_dwordx4 v8, s[8:11], s20 offen lds
    s_add_u32 s20, s20, 32768
    s_add_u32 m0, s42, 134144
    s_nop 0
    buffer_load_dwordx4 v9, s[8:11], s20 offen lds
    s_add_u32 s20, s20, 425984
    s_add_u32 m0, s42, 147456
    s_nop 0
    buffer_load_dwordx4 v8, s[8:11], s20 offen lds
    s_add_u32 s20, s20, 32768
    s_add_u32 m0, s42, 148480
    s_nop 0
    buffer_load_dwordx4 v9, s[8:11], s20 offen lds
    s_add_u32 s20, s20, 32768
    s_add_u32 m0, s42, 149504
    s_nop 0
    buffer_load_dwordx4 v8, s[8:11], s20 offen lds
    s_add_u32 s20, s20, 32768
    s_add_u32 m0, s42, 150528
    s_nop 0
    buffer_load_dwordx4 v9, s[8:11], s20 offen lds
    s_add_u32 s20, s20, 425984
    v_add_u32 v10, 0, v6
    v_xor_b32 v11, 32, v10
    s_waitcnt vmcnt(36)
    s_barrier
    ds_read_b64_tr_b16 a[0:1], v10 offset:0
    ds_read_b64_tr_b16 a[2:3], v10 offset:4096
    ds_read_b64_tr_b16 a[4:5], v11 offset:0
    ds_read_b64_tr_b16 a[6:7], v11 offset:4096
    ds_read_b64_tr_b16 a[8:9], v10 offset:8192
    ds_read_b64_tr_b16 a[10:11], v10 offset:12288
    ds_read_b64_tr_b16 a[12:13], v11 offset:8192
    ds_read_b64_tr_b16 a[14:15], v11 offset:12288
    s_waitcnt vmcnt(32)
    s_barrier
    ds_read_b64_tr_b16 a[16:17], v10 offset:16384
    ds_read_b64_tr_b16 a[18:19], v10 offset:20480
    ds_read_b64_tr_b16 a[20:21], v11 offset:16384
    ds_read_b64_tr_b16 a[22:23], v11 offset:20480
    ds_read_b64_tr_b16 a[24:25], v10 offset:24576
    ds_read_b64_tr_b16 a[26:27], v10 offset:28672
    ds_read_b64_tr_b16 a[28:29], v11 offset:24576
    ds_read_b64_tr_b16 a[30:31], v11 offset:28672
    s_waitcnt vmcnt(28)
    s_barrier
    ds_read_b64_tr_b16 a[32:33], v10 offset:32768
    ds_read_b64_tr_b16 a[34:35], v10 offset:36864
    ds_read_b64_tr_b16 a[36:37], v11 offset:32768
    ds_read_b64_tr_b16 a[38:39], v11 offset:36864
    ds_read_b64_tr_b16 a[40:41], v10 offset:40960
    ds_read_b64_tr_b16 a[42:43], v10 offset:45056
    ds_read_b64_tr_b16 a[44:45], v11 offset:40960
    ds_read_b64_tr_b16 a[46:47], v11 offset:45056
    s_waitcnt vmcnt(24)
    s_barrier
    ds_read_b64_tr_b16 a[48:49], v10 offset:49152
    ds_read_b64_tr_b16 a[50:51], v10 offset:53248
    ds_read_b64_tr_b16 a[52:53], v11 offset:49152
    ds_read_b64_tr_b16 a[54:55], v11 offset:53248
    ds_read_b64_tr_b16 a[56:57], v10 offset:57344
    ds_read_b64_tr_b16 a[58:59], v10 offset:61440
    ds_read_b64_tr_b16 a[60:61], v11 offset:57344
    ds_read_b64_tr_b16 a[62:63], v11 offset:61440
    v_add_u32 v10, 65536, v6
    v_xor_b32 v11, 32, v10
    s_waitcnt vmcnt(20)
    s_barrier
    ds_read_b64_tr_b16 a[64:65], v10 offset:0
    ds_read_b64_tr_b16 a[66:67], v10 offset:4096
    ds_read_b64_tr_b16 a[68:69], v11 offset:0
    ds_read_b64_tr_b16 a[70:71], v11 offset:4096
    ds_read_b64_tr_b16 a[72:73], v10 offset:8192
    ds_read_b64_tr_b16 a[74:75], v10 offset:12288
    ds_read_b64_tr_b16 a[76:77], v11 offset:8192
    ds_read_b64_tr_b16 a[78:79], v11 offset:12288
    s_waitcnt vmcnt(16)
    s_barrier
    ds_read_b64_tr_b16 a[80:81], v10 offset:16384
    ds_read_b64_tr_b16 a[82:83], v10 offset:20480
    ds_read_b64_tr_b16 a[84:85], v11 offset:16384
    ds_read_b64_tr_b16 a[86:87], v11 offset:20480
    ds_read_b64_tr_b16 a[88:89], v10 offset:24576
    ds_read_b64_tr_b16 a[90:91], v10 offset:28672
    ds_read_b64_tr_b16 a[92:93], v11 offset:24576
    ds_read_b64_tr_b16 a[94:95], v11 offset:28672
    s_waitcnt vmcnt(12)
    s_barrier
    ds_read_b64_tr_b16 a[96:97], v10 offset:32768
    ds_read_b64_tr_b16 a[98:99], v10 offset:36864
    ds_read_b64_tr_b16 a[100:101], v11 offset:32768
    ds_read_b64_tr_b16 a[102:103], v11 offset:36864
    ds_read_b64_tr_b16 a[104:105], v10 offset:40960
    ds_read_b64_tr_b16 a[106:107], v10 offset:45056
    ds_read_b64_tr_b16 a[108:109], v11 offset:40960
    ds_read_b64_tr_b16 a[110:111], v11 offset:45056
    s_waitcnt vmcnt(8)
    s_barrier
    ds_read_b64_tr_b16 a[112:113], v10 offset:49152
    ds_read_b64_tr_b16 a[114:115], v10 offset:53248
    ds_read_b64_tr_b16 a[116:117], v11 offset:49152
    ds_read_b64_tr_b16 a[118:119], v11 offset:53248
    ds_read_b64_tr_b16 a[120:121], v10 offset:57344
    ds_read_b64_tr_b16 a[122:123], v10 offset:61440
    ds_read_b64_tr_b16 a[124:125], v11 offset:57344
    ds_read_b64_tr_b16 a[126:127], v11 offset:61440
    v_add_u32 v10, 131072, v6
    v_xor_b32 v11, 32, v10
    s_waitcnt vmcnt(4)
    s_barrier
    ds_read_b64_tr_b16 a[128:129], v10 offset:0
    ds_read_b64_tr_b16 a[130:131], v10 offset:4096
    ds_read_b64_tr_b16 a[132:133], v11 offset:0
    ds_read_b64_tr_b16 a[134:135], v11 offset:4096
    ds_read_b64_tr_b16 a[136:137], v10 offset:8192
    ds_read_b64_tr_b16 a[138:139], v10 offset:12288
    ds_read_b64_tr_b16 a[140:141], v11 offset:8192
    ds_read_b64_tr_b16 a[142:143], v11 offset:12288
    s_waitcnt vmcnt(0)
    s_barrier
    ds_read_b64_tr_b16 a[144:145], v10 offset:16384
    ds_read_b64_tr_b16 a[146:147], v10 offset:20480
    ds_read_b64_tr_b16 a[148:149], v11 offset:16384
    ds_read_b64_tr_b16 a[150:151], v11 offset:20480
    ds_read_b64_tr_b16 a[152:153], v10 offset:24576
    ds_read_b64_tr_b16 a[154:155], v10 offset:28672
    ds_read_b64_tr_b16 a[156:157], v11 offset:24576
    ds_read_b64_tr_b16 a[158:159], v11 offset:28672
    s_waitcnt lgkmcnt(0)
    s_barrier
    s_add_u32 s23, s16, 32
    s_cmp_lg_u32 s18, 0
    s_cbranch_scc1 L_cal_166
    v_mov_b32 v4, -1
    s_mov_b64 exec, 1
    s_waitcnt vmcnt(0)
    s_mov_b32 s60, -1
    s_mov_b32 s61, -1
    s_lshl_b32 s41, s23, 15
    s_add_u32 s41, s41, 0x201800
    s_memtime s[56:57]
    s_waitcnt lgkmcnt(0)
    buffer_store_dword v4, off, s[4:7], s41 sc1
    s_waitcnt vmcnt(0)
    s_memtime s[58:59]
    s_waitcnt lgkmcnt(0)
    s_sub_u32 s58, s58, s56
    s_min_u32 s60, s60, s58
    s_lshl_b32 s41, s23, 15
    s_add_u32 s41, s41, 0x203800
    s_memtime s[56:57]
    s_waitcnt lgkmcnt(0)
    buffer_store_dword v4, off, s[4:7], s41 sc1
    s_waitcnt vmcnt(0)
    s_memtime s[58:59]
    s_waitcnt lgkmcnt(0)
    s_sub_u32 s58, s58, s56
    s_min_u32 s61, s61, s58
    s_lshl_b32 s41, s23, 15
    s_add_u32 s41, s41, 0x201800
    s_memtime s[56:57]
    s_waitcnt lgkmcnt(0)
    buffer_store_dword v4, off, s[4:7], s41 sc1
    s_waitcnt vmcnt(0)
    s_memtime s[58:59]
    s_waitcnt lgkmcnt(0)
    s_sub_u32 s58, s58, s56
    s_min_u32 s60, s60, s58
    s_lshl_b32 s41, s23, 15
    s_add_u32 s41, s41, 0x203800
    s_memtime s[56:57]
    s_waitcnt lgkmcnt(0)
    buffer_store_dword v4, off, s[4:7], s41 sc1
    s_waitcnt vmcnt(0)
    s_memtime s[58:59]
    s_waitcnt lgkmcnt(0)
    s_sub_u32 s58, s58, s56
    s_min_u32 s61, s61, s58
    s_lshl_b32 s41, s23, 15
    s_add_u32 s41, s41, 0x201800
    s_memtime s[56:57]
    s_waitcnt lgkmcnt(0)
    buffer_store_dword v4, off, s[4:7], s41 sc1
    s_waitcnt vmcnt(0)
    s_memtime s[58:59]
    s_waitcnt lgkmcnt(0)
    s_sub_u32 s58, s58, s56
    s_min_u32 s60, s60, s58
    s_lshl_b32 s41, s23, 15
    s_add_u32 s41, s41, 0x203800
    s_memtime s[56:57]
    s_waitcnt lgkmcnt(0)
    buffer_store_dword v4, off, s[4:7], s41 sc1
    s_waitcnt vmcnt(0)
    s_memtime s[58:59]
    s_waitcnt lgkmcnt(0)
    s_sub_u32 s58, s58, s56
    s_min_u32 s61, s61, s58
    s_cmp_lt_u32 s61, s60
    s_cselect_b32 s62, 1, 0
    s_mov_b32 s60, -1
    s_mov_b32 s61, -1
    s_lshl_b32 s41, s23, 15
    s_add_u32 s41, s41, 0x205800
    s_memtime s[56:57]
    s_waitcnt lgkmcnt(0)
    buffer_store_dword v4, off, s[4:7], s41 sc1
    s_waitcnt vmcnt(0)
    s_memtime s[58:59]
    s_waitcnt lgkmcnt(0)
    s_sub_u32 s58, s58, s56
    s_min_u32 s60, s60, s58
    s_lshl_b32 s41, s23, 15
    s_add_u32 s41, s41, 0x207800
    s_memtime s[56:57]
    s_waitcnt lgkmcnt(0)
    buffer_store_dword v4, off, s[4:7], s41 sc1
    s_waitcnt vmcnt(0)
    s_memtime s[58:59]
    s_waitcnt lgkmcnt(0)
    s_sub_u32 s58, s58, s56
    s_min_u32 s61, s61, s58
    s_lshl_b32 s41, s23, 15
    s_add_u32 s41, s41, 0x205800
    s_memtime s[56:57]
    s_waitcnt lgkmcnt(0)
    buffer_store_dword v4, off, s[4:7], s41 sc1
    s_waitcnt vmcnt(0)
    s_memtime s[58:59]
    s_waitcnt lgkmcnt(0)
    s_sub_u32 s58, s58, s56
    s_min_u32 s60, s60, s58
    s_lshl_b32 s41, s23, 15
    s_add_u32 s41, s41, 0x207800
    s_memtime s[56:57]
    s_waitcnt lgkmcnt(0)
    buffer_store_dword v4, off, s[4:7], s41 sc1
    s_waitcnt vmcnt(0)
    s_memtime s[58:59]
    s_waitcnt lgkmcnt(0)
    s_sub_u32 s58, s58, s56
    s_min_u32 s61, s61, s58
    s_lshl_b32 s41, s23, 15
    s_add_u32 s41, s41, 0x205800
    s_memtime s[56:57]
    s_waitcnt lgkmcnt(0)
    buffer_store_dword v4, off, s[4:7], s41 sc1
    s_waitcnt vmcnt(0)
    s_memtime s[58:59]
    s_waitcnt lgkmcnt(0)
    s_sub_u32 s58, s58, s56
    s_min_u32 s60, s60, s58
    s_lshl_b32 s41, s23, 15
    s_add_u32 s41, s41, 0x207800
    s_memtime s[56:57]
    s_waitcnt lgkmcnt(0)
    buffer_store_dword v4, off, s[4:7], s41 sc1
    s_waitcnt vmcnt(0)
    s_memtime s[58:59]
    s_waitcnt lgkmcnt(0)
    s_sub_u32 s58, s58, s56
    s_min_u32 s61, s61, s58
    s_cmp_lt_u32 s61, s60
    s_cselect_b32 s63, 1, 0
    s_and_b32 s41, s23, 31
    s_lshl_b32 s62, s62, s41
    v_mov_b32 v5, s62
    s_lshr_b32 s41, s23, 5
    s_lshl_b32 s41, s41, 2
    buffer_atomic_or v5, off, s[12:15], s41 offset:144 sc1
    s_and_b32 s41, s23, 31
    s_lshl_b32 s63, s63, s41
    v_mov_b32 v5, s63
    s_lshr_b32 s41, s23, 5
    s_lshl_b32 s41, s41, 2
    buffer_atomic_or v5, off, s[12:15], s41 offset:152 sc1
    s_waitcnt vmcnt(0)
    v_mov_b32 v5, 1
    buffer_atomic_add v5, off, s[12:15], 0 offset:160 sc1
    s_mov_b64 exec, -1
L_cal_166:
    s_cmp_lg_u32 s18, 0
    s_cbranch_scc1 L_wi_167
    s_mov_b32 s41, 16
    v_min_u32 v4, 0, v0
    v_lshlrev_b32 v4, 2, v4
L_wf_168:
    buffer_load_dword v5, v4, s[12:15], s41 offen sc1
    s_waitcnt vmcnt(0)
    v_cmp_gt_u32 vcc, 128, v5
    s_cbranch_vccz L_wfd_169
    s_sleep 6
    s_add_u32 s46, s46, 1
    s_cmp_lt_u32 s46, 131072
    s_cbranch_scc1 L_wf_168
    s_branch L_end
L_wfd_169:
L_wi_167:
    s_barrier
    s_mov_b32 s19, 0
    s_mov_b32 s40, 64
    s_mov_b32 s20, 0x600000
    s_mov_b32 s21, 0x500000
    s_lshl_b32 s22, s16, 4
    s_add_u32 s22, s22, 0x518004
    s_lshl_b32 s26, s16, 12
    s_lshl_b32 s41, s18, 10
    s_add_u32 s26, s26, s41
    s_add_u32 s26, s26, 0x900000
    s_lshl_b32 s23, s16, 13
    s_lshl_b32 s41, s18, 11
    s_add_u32 s23, s23, s41
    s_add_u32 s23, s23, 0x2100000
    v_min_u32 v10, 1, v0
    v_lshlrev_b32 v10, 2, v10
    s_mov_b32 s25, 0
    s_mul_i32 s41, s19, 40960
    s_add_u32 s20, s20, s41
    s_mul_i32 s41, s19, 8
    s_add_u32 s21, s21, s41
    s_mul_i32 s41, s19, 512
    s_add_u32 s22, s22, s41
L_gload_172:
    v_min_u32 v4, 1, v0
    v_lshlrev_b32 v4, 2, v4
L_wf_174:
    buffer_load_dword v5, v4, s[4:7], s21 offen sc1
    s_waitcnt vmcnt(0)
    v_cmp_ne_u32 vcc, 1, v5
    s_cbranch_vccz L_wfd_175
    s_sleep 1
    s_add_u32 s46, s46, 1
    s_cmp_lt_u32 s46, 131072
    s_cbranch_scc1 L_wf_174
    s_branch L_end
L_wfd_175:
    s_lshl_b32 s38, s18, 10
    s_add_u32 s38, s38, s25
    s_lshl_b32 s39, s18, 10
    s_add_u32 s39, s39, s20
    s_add_u32 s20, s20, 40960
    s_add_u32 s21, s21, 8
    s_add_u32 m0, s38, 0
    s_nop 0
    buffer_load_dwordx4 v3, s[4:7], s39 offen sc1 lds
    s_add_u32 s39, s39, 4096
    s_add_u32 m0, s38, 4096
    s_nop 0
    buffer_load_dwordx4 v3, s[4:7], s39 offen sc1 lds
    s_add_u32 s39, s39, 4096
    s_add_u32 m0, s38, 8192
    s_nop 0
    buffer_load_dwordx4 v3, s[4:7], s39 offen sc1 lds
    s_add_u32 s39, s39, 4096
    s_add_u32 m0, s38, 12288
    s_nop 0
    buffer_load_dwordx4 v3, s[4:7], s39 offen sc1 lds
    s_add_u32 s39, s39, 4096
    s_add_u32 m0, s38, 16384
    s_nop 0
    buffer_load_dwordx4 v3, s[4:7], s39 offen sc1 lds
    s_add_u32 s39, s39, 4096
    s_add_u32 m0, s38, 20480
    s_nop 0
    buffer_load_dwordx4 v3, s[4:7], s39 offen sc1 lds
    s_add_u32 s39, s39, 4096
    s_add_u32 m0, s38, 24576
    s_nop 0
    buffer_load_dwordx4 v3, s[4:7], s39 offen sc1 lds
    s_add_u32 s39, s39, 4096
    s_add_u32 m0, s38, 28672
    s_nop 0
    buffer_load_dwordx4 v3, s[4:7], s39 offen sc1 lds
    s_add_u32 s39, s39, 4096
    s_add_u32 m0, s38, 32768
    s_nop 0
    buffer_load_dwordx4 v3, s[4:7], s39 offen sc1 lds
    s_add_u32 s39, s39, 4096
    s_add_u32 m0, s38, 36864
    s_nop 0
    buffer_load_dwordx4 v3, s[4:7], s39 offen sc1 lds
    s_add_u32 s39, s39, 4096
    buffer_load_dword v11, v10, s[4:7], s21 offen sc1
    s_mov_b32 s37, 0
    s_waitcnt vmcnt(0) lgkmcnt(0)
    s_branch L_ggo_173
L_gtop_170:
    s_waitcnt vmcnt(4)
L_ggo_173:
    s_barrier
    v_add_u32 v8, s25, v3
    s_add_u32 s27, s19, 1
    s_sub_u32 s25, 40960, s25
    ds_read_b128 v[28:31], v8 offset:0
    ds_read_b128 v[32:35], v8 offset:1024
    ds_read_b128 v[36:39], v8 offset:2048
    ds_read_b128 v[40:43], v8 offset:3072
    ds_read_b128 v[44:47], v8 offset:4096
    ds_read_b128 v[48:51], v8 offset:5120
    s_waitcnt lgkmcnt(4)
    v_mfma_f32_16x16x32_bf16 v[12:15], v[28:31], a[0:3], 0
    v_mfma_f32_16x16x32_bf16 v[16:19], v[32:35], a[0:3], 0
    v_mfma_f32_16x16x32_bf16 v[20:23], v[28:31], a[4:7], 0
    v_mfma_f32_16x16x32_bf16 v[24:27], v[32:35], a[4:7], 0
    ds_read_b128 v[28:31], v8 offset:6144
    ds_read_b128 v[32:35], v8 offset:7168
    s_waitcnt lgkmcnt(4)
    v_mfma_f32_16x16x32_bf16 v[12:15], v[36:39], a[8:11], v[12:15]
    v_mfma_f32_16x16x32_bf16 v[16:19], v[40:43], a[8:11], v[16:19]
    v_mfma_f32_16x16x32_bf16 v[20:23], v[36:39], a[12:15], v[20:23]
    v_mfma_f32_16x16x32_bf16 v[24:27], v[40:43], a[12:15], v[24:27]
    ds_read_b128 v[36:39], v8 offset:8192
    ds_read_b128 v[40:43], v8 offset:9216
    s_waitcnt lgkmcnt(4)
    v_mfma_f32_16x16x32_bf16 v[12:15], v[44:47], a[16:19], v[12:15]
    v_mfma_f32_16x16x32_bf16 v[16:19], v[48:51], a[16:19], v[16:19]
    v_mfma_f32_16x16x32_bf16 v[20:23], v[44:47], a[20:23], v[20:23]
    v_mfma_f32_16x16x32_bf16 v[24:27], v[48:51], a[20:23], v[24:27]
    ds_read_b128 v[44:47], v8 offset:10240
    ds_read_b128 v[48:51], v8 offset:11264
    s_waitcnt lgkmcnt(4)
    v_mfma_f32_16x16x32_bf16 v[12:15], v[28:31], a[24:27], v[12:15]
    v_mfma_f32_16x16x32_bf16 v[16:19], v[32:35], a[24:27], v[16:19]
    v_mfma_f32_16x16x32_bf16 v[20:23], v[28:31], a[28:31], v[20:23]
    v_mfma_f32_16x16x32_bf16 v[24:27], v[32:35], a[28:31], v[24:27]
    ds_read_b128 v[28:31], v8 offset:12288
    ds_read_b128 v[32:35], v8 offset:13312
    s_waitcnt lgkmcnt(4)
    v_mfma_f32_16x16x32_bf16 v[12:15], v[36:39], a[32:35], v[12:15]
    v_mfma_f32_16x16x32_bf16 v[16:19], v[40:43], a[32:35], v[16:19]
    v_mfma_f32_16x16x32_bf16 v[20:23], v[36:39], a[36:39], v[20:23]
    v_mfma_f32_16x16x32_bf16 v[24:27], v[40:43], a[36:39], v[24:27]
    ds_read_b128 v[36:39], v8 offset:14336
    ds_read_b128 v[40:43], v8 offset:15360
    s_waitcnt lgkmcnt(4)
    v_mfma_f32_16x16x32_bf16 v[12:15], v[44:47], a[40:43], v[12:15]
    v_mfma_f32_16x16x32_bf16 v[16:19], v[48:51], a[40:43], v[16:19]
    v_mfma_f32_16x16x32_bf16 v[20:23], v[44:47], a[44:47], v[20:23]
    v_mfma_f32_16x16x32_bf16 v[24:27], v[48:51], a[44:47], v[24:27]
    ds_read_b128 v[44:47], v8 offset:16384
    ds_read_b128 v[48:51], v8 offset:17408
    s_waitcnt vmcnt(0)
    v_cmp_ne_u32 vcc, 1, v11
    s_cmp_eq_u64 vcc, 0
    s_cselect_b32 s24, 1, 0
    s_cmp_ge_u32 s27, s40
    s_cselect_b32 s24, 0, s24
    v_mov_b32 v4, 81920
    s_cmp_lg_u32 s18, 0
    s_cbranch_scc1 L_dec_176
    v_mov_b32 v5, s24
    ds_write_b32 v4, v5
L_dec_176:
    s_waitcnt lgkmcnt(0)
    s_barrier
    ds_read_b32 v5, v4
    s_cmp_eq_u32 s37, 0
    s_cbranch_scc1 L_pend_177
    v_mov_b32 v6, 1
    s_cmp_lg_u32 s18, 0
    s_cbranch_scc1 L_sig_178
    s_mov_b64 exec, 1
    buffer_store_dword v6, off, s[4:7], s22 sc1
    s_mov_b64 exec, -1
L_sig_178:
    s_add_u32 s22, s22, 512
L_pend_177:
    s_waitcnt lgkmcnt(0)
    v_readfirstlane_b32 s24, v5
    s_cmp_eq_u32 s24, 0
    s_cbranch_scc1 L_nos_179
    s_lshl_b32 s38, s18, 10
    s_add_u32 s38, s38, s25
    s_lshl_b32 s39, s18, 10
    s_add_u32 s39, s39, s20
    s_add_u32 s20, s20, 40960
    s_add_u32 s21, s21, 8
L_nos_179:
    v_mfma_f32_16x16x32_bf16 v[12:15], v[28:31], a[48:51], v[12:15]
    v_mfma_f32_16x16x32_bf16 v[16:19], v[32:35], a[48:51], v[16:19]
    v_mfma_f32_16x16x32_bf16 v[20:23], v[28:31], a[52:55], v[20:23]
    v_mfma_f32_16x16x32_bf16 v[24:27], v[32:35], a[52:55], v[24:27]
    ds_read_b128 v[28:31], v8 offset:18432
    ds_read_b128 v[32:35], v8 offset:19456
    s_cmp_eq_u32 s24, 0
    s_cbranch_scc1 L_nod_180
    s_add_u32 m0, s38, 0
    s_nop 0
    buffer_load_dwordx4 v3, s[4:7], s39 offen sc1 lds
    s_add_u32 s39, s39, 4096
L_nod_180:
    v_mfma_f32_16x16x32_bf16 v[12:15], v[36:39], a[56:59], v[12:15]
    v_mfma_f32_16x16x32_bf16 v[16:19], v[40:43], a[56:59], v[16:19]
    v_mfma_f32_16x16x32_bf16 v[20:23], v[36:39], a[60:63], v[20:23]
    v_mfma_f32_16x16x32_bf16 v[24:27], v[40:43], a[60:63], v[24:27]
    ds_read_b128 v[36:39], v8 offset:20480
    ds_read_b128 v[40:43], v8 offset:21504
    s_cmp_eq_u32 s24, 0
    s_cbranch_scc1 L_nod_181
    s_add_u32 m0, s38, 4096
    s_nop 0
    buffer_load_dwordx4 v3, s[4:7], s39 offen sc1 lds
    s_add_u32 s39, s39, 4096
L_nod_181:
    v_mfma_f32_16x16x32_bf16 v[12:15], v[44:47], a[64:67], v[12:15]
    v_mfma_f32_16x16x32_bf16 v[16:19], v[48:51], a[64:67], v[16:19]
    v_mfma_f32_16x16x32_bf16 v[20:23], v[44:47], a[68:71], v[20:23]
    v_mfma_f32_16x16x32_bf16 v[24:27], v[48:51], a[68:71], v[24:27]
    ds_read_b128 v[44:47], v8 offset:22528
    ds_read_b128 v[48:51], v8 offset:23552
    s_cmp_eq_u32 s24, 0
    s_cbranch_scc1 L_nod_182
    s_add_u32 m0, s38, 8192
    s_nop 0
    buffer_load_dwordx4 v3, s[4:7], s39 offen sc1 lds
    s_add_u32 s39, s39, 4096
L_nod_182:
    s_waitcnt lgkmcnt(4)
    v_mfma_f32_16x16x32_bf16 v[12:15], v[28:31], a[72:75], v[12:15]
    v_mfma_f32_16x16x32_bf16 v[16:19], v[32:35], a[72:75], v[16:19]
    v_mfma_f32_16x16x32_bf16 v[20:23], v[28:31], a[76:79], v[20:23]
    v_mfma_f32_16x16x32_bf16 v[24:27], v[32:35], a[76:79], v[24:27]
    ds_read_b128 v[28:31], v8 offset:24576
    ds_read_b128 v[32:35], v8 offset:25600
    s_cmp_eq_u32 s24, 0
    s_cbranch_scc1 L_nod_183
    s_add_u32 m0, s38, 12288
    s_nop 0
    buffer_load_dwordx4 v3, s[4:7], s39 offen sc1 lds
    s_add_u32 s39, s39, 4096
L_nod_183:
    s_waitcnt lgkmcnt(4)
    v_mfma_f32_16x16x32_bf16 v[12:15], v[36:39], a[80:83], v[12:15]
    v_mfma_f32_16x16x32_bf16 v[16:19], v[40:43], a[80:83], v[16:19]
    v_mfma_f32_16x16x32_bf16 v[20:23], v[36:39], a[84:87], v[20:23]
    v_mfma_f32_16x16x32_bf16 v[24:27], v[40:43], a[84:87], v[24:27]
    ds_read_b128 v[36:39], v8 offset:26624
    ds_read_b128 v[40:43], v8 offset:27648
    s_cmp_eq_u32 s24, 0
    s_cbranch_scc1 L_nod_184
    s_add_u32 m0, s38, 16384
    s_nop 0
    buffer_load_dwordx4 v3, s[4:7], s39 offen sc1 lds
    s_add_u32 s39, s39, 4096
L_nod_184:
    s_waitcnt lgkmcnt(4)
    v_mfma_f32_16x16x32_bf16 v[12:15], v[44:47], a[88:91], v[12:15]
    v_mfma_f32_16x16x32_bf16 v[16:19], v[48:51], a[88:91], v[16:19]
    v_mfma_f32_16x16x32_bf16 v[20:23], v[44:47], a[92:95], v[20:23]
    v_mfma_f32_16x16x32_bf16 v[24:27], v[48:51], a[92:95], v[24:27]
    ds_read_b128 v[44:47], v8 offset:28672
    ds_read_b128 v[48:51], v8 offset:29696
    s_cmp_eq_u32 s24, 0
    s_cbranch_scc1 L_nod_185
    s_add_u32 m0, s38, 20480
    s_nop 0
    buffer_load_dwordx4 v3, s[4:7], s39 offen sc1 lds
    s_add_u32 s39, s39, 4096
L_nod_185:
    s_waitcnt lgkmcnt(4)
    v_mfma_f32_16x16x32_bf16 v[12:15], v[28:31], a[96:99], v[12:15]
    v_mfma_f32_16x16x32_bf16 v[16:19], v[32:35], a[96:99], v[16:19]
    v_mfma_f32_16x16x32_bf16 v[20:23], v[28:31], a[100:103], v[20:23]
    v_mfma_f32_16x16x32_bf16 v[24:27], v[32:35], a[100:103], v[24:27]
    ds_read_b128 v[28:31], v8 offset:30720
    ds_read_b128 v[32:35], v8 offset:31744
    s_cmp_eq_u32 s24, 0
    s_cbranch_scc1 L_nod_186
    s_add_u32 m0, s38, 24576
    s_nop 0
    buffer_load_dwordx4 v3, s[4:7], s39 offen sc1 lds
    s_add_u32 s39, s39, 4096
L_nod_186:
    s_waitcnt lgkmcnt(4)
    v_mfma_f32_16x16x32_bf16 v[12:15], v[36:39], a[104:107], v[12:15]
    v_mfma_f32_16x16x32_bf16 v[16:19], v[40:43], a[104:107], v[16:19]
    v_mfma_f32_16x16x32_bf16 v[20:23], v[36:39], a[108:111], v[20:23]
    v_mfma_f32_16x16x32_bf16 v[24:27], v[40:43], a[108:111], v[24:27]
    ds_read_b128 v[36:39], v8 offset:32768
    ds_read_b128 v[40:43], v8 offset:33792
    s_cmp_eq_u32 s24, 0
    s_cbranch_scc1 L_nod_187
    s_add_u32 m0, s38, 28672
    s_nop 0
    buffer_load_dwordx4 v3, s[4:7], s39 offen sc1 lds
    s_add_u32 s39, s39, 4096
L_nod_187:
    s_waitcnt lgkmcnt(4)
    v_mfma_f32_16x16x32_bf16 v[12:15], v[44:47], a[112:115], v[12:15]
    v_mfma_f32_16x16x32_bf16 v[16:19], v[48:51], a[112:115], v[16:19]
    v_mfma_f32_16x16x32_bf16 v[20:23], v[44:47], a[116:119], v[20:23]
    v_mfma_f32_16x16x32_bf16 v[24:27], v[48:51], a[116:119], v[24:27]
    ds_read_b128 v[44:47], v8 offset:34816
    ds_read_b128 v[48:51], v8 offset:35840
    s_cmp_eq_u32 s24, 0
    s_cbranch_scc1 L_nod_188
    s_add_u32 m0, s38, 32768
    s_nop 0
    buffer_load_dwordx4 v3, s[4:7], s39 offen sc1 lds
    s_add_u32 s39, s39, 4096
L_nod_188:
    s_waitcnt lgkmcnt(4)
    v_mfma_f32_16x16x32_bf16 v[12:15], v[28:31], a[120:123], v[12:15]
    v_mfma_f32_16x16x32_bf16 v[16:19], v[32:35], a[120:123], v[16:19]
    v_mfma_f32_16x16x32_bf16 v[20:23], v[28:31], a[124:127], v[20:23]
    v_mfma_f32_16x16x32_bf16 v[24:27], v[32:35], a[124:127], v[24:27]
    ds_read_b128 v[28:31], v8 offset:36864
    ds_read_b128 v[32:35], v8 offset:37888
    s_cmp_eq_u32 s24, 0
    s_cbranch_scc1 L_nod_189
    s_add_u32 m0, s38, 36864
    s_nop 0
    buffer_load_dwordx4 v3, s[4:7], s39 offen sc1 lds
    s_add_u32 s39, s39, 4096
L_nod_189:
    s_waitcnt lgkmcnt(4)
    v_mfma_f32_16x16x32_bf16 v[12:15], v[36:39], a[128:131], v[12:15]
    v_mfma_f32_16x16x32_bf16 v[16:19], v[40:43], a[128:131], v[16:19]
    v_mfma_f32_16x16x32_bf16 v[20:23], v[36:39], a[132:135], v[20:23]
    v_mfma_f32_16x16x32_bf16 v[24:27], v[40:43], a[132:135], v[24:27]
    ds_read_b128 v[36:39], v8 offset:38912
    ds_read_b128 v[40:43], v8 offset:39936
    s_waitcnt lgkmcnt(4)
    v_mfma_f32_16x16x32_bf16 v[12:15], v[44:47], a[136:139], v[12:15]
    v_mfma_f32_16x16x32_bf16 v[16:19], v[48:51], a[136:139], v[16:19]
    v_mfma_f32_16x16x32_bf16 v[20:23], v[44:47], a[140:143], v[20:23]
    v_mfma_f32_16x16x32_bf16 v[24:27], v[48:51], a[140:143], v[24:27]
    s_waitcnt lgkmcnt(2)
    v_mfma_f32_16x16x32_bf16 v[12:15], v[28:31], a[144:147], v[12:15]
    v_mfma_f32_16x16x32_bf16 v[16:19], v[32:35], a[144:147], v[16:19]
    v_mfma_f32_16x16x32_bf16 v[20:23], v[28:31], a[148:151], v[20:23]
    v_mfma_f32_16x16x32_bf16 v[24:27], v[32:35], a[148:151], v[24:27]
    s_waitcnt lgkmcnt(0)
    v_mfma_f32_16x16x32_bf16 v[12:15], v[36:39], a[152:155], v[12:15]
    v_mfma_f32_16x16x32_bf16 v[16:19], v[40:43], a[152:155], v[16:19]
    v_mfma_f32_16x16x32_bf16 v[20:23], v[36:39], a[156:159], v[20:23]
    v_mfma_f32_16x16x32_bf16 v[24:27], v[40:43], a[156:159], v[24:27]
    s_nop 4
    v_cvt_pk_bf16_f32 v68, v12, v13
    v_cvt_pk_bf16_f32 v69, v14, v15
    v_cvt_pk_bf16_f32 v70, v16, v17
    v_cvt_pk_bf16_f32 v71, v18, v19
    buffer_store_dwordx4 v[68:71], v3, s[4:7], s23 offen offset:0 sc1
    v_cvt_pk_bf16_f32 v72, v20, v21
    v_cvt_pk_bf16_f32 v73, v22, v23
    v_cvt_pk_bf16_f32 v74, v24, v25
    v_cvt_pk_bf16_f32 v75, v26, v27
    buffer_store_dwordx4 v[72:75], v3, s[4:7], s23 offen offset:1024 sc1
    s_add_u32 s23, s23, 262144
    buffer_store_dwordx4 v[68:71], v3, s[4:7], s26 offen sc1
    s_add_u32 s26, s26, 131072
    buffer_load_dword v11, v10, s[4:7], s21 offen sc1
    s_mov_b32 s19, s27
    s_mov_b32 s37, 1
    s_cmp_eq_u32 s24, 1
    s_cbranch_scc1 L_gtop_170
    s_waitcnt vmcnt(0) lgkmcnt(0)
    s_barrier
    s_cmp_lg_u32 s18, 0
    s_cbranch_scc1 L_sig_190
    v_mov_b32 v5, 1
    s_mov_b64 exec, 1
    buffer_store_dword v5, off, s[4:7], s22 sc1
    s_mov_b64 exec, -1
L_sig_190:
    s_add_u32 s22, s22, 512
    s_cmp_lt_u32 s19, s40
    s_cbranch_scc1 L_gload_172
L_gend_171:
L_kvd:
    s_lshl_b32 s17, s17, 5
    s_add_u32 s17, s17, s16
    s_barrier
    s_cmp_lt_u32 s17, 24
    s_cbranch_scc1 L_ln2r
    s_sub_u32 s41, s17, 32
    s_cmp_ge_u32 s41, 20
    s_cbranch_scc1 L_end
    s_mul_i32 s16, s41, 52
    s_lshr_b32 s16, s16, 8
    s_mul_i32 s17, s16, 5
    s_sub_u32 s17, s41, s17
    s_load_dwordx2 s[44:45], s[0:1], 40
    s_waitcnt lgkmcnt(0)
    s_mov_b32 s8, s44
    s_mov_b32 s9, s45
    s_mov_b32 s10, 0x500000
    s_mov_b32 s11, 0x20000
    s_mul_i32 s20, s16, 1310720
    s_lshl_b32 s41, s17, 8
    s_add_u32 s20, s20, s41
    s_mov_b32 s41, 1280
    v_or_b32 v4, 0, v1
    v_lshlrev_b32 v4, 1, v4
    v_xor_b32 v4, v4, v2
    v_mul_lo_u32 v5, v1, s41
    v_lshl_add_u32 v8, v4, 4, v5
    v_or_b32 v4, 4, v1
    v_lshlrev_b32 v4, 1, v4
    v_xor_b32 v4, v4, v2
    v_mul_lo_u32 v5, v1, s41
    v_lshl_add_u32 v9, v4, 4, v5
    v_bfe_u32 v4, v0, 2, 3
    v_lshlrev_b32 v4, 1, v4
    v_bfe_u32 v5, v0, 1, 1
    s_lshl_b32 s41, s18, 2
    v_or_b32 v5, s41, v5
    v_xor_b32 v4, v4, v5
    v_lshlrev_b32 v4, 4, v4
    v_lshrrev_b32 v5, 2, v0
    v_lshl_add_u32 v4, v5, 8, v4
    v_and_b32 v5, 1, v0
    v_lshl_add_u32 v6, v5, 3, v4
    s_mul_i32 s41, s18, 20480
    s_add_u32 s20, s20, s41
    s_lshl_b32 s42, s18, 12
    s_waitcnt lgkmcnt(0)
    s_barrier
    s_add_u32 m0, s42, 0
    s_nop 0
    buffer_load_dwordx4 v8, s[8:11], s20 offen lds
    s_add_u32 s20, s20, 5120
    s_add_u32 m0, s42, 1024
    s_nop 0
    buffer_load_dwordx4 v9, s[8:11], s20 offen lds
    s_add_u32 s20, s20, 5120
    s_add_u32 m0, s42, 2048
    s_nop 0
    buffer_load_dwordx4 v8, s[8:11], s20 offen lds
    s_add_u32 s20, s20, 5120
    s_add_u32 m0, s42, 3072
    s_nop 0
    buffer_load_dwordx4 v9, s[8:11], s20 offen lds
    s_add_u32 s20, s20, 66560
    s_add_u32 m0, s42, 16384
    s_nop 0
    buffer_load_dwordx4 v8, s[8:11], s20 offen lds
    s_add_u32 s20, s20, 5120
    s_add_u32 m0, s42, 17408
    s_nop 0
    buffer_load_dwordx4 v9, s[8:11], s20 offen lds
    s_add_u32 s20, s20, 5120
    s_add_u32 m0, s42, 18432
    s_nop 0
    buffer_load_dwordx4 v8, s[8:11], s20 offen lds
    s_add_u32 s20, s20, 5120
    s_add_u32 m0, s42, 19456
    s_nop 0
    buffer_load_dwordx4 v9, s[8:11], s20 offen lds
    s_add_u32 s20, s20, 66560
    s_add_u32 m0, s42, 32768
    s_nop 0
    buffer_load_dwordx4 v8, s[8:11], s20 offen lds
    s_add_u32 s20, s20, 5120
    s_add_u32 m0, s42, 33792
    s_nop 0
    buffer_load_dwordx4 v9, s[8:11], s20 offen lds
    s_add_u32 s20, s20, 5120
    s_add_u32 m0, s42, 34816
    s_nop 0
    buffer_load_dwordx4 v8, s[8:11], s20 offen lds
    s_add_u32 s20, s20, 5120
    s_add_u32 m0, s42, 35840
    s_nop 0
    buffer_load_dwordx4 v9, s[8:11], s20 offen lds
    s_add_u32 s20, s20, 66560
    s_add_u32 m0, s42, 49152
    s_nop 0
    buffer_load_dwordx4 v8, s[8:11], s20 offen lds
    s_add_u32 s20, s20, 5120
    s_add_u32 m0, s42, 50176
    s_nop 0
    buffer_load_dwordx4 v9, s[8:11], s20 offen lds
    s_add_u32 s20, s20, 5120
    s_add_u32 m0, s42, 51200
    s_nop 0
    buffer_load_dwordx4 v8, s[8:11], s20 offen lds
    s_add_u32 s20, s20, 5120
    s_add_u32 m0, s42, 52224
    s_nop 0
    buffer_load_dwordx4 v9, s[8:11], s20 offen lds
    s_add_u32 s20, s20, 66560
    s_add_u32 m0, s42, 65536
    s_nop 0
    buffer_load_dwordx4 v8, s[8:11], s20 offen lds
    s_add_u32 s20, s20, 5120
    s_add_u32 m0, s42, 66560
    s_nop 0
    buffer_load_dwordx4 v9, s[8:11], s20 offen lds
    s_add_u32 s20, s20, 5120
    s_add_u32 m0, s42, 67584
    s_nop 0
    buffer_load_dwordx4 v8, s[8:11], s20 offen lds
    s_add_u32 s20, s20, 5120
    s_add_u32 m0, s42, 68608
    s_nop 0
    buffer_load_dwordx4 v9, s[8:11], s20 offen lds
    s_add_u32 s20, s20, 66560
    s_add_u32 m0, s42, 81920
    s_nop 0
    buffer_load_dwordx4 v8, s[8:11], s20 offen lds
    s_add_u32 s20, s20, 5120
    s_add_u32 m0, s42, 82944
    s_nop 0
    buffer_load_dwordx4 v9, s[8:11], s20 offen lds
    s_add_u32 s20, s20, 5120
    s_add_u32 m0, s42, 83968
    s_nop 0
    buffer_load_dwordx4 v8, s[8:11], s20 offen lds
    s_add_u32 s20, s20, 5120
    s_add_u32 m0, s42, 84992
    s_nop 0
    buffer_load_dwordx4 v9, s[8:11], s20 offen lds
    s_add_u32 s20, s20, 66560
    s_add_u32 m0, s42, 98304
    s_nop 0
    buffer_load_dwordx4 v8, s[8:11], s20 offen lds
    s_add_u32 s20, s20, 5120
    s_add_u32 m0, s42, 99328
    s_nop 0
    buffer_load_dwordx4 v9, s[8:11], s20 offen lds
    s_add_u32 s20, s20, 5120
    s_add_u32 m0, s42, 100352
    s_nop 0
    buffer_load_dwordx4 v8, s[8:11], s20 offen lds
    s_add_u32 s20, s20, 5120
    s_add_u32 m0, s42, 101376
    s_nop 0
    buffer_load_dwordx4 v9, s[8:11], s20 offen lds
    s_add_u32 s20, s20, 66560
    s_add_u32 m0, s42, 114688
    s_nop 0
    buffer_load_dwordx4 v8, s[8:11], s20 offen lds
    s_add_u32 s20, s20, 5120
    s_add_u32 m0, s42, 115712
    s_nop 0
    buffer_load_dwordx4 v9, s[8:11], s20 offen lds
    s_add_u32 s20, s20, 5120
    s_add_u32 m0, s42, 116736
    s_nop 0
    buffer_load_dwordx4 v8, s[8:11], s20 offen lds
    s_add_u32 s20, s20, 5120
    s_add_u32 m0, s42, 117760
    s_nop 0
    buffer_load_dwordx4 v9, s[8:11], s20 offen lds
    s_add_u32 s20, s20, 66560
    s_add_u32 m0, s42, 131072
    s_nop 0
    buffer_load_dwordx4 v8, s[8:11], s20 offen lds
    s_add_u32 s20, s20, 5120
    s_add_u32 m0, s42, 132096
    s_nop 0
    buffer_load_dwordx4 v9, s[8:11], s20 offen lds
    s_add_u32 s20, s20, 5120
    s_add_u32 m0, s42, 133120
    s_nop 0
    buffer_load_dwordx4 v8, s[8:11], s20 offen lds
    s_add_u32 s20, s20, 5120
    s_add_u32 m0, s42, 134144
    s_nop 0
    buffer_load_dwordx4 v9, s[8:11], s20 offen lds
    s_add_u32 s20, s20, 66560
    s_add_u32 m0, s42, 147456
    s_nop 0
    buffer_load_dwordx4 v8, s[8:11], s20 offen lds
    s_add_u32 s20, s20, 5120
    s_add_u32 m0, s42, 148480
    s_nop 0
    buffer_load_dwordx4 v9, s[8:11], s20 offen lds
    s_add_u32 s20, s20, 5120
    s_add_u32 m0, s42, 149504
    s_nop 0
    buffer_load_dwordx4 v8, s[8:11], s20 offen lds
    s_add_u32 s20, s20, 5120
    s_add_u32 m0, s42, 150528
    s_nop 0
    buffer_load_dwordx4 v9, s[8:11], s20 offen lds
    s_add_u32 s20, s20, 66560
    v_add_u32 v10, 0, v6
    v_xor_b32 v11, 32, v10
    s_waitcnt vmcnt(36)
    s_barrier
    ds_read_b64_tr_b16 a[0:1], v10 offset:0
    ds_read_b64_tr_b16 a[2:3], v10 offset:4096
    ds_read_b64_tr_b16 a[4:5], v11 offset:0
    ds_read_b64_tr_b16 a[6:7], v11 offset:4096
    ds_read_b64_tr_b16 a[8:9], v10 offset:8192
    ds_read_b64_tr_b16 a[10:11], v10 offset:12288
    ds_read_b64_tr_b16 a[12:13], v11 offset:8192
    ds_read_b64_tr_b16 a[14:15], v11 offset:12288
    s_waitcnt vmcnt(32)
    s_barrier
    ds_read_b64_tr_b16 a[16:17], v10 offset:16384
    ds_read_b64_tr_b16 a[18:19], v10 offset:20480
    ds_read_b64_tr_b16 a[20:21], v11 offset:16384
    ds_read_b64_tr_b16 a[22:23], v11 offset:20480
    ds_read_b64_tr_b16 a[24:25], v10 offset:24576
    ds_read_b64_tr_b16 a[26:27], v10 offset:28672
    ds_read_b64_tr_b16 a[28:29], v11 offset:24576
    ds_read_b64_tr_b16 a[30:31], v11 offset:28672
    s_waitcnt vmcnt(28)
    s_barrier
    ds_read_b64_tr_b16 a[32:33], v10 offset:32768
    ds_read_b64_tr_b16 a[34:35], v10 offset:36864
    ds_read_b64_tr_b16 a[36:37], v11 offset:32768
    ds_read_b64_tr_b16 a[38:39], v11 offset:36864
    ds_read_b64_tr_b16 a[40:41], v10 offset:40960
    ds_read_b64_tr_b16 a[42:43], v10 offset:45056
    ds_read_b64_tr_b16 a[44:45], v11 offset:40960
    ds_read_b64_tr_b16 a[46:47], v11 offset:45056
    s_waitcnt vmcnt(24)
    s_barrier
    ds_read_b64_tr_b16 a[48:49], v10 offset:49152
    ds_read_b64_tr_b16 a[50:51], v10 offset:53248
    ds_read_b64_tr_b16 a[52:53], v11 offset:49152
    ds_read_b64_tr_b16 a[54:55], v11 offset:53248
    ds_read_b64_tr_b16 a[56:57], v10 offset:57344
    ds_read_b64_tr_b16 a[58:59], v10 offset:61440
    ds_read_b64_tr_b16 a[60:61], v11 offset:57344
    ds_read_b64_tr_b16 a[62:63], v11 offset:61440
    v_add_u32 v10, 65536, v6
    v_xor_b32 v11, 32, v10
    s_waitcnt vmcnt(20)
    s_barrier
    ds_read_b64_tr_b16 a[64:65], v10 offset:0
    ds_read_b64_tr_b16 a[66:67], v10 offset:4096
    ds_read_b64_tr_b16 a[68:69], v11 offset:0
    ds_read_b64_tr_b16 a[70:71], v11 offset:4096
    ds_read_b64_tr_b16 a[72:73], v10 offset:8192
    ds_read_b64_tr_b16 a[74:75], v10 offset:12288
    ds_read_b64_tr_b16 a[76:77], v11 offset:8192
    ds_read_b64_tr_b16 a[78:79], v11 offset:12288
    s_waitcnt vmcnt(16)
    s_barrier
    ds_read_b64_tr_b16 a[80:81], v10 offset:16384
    ds_read_b64_tr_b16 a[82:83], v10 offset:20480
    ds_read_b64_tr_b16 a[84:85], v11 offset:16384
    ds_read_b64_tr_b16 a[86:87], v11 offset:20480
    ds_read_b64_tr_b16 a[88:89], v10 offset:24576
    ds_read_b64_tr_b16 a[90:91], v10 offset:28672
    ds_read_b64_tr_b16 a[92:93], v11 offset:24576
    ds_read_b64_tr_b16 a[94:95], v11 offset:28672
    s_waitcnt vmcnt(12)
    s_barrier
    ds_read_b64_tr_b16 a[96:97], v10 offset:32768
    ds_read_b64_tr_b16 a[98:99], v10 offset:36864
    ds_read_b64_tr_b16 a[100:101], v11 offset:32768
    ds_read_b64_tr_b16 a[102:103], v11 offset:36864
    ds_read_b64_tr_b16 a[104:105], v10 offset:40960
    ds_read_b64_tr_b16 a[106:107], v10 offset:45056
    ds_read_b64_tr_b16 a[108:109], v11 offset:40960
    ds_read_b64_tr_b16 a[110:111], v11 offset:45056
    s_waitcnt vmcnt(8)
    s_barrier
    ds_read_b64_tr_b16 a[112:113], v10 offset:49152
    ds_read_b64_tr_b16 a[114:115], v10 offset:53248
    ds_read_b64_tr_b16 a[116:117], v11 offset:49152
    ds_read_b64_tr_b16 a[118:119], v11 offset:53248
    ds_read_b64_tr_b16 a[120:121], v10 offset:57344
    ds_read_b64_tr_b16 a[122:123], v10 offset:61440
    ds_read_b64_tr_b16 a[124:125], v11 offset:57344
    ds_read_b64_tr_b16 a[126:127], v11 offset:61440
    v_add_u32 v10, 131072, v6
    v_xor_b32 v11, 32, v10
    s_waitcnt vmcnt(4)
    s_barrier
    ds_read_b64_tr_b16 a[128:129], v10 offset:0
    ds_read_b64_tr_b16 a[130:131], v10 offset:4096
    ds_read_b64_tr_b16 a[132:133], v11 offset:0
    ds_read_b64_tr_b16 a[134:135], v11 offset:4096
    ds_read_b64_tr_b16 a[136:137], v10 offset:8192
    ds_read_b64_tr_b16 a[138:139], v10 offset:12288
    ds_read_b64_tr_b16 a[140:141], v11 offset:8192
    ds_read_b64_tr_b16 a[142:143], v11 offset:12288
    s_waitcnt vmcnt(0)
    s_barrier
    ds_read_b64_tr_b16 a[144:145], v10 offset:16384
    ds_read_b64_tr_b16 a[146:147], v10 offset:20480
    ds_read_b64_tr_b16 a[148:149], v11 offset:16384
    ds_read_b64_tr_b16 a[150:151], v11 offset:20480
    ds_read_b64_tr_b16 a[152:153], v10 offset:24576
    ds_read_b64_tr_b16 a[154:155], v10 offset:28672
    ds_read_b64_tr_b16 a[156:157], v11 offset:24576
    ds_read_b64_tr_b16 a[158:159], v11 offset:28672
    s_waitcnt lgkmcnt(0)
    s_barrier
    s_add_u32 m0, s42, 0
    s_nop 0
    buffer_load_dwordx4 v8, s[8:11], s20 offen lds
    s_add_u32 s20, s20, 5120
    s_add_u32 m0, s42, 1024
    s_nop 0
    buffer_load_dwordx4 v9, s[8:11], s20 offen lds
    s_add_u32 s20, s20, 5120
    s_add_u32 m0, s42, 2048
    s_nop 0
    buffer_load_dwordx4 v8, s[8:11], s20 offen lds
    s_add_u32 s20, s20, 5120
    s_add_u32 m0, s42, 3072
    s_nop 0
    buffer_load_dwordx4 v9, s[8:11], s20 offen lds
    s_add_u32 s20, s20, 66560
    s_add_u32 m0, s42, 16384
    s_nop 0
    buffer_load_dwordx4 v8, s[8:11], s20 offen lds
    s_add_u32 s20, s20, 5120
    s_add_u32 m0, s42, 17408
    s_nop 0
    buffer_load_dwordx4 v9, s[8:11], s20 offen lds
    s_add_u32 s20, s20, 5120
    s_add_u32 m0, s42, 18432
    s_nop 0
    buffer_load_dwordx4 v8, s[8:11], s20 offen lds
    s_add_u32 s20, s20, 5120
    s_add_u32 m0, s42, 19456
    s_nop 0
    buffer_load_dwordx4 v9, s[8:11], s20 offen lds
    s_add_u32 s20, s20, 66560
    s_add_u32 m0, s42, 32768
    s_nop 0
    buffer_load_dwordx4 v8, s[8:11], s20 offen lds
    s_add_u32 s20, s20, 5120
    s_add_u32 m0, s42, 33792
    s_nop 0
    buffer_load_dwordx4 v9, s[8:11], s20 offen lds
    s_add_u32 s20, s20, 5120
    s_add_u32 m0, s42, 34816
    s_nop 0
    buffer_load_dwordx4 v8, s[8:11], s20 offen lds
    s_add_u32 s20, s20, 5120
    s_add_u32 m0, s42, 35840
    s_nop 0
    buffer_load_dwordx4 v9, s[8:11], s20 offen lds
    s_add_u32 s20, s20, 66560
    s_add_u32 m0, s42, 49152
    s_nop 0
    buffer_load_dwordx4 v8, s[8:11], s20 offen lds
    s_add_u32 s20, s20, 5120
    s_add_u32 m0, s42, 50176
    s_nop 0
    buffer_load_dwordx4 v9, s[8:11], s20 offen lds
    s_add_u32 s20, s20, 5120
    s_add_u32 m0, s42, 51200
    s_nop 0
    buffer_load_dwordx4 v8, s[8:11], s20 offen lds
    s_add_u32 s20, s20, 5120
    s_add_u32 m0, s42, 52224
    s_nop 0
    buffer_load_dwordx4 v9, s[8:11], s20 offen lds
    s_add_u32 s20, s20, 66560
    s_add_u32 m0, s42, 65536
    s_nop 0
    buffer_load_dwordx4 v8, s[8:11], s20 offen lds
    s_add_u32 s20, s20, 5120
    s_add_u32 m0, s42, 66560
    s_nop 0
    buffer_load_dwordx4 v9, s[8:11], s20 offen lds
    s_add_u32 s20, s20, 5120
    s_add_u32 m0, s42, 67584
    s_nop 0
    buffer_load_dwordx4 v8, s[8:11], s20 offen lds
    s_add_u32 s20, s20, 5120
    s_add_u32 m0, s42, 68608
    s_nop 0
    buffer_load_dwordx4 v9, s[8:11], s20 offen lds
    s_add_u32 s20, s20, 66560
    s_add_u32 m0, s42, 81920
    s_nop 0
    buffer_load_dwordx4 v8, s[8:11], s20 offen lds
    s_add_u32 s20, s20, 5120
    s_add_u32 m0, s42, 82944
    s_nop 0
    buffer_load_dwordx4 v9, s[8:11], s20 offen lds
    s_add_u32 s20, s20, 5120
    s_add_u32 m0, s42, 83968
    s_nop 0
    buffer_load_dwordx4 v8, s[8:11], s20 offen lds
    s_add_u32 s20, s20, 5120
    s_add_u32 m0, s42, 84992
    s_nop 0
    buffer_load_dwordx4 v9, s[8:11], s20 offen lds
    s_add_u32 s20, s20, 66560
    v_add_u32 v10, 0, v6
    v_xor_b32 v11, 32, v10
    s_waitcnt vmcnt(20)
    s_barrier
    ds_read_b64_tr_b16 a[160:161], v10 offset:0
    ds_read_b64_tr_b16 a[162:163], v10 offset:4096
    ds_read_b64_tr_b16 a[164:165], v11 offset:0
    ds_read_b64_tr_b16 a[166:167], v11 offset:4096
    ds_read_b64_tr_b16 a[168:169], v10 offset:8192
    ds_read_b64_tr_b16 a[170:171], v10 offset:12288
    ds_read_b64_tr_b16 a[172:173], v11 offset:8192
    ds_read_b64_tr_b16 a[174:175], v11 offset:12288
    s_waitcnt vmcnt(16)
    s_barrier
    ds_read_b64_tr_b16 a[176:177], v10 offset:16384
    ds_read_b64_tr_b16 a[178:179], v10 offset:20480
    ds_read_b64_tr_b16 a[180:181], v11 offset:16384
    ds_read_b64_tr_b16 a[182:183], v11 offset:20480
    ds_read_b64_tr_b16 a[184:185], v10 offset:24576
    ds_read_b64_tr_b16 a[186:187], v10 offset:28672
    ds_read_b64_tr_b16 a[188:189], v11 offset:24576
    ds_read_b64_tr_b16 a[190:191], v11 offset:28672
    s_waitcnt vmcnt(12)
    s_barrier
    ds_read_b64_tr_b16 a[192:193], v10 offset:32768
    ds_read_b64_tr_b16 a[194:195], v10 offset:36864
    ds_read_b64_tr_b16 a[196:197], v11 offset:32768
    ds_read_b64_tr_b16 a[198:199], v11 offset:36864
    ds_read_b64_tr_b16 a[200:201], v10 offset:40960
    ds_read_b64_tr_b16 a[202:203], v10 offset:45056
    ds_read_b64_tr_b16 a[204:205], v11 offset:40960
    ds_read_b64_tr_b16 a[206:207], v11 offset:45056
    s_waitcnt vmcnt(8)
    s_barrier
    ds_read_b64_tr_b16 a[208:209], v10 offset:49152
    ds_read_b64_tr_b16 a[210:211], v10 offset:53248
    ds_read_b64_tr_b16 a[212:213], v11 offset:49152
    ds_read_b64_tr_b16 a[214:215], v11 offset:53248
    ds_read_b64_tr_b16 a[216:217], v10 offset:57344
    ds_read_b64_tr_b16 a[218:219], v10 offset:61440
    ds_read_b64_tr_b16 a[220:221], v11 offset:57344
    ds_read_b64_tr_b16 a[222:223], v11 offset:61440
    v_add_u32 v10, 65536, v6
    v_xor_b32 v11, 32, v10
    s_waitcnt vmcnt(4)
    s_barrier
    ds_read_b64_tr_b16 a[224:225], v10 offset:0
    ds_read_b64_tr_b16 a[226:227], v10 offset:4096
    ds_read_b64_tr_b16 a[228:229], v11 offset:0
    ds_read_b64_tr_b16 a[230:231], v11 offset:4096
    ds_read_b64_tr_b16 a[232:233], v10 offset:8192
    ds_read_b64_tr_b16 a[234:235], v10 offset:12288
    ds_read_b64_tr_b16 a[236:237], v11 offset:8192
    ds_read_b64_tr_b16 a[238:239], v11 offset:12288
    s_waitcnt vmcnt(0)
    s_barrier
    ds_read_b64_tr_b16 a[240:241], v10 offset:16384
    ds_read_b64_tr_b16 a[242:243], v10 offset:20480
    ds_read_b64_tr_b16 a[244:245], v11 offset:16384
    ds_read_b64_tr_b16 a[246:247], v11 offset:20480
    ds_read_b64_tr_b16 a[248:249], v10 offset:24576
    ds_read_b64_tr_b16 a[250:251], v10 offset:28672
    ds_read_b64_tr_b16 a[252:253], v11 offset:24576
    ds_read_b64_tr_b16 a[254:255], v11 offset:28672
    s_waitcnt lgkmcnt(0)
    s_barrier
    s_mov_b32 s29, 1
    s_branch L_ops
L_rec:
    s_mov_b32 s16, s98
    s_mov_b32 s17, s99
    s_load_dwordx2 s[44:45], s[0:1], 120
    s_load_dwordx2 s[42:43], s[0:1], 112
    v_lshrrev_b32 v1, 6, v0
    s_nop 0
    v_readfirstlane_b32 s18, v1
    v_and_b32 v0, 63, v0
    s_waitcnt lgkmcnt(0)
    s_mov_b32 s4, s44
    s_mov_b32 s5, s45
    s_mov_b32 s6, 0x10000000
    s_mov_b32 s7, 0x20000
    s_mov_b32 s12, s42
    s_mov_b32 s13, s43
    s_mov_b32 s14, 0x100
    s_mov_b32 s15, 0x20000
    s_mov_b32 s46, 0
    v_lshrrev_b32 v20, 4, v0
    v_bfe_u32 v21, v0, 2, 2
    v_and_b32 v22, 3, v0
    v_and_b32 v11, 8, v0
    v_cmp_eq_u32 vcc, 0, v11
    v_mov_b32 v11, 0xeeee
    v_mov_b32 v10, 0x4444
    v_cndmask_b32 v1, v11, v10, vcc
    s_mul_i32 s41, s18, 34816
    v_lshlrev_b32 v11, 4, v0
    v_add_u32 v2, s41, v11
    v_add_u32 v3, 139264, v11
    v_lshrrev_b32 v11, 5, v0
    v_lshlrev_b32 v11, 8, v11
    v_and_b32 v10, 15, v0
    v_lshl_add_u32 v11, v10, 4, v11
    v_and_b32 v10, 1, v20
    v_lshl_add_u32 v11, v10, 3, v11
    s_lshl_b32 s41, s18, 9
    s_add_u32 s41, s41, 149504
    v_add_u32 v4, s41, v11
    v_lshlrev_b32 v11, 6, v20
    v_lshl_add_u32 v11, v21, 4, v11
    v_and_b32 v10, 1, v22
    v_lshl_add_u32 v11, v10, 3, v11
    v_add_u32 v5, 149504, v11
    v_and_b32 v23, 7, v0
    v_lshrrev_b32 v11, 1, v20
    s_lshl_b32 s41, s18, 2
    v_add_u32 v11, s41, v11
    v_xor_b32 v11, v11, v23
    v_lshlrev_b32 v11, 4, v11
    v_lshl_add_u32 v11, v23, 8, v11
    v_and_b32 v10, 1, v20
    v_lshl_add_u32 v11, v10, 3, v11
    v_add_u32 v6, 153600, v11
    v_bfe_u32 v11, v0, 3, 1
    v_lshl_add_u32 v11, v20, 1, v11
    v_xor_b32 v11, v11, v23
    v_lshlrev_b32 v11, 4, v11
    v_lshl_add_u32 v11, v23, 8, v11
    v_add_u32 v7, 153600, v11
    v_and_b32 v11, 1, v20
    v_lshlrev_b32 v11, 1, v11
    v_lshrrev_b32 v10, 1, v20
    v_add_u32 v11, v11, v10
    v_lshlrev_b32 v11, 1, v11
    v_bfe_u32 v10, v0, 3, 1
    v_add_u32 v11, v11, v10
    v_lshlrev_b32 v11, 12, v11
    v_lshl_add_u32 v8, v23, 4, v11
    s_lshl_b32 s96, s16, 2
    s_add_u32 s96, s96, s18
    s_mov_b32 s76, 0x3f803f80
    s_mov_b32 s77, 0x3f803f80
    s_mov_b32 s78, 0x3f003f00
    s_mov_b32 s79, 0x3f003f00
    s_mov_b32 s72, 0
    s_mul_i32 s73, s18, 1280
    s_add_u32 s74, s73, 140288
    s_lshl_b32 s75, s18, 9
    s_mov_b32 s44, 0x00ff00ff
    s_mov_b32 s45, 0x00ff00ff
    s_mov_b32 s34, -1
    s_mov_b32 s35, 0
    s_mov_b32 s36, 0x00ff00ff
    s_mov_b32 s37, 0x00ff00ff
    s_mov_b32 s32, 0xfffffffe
    s_mov_b32 s33, 0x3e0293ee
    s_mul_i32 s47, s18, 34816
    s_mul_i32 s41, s16, 5120
    s_add_u32 s21, s41, 0xde000
    s_xor_b32 s41, s16, 1
    s_lshl_b32 s41, s41, 14
    s_add_u32 s22, s41, 0x1de000
    s_mul_i32 s41, s16, 163840
    s_add_u32 s41, s41, 0x400000
    s_mul_i32 s42, s18, 40960
    s_add_u32 s23, s41, s42
    s_lshl_b32 s42, s17, 7
    s_add_u32 s23, s23, s42
    s_add_u32 s24, s23, 32768
    s_lshl_b32 s31, s18, 5
    s_add_u32 s31, s31, s17
    s_min_u32 s43, s31, 39
    s_lshl_b32 s42, s43, 12
    s_add_u32 s26, s41, s42
    s_sub_u32 s26, s26, s47
    s_lshl_b32 s42, s43, 7
    s_lshl_b32 s41, s16, 14
    s_add_u32 s27, s41, s42
    s_add_u32 s27, s27, 0x208000
    s_mul_i32 s41, s16, 5120
    s_add_u32 s28, s41, s42
    s_add_u32 s28, s28, 0x102800
    s_lshl_b32 s41, s17, 13
    s_lshl_b32 s42, s18, 11
    s_add_u32 s41, s41, s42
    s_sub_u32 s41, s41, s47
    s_add_u32 s29, s41, 0x1100000
    s_add_u32 s30, s41, 0x2100000
    s_lshl_b32 s41, s17, 12
    s_lshl_b32 s42, s18, 10
    s_add_u32 s41, s41, s42
    s_sub_u32 s41, s41, s47
    s_add_u32 s38, s41, 0x7400000
    s_mul_i32 s41, s16, 0x6b00000
    s_sub_u32 s38, s38, s41
    s_sub_u32 s94, 0, s16
    s_mov_b32 s95, s94
    s_cmp_lg_u32 s18, 0
    s_cbranch_scc1 L_ann_191
    s_mov_b32 s54, 0
L_nocal_192:
    s_getreg_b32 s41, hwreg(HW_REG_XCC_ID)
    s_and_b32 s41, s41, 15
    s_mul_i32 s42, s41, s41
    s_lshl_b32 s42, s42, 16
    s_lshl_b32 s41, s41, 6
    s_add_u32 s41, s41, s42
    s_add_u32 s41, s41, 1
    s_add_u32 s41, s41, s54
    v_mov_b32 v11, s41
    s_lshl_b32 s42, s16, 2
    s_mov_b64 exec, 1
    buffer_atomic_add v11, off, s[12:15], s42 offset:128 sc1
    s_mov_b64 exec, -1
L_ann_191:
    v_and_b32 v11, 1, v20
    v_or_b32 v11, 0, v11
    v_lshlrev_b32 v11, 1, v11
    v_and_b32 v10, 15, v0
    v_xor_b32 v11, v11, v10
    v_lshlrev_b32 v11, 4, v11
    v_lshl_add_u32 v12, v20, 13, v11
    v_and_b32 v11, 1, v20
    v_or_b32 v11, 2, v11
    v_lshlrev_b32 v11, 1, v11
    v_and_b32 v10, 15, v0
    v_xor_b32 v11, v11, v10
    v_lshlrev_b32 v11, 4, v11
    v_lshl_add_u32 v13, v20, 13, v11
    v_and_b32 v11, 1, v20
    v_or_b32 v11, 4, v11
    v_lshlrev_b32 v11, 1, v11
    v_and_b32 v10, 15, v0
    v_xor_b32 v11, v11, v10
    v_lshlrev_b32 v11, 4, v11
    v_lshl_add_u32 v14, v20, 13, v11
    v_and_b32 v11, 1, v20
    v_or_b32 v11, 6, v11
    v_lshlrev_b32 v11, 1, v11
    v_and_b32 v10, 15, v0
    v_xor_b32 v11, v11, v10
    v_lshlrev_b32 v11, 4, v11
    v_lshl_add_u32 v15, v20, 13, v11
    v_and_b32 v11, 1, v21
    v_and_b32 v10, 1, v20
    v_lshl_add_u32 v24, v10, 1, v11
    v_lshl_add_u32 v11, v10, 2, v11
    v_lshrrev_b32 v10, 1, v21
    v_lshl_add_u32 v24, v10, 2, v24
    v_lshl_add_u32 v11, v10, 3, v11
    v_lshlrev_b32 v11, 8, v11
    v_lshrrev_b32 v10, 1, v20
    v_mul_u32_u24 v10, 34816, v10
    v_add_u32 v11, v11, v10
    v_and_b32 v10, 1, v22
    v_lshl_add_u32 v11, v10, 3, v11
    v_lshlrev_b32 v24, 1, v24
    v_lshrrev_b32 v10, 1, v22
    s_lshl_b32 s41, s18, 2
    v_or_b32 v10, s41, v10
    v_xor_b32 v10, v10, v24
    v_lshl_add_u32 v16, v10, 4, v11
    v_xor_b32 v17, 32, v16
    v_add_u32 v18, 69632, v16
    v_add_u32 v19, 69632, v17
    v_lshrrev_b32 v11, 1, v20
    v_lshlrev_b32 v11, 4, v11
    v_and_b32 v10, 1, v20
    v_lshl_add_u32 v11, v10, 2, v11
    v_lshrrev_b32 v10, 1, v21
    v_lshl_add_u32 v11, v10, 3, v11
    v_and_b32 v10, 1, v21
    v_add_u32 v11, v10, v11
    v_lshlrev_b32 v10, 6, v11
    v_lshl_add_u32 v10, v22, 3, v10
    v_add_u32 v25, s47, v10
    v_mul_u32_u24 v11, 160, v11
    v_lshl_add_u32 v11, v22, 3, v11
    v_add_u32 v26, s47, v11
    v_add_u32 v11, 0, v0
    v_mul_u32_u24 v10, 6554, v11
    v_lshrrev_b32 v10, 16, v10
    v_mul_u32_u24 v27, 10, v10
    v_sub_u32 v11, v11, v27
    v_mul_u32_u24 v10, 1280, v10
    v_lshl_add_u32 v27, v11, 4, v10
    v_add_u32 v11, 64, v0
    v_mul_u32_u24 v10, 6554, v11
    v_lshrrev_b32 v10, 16, v10
    v_mul_u32_u24 v28, 10, v10
    v_sub_u32 v11, v11, v28
    v_mul_u32_u24 v10, 1280, v10
    v_lshl_add_u32 v28, v11, 4, v10
    v_add_u32 v11, 128, v0
    v_mul_u32_u24 v10, 6554, v11
    v_lshrrev_b32 v10, 16, v10
    v_mul_u32_u24 v29, 10, v10
    v_sub_u32 v11, v11, v29
    v_mul_u32_u24 v10, 1280, v10
    v_lshl_add_u32 v29, v11, 4, v10
    v_add_u32 v11, 192, v0
    v_mul_u32_u24 v10, 6554, v11
    v_lshrrev_b32 v10, 16, v10
    v_mul_u32_u24 v30, 10, v10
    v_sub_u32 v11, v11, v30
    v_mul_u32_u24 v10, 1280, v10
    v_lshl_add_u32 v30, v11, 4, v10
    v_add_u32 v11, 256, v0
    v_mul_u32_u24 v10, 6554, v11
    v_lshrrev_b32 v10, 16, v10
    v_mul_u32_u24 v31, 10, v10
    v_sub_u32 v11, v11, v31
    v_mul_u32_u24 v10, 1280, v10
    v_lshl_add_u32 v31, v11, 4, v10
    s_load_dwordx2 s[62:63], s[0:1], 16
    s_load_dwordx2 s[64:65], s[0:1], 24
    s_load_dwordx2 s[66:67], s[0:1], 32
    s_load_dwordx2 s[68:69], s[0:1], 40
    s_lshl_b32 s58, s17, 8
    s_lshl_b32 s41, s18, 17
    s_add_u32 s58, s58, s41
    s_waitcnt lgkmcnt(0)
    s_load_dwordx2 s[60:61], s[0:1], 8
    s_waitcnt lgkmcnt(0)
    s_mov_b32 s8, s60
    s_mov_b32 s9, s61
    s_mov_b32 s10, 0x2800
    s_mov_b32 s11, 0x20000
    v_add_u32 v11, 0, v0
    v_min_u32 v11, 159, v11
    s_mul_i32 s41, s18, 160
    v_add_u32 v11, s41, v11
    v_lshrrev_b32 v10, 3, v11
    s_mul_i32 s42, s16, 40
    v_add_u32 v10, s42, v10
    v_subrev_u32 v25, 80, v10
    v_min_u32 v10, v10, v25
    v_lshlrev_b32 v10, 4, v10
    v_and_b32 v25, 7, v11
    v_mul_u32_u24 v25, 1280, v25
    v_add_u32 v10, v10, v25
    v_lshlrev_b32 v11, 4, v11
    v_add_u32 v72, 139264, v11
    buffer_load_dwordx4 v[76:79], v10, s[8:11], 0 offen
    v_add_u32 v11, 64, v0
    v_min_u32 v11, 159, v11
    s_mul_i32 s41, s18, 160
    v_add_u32 v11, s41, v11
    v_lshrrev_b32 v10, 3, v11
    s_mul_i32 s42, s16, 40
    v_add_u32 v10, s42, v10
    v_subrev_u32 v25, 80, v10
    v_min_u32 v10, v10, v25
    v_lshlrev_b32 v10, 4, v10
    v_and_b32 v25, 7, v11
    v_mul_u32_u24 v25, 1280, v25
    v_add_u32 v10, v10, v25
    v_lshlrev_b32 v11, 4, v11
    v_add_u32 v73, 139264, v11
    buffer_load_dwordx4 v[80:83], v10, s[8:11], 0 offen
    v_add_u32 v11, 128, v0
    v_min_u32 v11, 159, v11
    s_mul_i32 s41, s18, 160
    v_add_u32 v11, s41, v11
    v_lshrrev_b32 v10, 3, v11
    s_mul_i32 s42, s16, 40
    v_add_u32 v10, s42, v10
    v_subrev_u32 v25, 80, v10
    v_min_u32 v10, v10, v25
    v_lshlrev_b32 v10, 4, v10
    v_and_b32 v25, 7, v11
    v_mul_u32_u24 v25, 1280, v25
    v_add_u32 v10, v10, v25
    v_lshlrev_b32 v11, 4, v11
    v_add_u32 v74, 139264, v11
    buffer_load_dwordx4 v[84:87], v10, s[8:11], 0 offen
    s_mov_b32 s8, s62
    s_mov_b32 s9, s63
    s_mov_b32 s10, 0x500000
    s_mov_b32 s11, 0x20000
    s_cmp_eq_u32 s16, 0
    s_cselect_b32 s60, 0, 5
    s_lshl_b32 s60, s60, 19
    s_add_u32 s60, s60, s58
    s_add_u32 m0, s47, 0
    s_nop 0
    buffer_load_dwordx4 v12, s[8:11], s60 offen lds
    s_add_u32 s60, s60, 32768
    s_add_u32 m0, s47, 1024
    s_nop 0
    buffer_load_dwordx4 v13, s[8:11], s60 offen lds
    s_add_u32 s60, s60, 32768
    s_add_u32 m0, s47, 2048
    s_nop 0
    buffer_load_dwordx4 v14, s[8:11], s60 offen lds
    s_add_u32 s60, s60, 32768
    s_add_u32 m0, s47, 3072
    s_nop 0
    buffer_load_dwordx4 v15, s[8:11], s60 offen lds
    s_cmp_eq_u32 s16, 0
    s_cselect_b32 s60, 1, 6
    s_lshl_b32 s60, s60, 19
    s_add_u32 s60, s60, s58
    s_add_u32 m0, s47, 4096
    s_nop 0
    buffer_load_dwordx4 v12, s[8:11], s60 offen lds
    s_add_u32 s60, s60, 32768
    s_add_u32 m0, s47, 5120
    s_nop 0
    buffer_load_dwordx4 v13, s[8:11], s60 offen lds
    s_add_u32 s60, s60, 32768
    s_add_u32 m0, s47, 6144
    s_nop 0
    buffer_load_dwordx4 v14, s[8:11], s60 offen lds
    s_add_u32 s60, s60, 32768
    s_add_u32 m0, s47, 7168
    s_nop 0
    buffer_load_dwordx4 v15, s[8:11], s60 offen lds
    s_cmp_eq_u32 s16, 0
    s_cselect_b32 s60, 2, 7
    s_lshl_b32 s60, s60, 19
    s_add_u32 s60, s60, s58
    s_add_u32 m0, s47, 8192
    s_nop 0
    buffer_load_dwordx4 v12, s[8:11], s60 offen lds
    s_add_u32 s60, s60, 32768
    s_add_u32 m0, s47, 9216
    s_nop 0
    buffer_load_dwordx4 v13, s[8:11], s60 offen lds
    s_add_u32 s60, s60, 32768
    s_add_u32 m0, s47, 10240
    s_nop 0
    buffer_load_dwordx4 v14, s[8:11], s60 offen lds
    s_add_u32 s60, s60, 32768
    s_add_u32 m0, s47, 11264
    s_nop 0
    buffer_load_dwordx4 v15, s[8:11], s60 offen lds
    s_cmp_eq_u32 s16, 0
    s_cselect_b32 s60, 3, 8
    s_lshl_b32 s60, s60, 19
    s_add_u32 s60, s60, s58
    s_add_u32 m0, s47, 12288
    s_nop 0
    buffer_load_dwordx4 v12, s[8:11], s60 offen lds
    s_add_u32 s60, s60, 32768
    s_add_u32 m0, s47, 13312
    s_nop 0
    buffer_load_dwordx4 v13, s[8:11], s60 offen lds
    s_add_u32 s60, s60, 32768
    s_add_u32 m0, s47, 14336
    s_nop 0
    buffer_load_dwordx4 v14, s[8:11], s60 offen lds
    s_add_u32 s60, s60, 32768
    s_add_u32 m0, s47, 15360
    s_nop 0
    buffer_load_dwordx4 v15, s[8:11], s60 offen lds
    s_cmp_eq_u32 s16, 0
    s_cselect_b32 s60, 4, 9
    s_lshl_b32 s60, s60, 19
    s_add_u32 s60, s60, s58
    s_add_u32 m0, s47, 16384
    s_nop 0
    buffer_load_dwordx4 v12, s[8:11], s60 offen lds
    s_add_u32 s60, s60, 32768
    s_add_u32 m0, s47, 17408
    s_nop 0
    buffer_load_dwordx4 v13, s[8:11], s60 offen lds
    s_add_u32 s60, s60, 32768
    s_add_u32 m0, s47, 18432
    s_nop 0
    buffer_load_dwordx4 v14, s[8:11], s60 offen lds
    s_add_u32 s60, s60, 32768
    s_add_u32 m0, s47, 19456
    s_nop 0
    buffer_load_dwordx4 v15, s[8:11], s60 offen lds
    s_cmp_eq_u32 s16, 0
    s_cselect_b32 s60, 5, 0
    s_lshl_b32 s60, s60, 19
    s_add_u32 s60, s60, s58
    s_add_u32 m0, s47, 20480
    s_nop 0
    buffer_load_dwordx4 v12, s[8:11], s60 offen lds
    s_add_u32 s60, s60, 32768
    s_add_u32 m0, s47, 21504
    s_nop 0
    buffer_load_dwordx4 v13, s[8:11], s60 offen lds
    s_add_u32 s60, s60, 32768
    s_add_u32 m0, s47, 22528
    s_nop 0
    buffer_load_dwordx4 v14, s[8:11], s60 offen lds
    s_add_u32 s60, s60, 32768
    s_add_u32 m0, s47, 23552
    s_nop 0
    buffer_load_dwordx4 v15, s[8:11], s60 offen lds
    s_cmp_eq_u32 s16, 0
    s_cselect_b32 s60, 6, 1
    s_lshl_b32 s60, s60, 19
    s_add_u32 s60, s60, s58
    s_add_u32 m0, s47, 24576
    s_nop 0
    buffer_load_dwordx4 v12, s[8:11], s60 offen lds
    s_add_u32 s60, s60, 32768
    s_add_u32 m0, s47, 25600
    s_nop 0
    buffer_load_dwordx4 v13, s[8:11], s60 offen lds
    s_add_u32 s60, s60, 32768
    s_add_u32 m0, s47, 26624
    s_nop 0
    buffer_load_dwordx4 v14, s[8:11], s60 offen lds
    s_add_u32 s60, s60, 32768
    s_add_u32 m0, s47, 27648
    s_nop 0
    buffer_load_dwordx4 v15, s[8:11], s60 offen lds
    s_cmp_eq_u32 s16, 0
    s_cselect_b32 s60, 7, 2
    s_lshl_b32 s60, s60, 19
    s_add_u32 s60, s60, s58
    s_add_u32 m0, s47, 28672
    s_nop 0
    buffer_load_dwordx4 v12, s[8:11], s60 offen lds
    s_add_u32 s60, s60, 32768
    s_add_u32 m0, s47, 29696
    s_nop 0
    buffer_load_dwordx4 v13, s[8:11], s60 offen lds
    s_add_u32 s60, s60, 32768
    s_add_u32 m0, s47, 30720
    s_nop 0
    buffer_load_dwordx4 v14, s[8:11], s60 offen lds
    s_add_u32 s60, s60, 32768
    s_add_u32 m0, s47, 31744
    s_nop 0
    buffer_load_dwordx4 v15, s[8:11], s60 offen lds
    s_waitcnt vmcnt(32)
    ds_write_b128 v72, v[76:79]
    ds_write_b128 v73, v[80:83]
    ds_write_b128 v74, v[84:87]
    s_waitcnt vmcnt(28)
    s_barrier
    ds_read_b64_tr_b16 a[0:1], v16 offset:0
    ds_read_b64_tr_b16 a[2:3], v16 offset:512
    ds_read_b64_tr_b16 a[4:5], v18 offset:0
    ds_read_b64_tr_b16 a[6:7], v18 offset:512
    ds_read_b64_tr_b16 a[8:9], v17 offset:0
    ds_read_b64_tr_b16 a[10:11], v17 offset:512
    ds_read_b64_tr_b16 a[12:13], v19 offset:0
    ds_read_b64_tr_b16 a[14:15], v19 offset:512
    s_waitcnt lgkmcnt(0)
    s_barrier
    s_waitcnt lgkmcnt(0)
    s_cmp_eq_u32 s16, 0
    s_cselect_b32 s60, 8, 3
    s_lshl_b32 s60, s60, 19
    s_add_u32 s60, s60, s58
    s_add_u32 m0, s47, 0
    s_nop 0
    buffer_load_dwordx4 v12, s[8:11], s60 offen lds
    s_add_u32 s60, s60, 32768
    s_add_u32 m0, s47, 1024
    s_nop 0
    buffer_load_dwordx4 v13, s[8:11], s60 offen lds
    s_add_u32 s60, s60, 32768
    s_add_u32 m0, s47, 2048
    s_nop 0
    buffer_load_dwordx4 v14, s[8:11], s60 offen lds
    s_add_u32 s60, s60, 32768
    s_add_u32 m0, s47, 3072
    s_nop 0
    buffer_load_dwordx4 v15, s[8:11], s60 offen lds
    s_waitcnt vmcnt(28)
    s_barrier
    ds_read_b64_tr_b16 a[16:17], v16 offset:4096
    ds_read_b64_tr_b16 a[18:19], v16 offset:4608
    ds_read_b64_tr_b16 a[20:21], v18 offset:4096
    ds_read_b64_tr_b16 a[22:23], v18 offset:4608
    ds_read_b64_tr_b16 a[24:25], v17 offset:4096
    ds_read_b64_tr_b16 a[26:27], v17 offset:4608
    ds_read_b64_tr_b16 a[28:29], v19 offset:4096
    ds_read_b64_tr_b16 a[30:31], v19 offset:4608
    s_waitcnt lgkmcnt(0)
    s_barrier
    s_waitcnt lgkmcnt(0)
    s_cmp_eq_u32 s16, 0
    s_cselect_b32 s60, 9, 4
    s_lshl_b32 s60, s60, 19
    s_add_u32 s60, s60, s58
    s_add_u32 m0, s47, 4096
    s_nop 0
    buffer_load_dwordx4 v12, s[8:11], s60 offen lds
    s_add_u32 s60, s60, 32768
    s_add_u32 m0, s47, 5120
    s_nop 0
    buffer_load_dwordx4 v13, s[8:11], s60 offen lds
    s_add_u32 s60, s60, 32768
    s_add_u32 m0, s47, 6144
    s_nop 0
    buffer_load_dwordx4 v14, s[8:11], s60 offen lds
    s_add_u32 s60, s60, 32768
    s_add_u32 m0, s47, 7168
    s_nop 0
    buffer_load_dwordx4 v15, s[8:11], s60 offen lds
    s_waitcnt vmcnt(28)
    s_barrier
    ds_read_b64_tr_b16 a[32:33], v16 offset:8192
    ds_read_b64_tr_b16 a[34:35], v16 offset:8704
    ds_read_b64_tr_b16 a[36:37], v18 offset:8192
    ds_read_b64_tr_b16 a[38:39], v18 offset:8704
    ds_read_b64_tr_b16 a[40:41], v17 offset:8192
    ds_read_b64_tr_b16 a[42:43], v17 offset:8704
    ds_read_b64_tr_b16 a[44:45], v19 offset:8192
    ds_read_b64_tr_b16 a[46:47], v19 offset:8704
    s_waitcnt lgkmcnt(0)
    s_barrier
    s_waitcnt lgkmcnt(0)
    s_mov_b32 s8, s64
    s_mov_b32 s9, s65
    s_mov_b32 s10, 0x500000
    s_mov_b32 s11, 0x20000
    s_cmp_eq_u32 s16, 0
    s_cselect_b32 s60, 0, 5
    s_lshl_b32 s60, s60, 19
    s_add_u32 s60, s60, s58
    s_add_u32 m0, s47, 8192
    s_nop 0
    buffer_load_dwordx4 v12, s[8:11], s60 offen lds
    s_add_u32 s60, s60, 32768
    s_add_u32 m0, s47, 9216
    s_nop 0
    buffer_load_dwordx4 v13, s[8:11], s60 offen lds
    s_add_u32 s60, s60, 32768
    s_add_u32 m0, s47, 10240
    s_nop 0
    buffer_load_dwordx4 v14, s[8:11], s60 offen lds
    s_add_u32 s60, s60, 32768
    s_add_u32 m0, s47, 11264
    s_nop 0
    buffer_load_dwordx4 v15, s[8:11], s60 offen lds
    s_waitcnt vmcnt(28)
    s_barrier
    ds_read_b64_tr_b16 a[48:49], v16 offset:12288
    ds_read_b64_tr_b16 a[50:51], v16 offset:12800
    ds_read_b64_tr_b16 a[52:53], v18 offset:12288
    ds_read_b64_tr_b16 a[54:55], v18 offset:12800
    ds_read_b64_tr_b16 a[56:57], v17 offset:12288
    ds_read_b64_tr_b16 a[58:59], v17 offset:12800
    ds_read_b64_tr_b16 a[60:61], v19 offset:12288
    ds_read_b64_tr_b16 a[62:63], v19 offset:12800
    s_waitcnt lgkmcnt(0)
    s_barrier
    s_waitcnt lgkmcnt(0)
    s_cmp_eq_u32 s16, 0
    s_cselect_b32 s60, 1, 6
    s_lshl_b32 s60, s60, 19
    s_add_u32 s60, s60, s58
    s_add_u32 m0, s47, 12288
    s_nop 0
    buffer_load_dwordx4 v12, s[8:11], s60 offen lds
    s_add_u32 s60, s60, 32768
    s_add_u32 m0, s47, 13312
    s_nop 0
    buffer_load_dwordx4 v13, s[8:11], s60 offen lds
    s_add_u32 s60, s60, 32768
    s_add_u32 m0, s47, 14336
    s_nop 0
    buffer_load_dwordx4 v14, s[8:11], s60 offen lds
    s_add_u32 s60, s60, 32768
    s_add_u32 m0, s47, 15360
    s_nop 0
    buffer_load_dwordx4 v15, s[8:11], s60 offen lds
    s_waitcnt vmcnt(28)
    s_barrier
    ds_read_b64_tr_b16 a[64:65], v16 offset:16384
    ds_read_b64_tr_b16 a[66:67], v16 offset:16896
    ds_read_b64_tr_b16 a[68:69], v18 offset:16384
    ds_read_b64_tr_b16 a[70:71], v18 offset:16896
    ds_read_b64_tr_b16 a[72:73], v17 offset:16384
    ds_read_b64_tr_b16 a[74:75], v17 offset:16896
    ds_read_b64_tr_b16 a[76:77], v19 offset:16384
    ds_read_b64_tr_b16 a[78:79], v19 offset:16896
    s_waitcnt lgkmcnt(0)
    s_barrier
    s_waitcnt lgkmcnt(0)
    s_cmp_eq_u32 s16, 0
    s_cselect_b32 s60, 2, 7
    s_lshl_b32 s60, s60, 19
    s_add_u32 s60, s60, s58
    s_add_u32 m0, s47, 16384
    s_nop 0
    buffer_load_dwordx4 v12, s[8:11], s60 offen lds
    s_add_u32 s60, s60, 32768
    s_add_u32 m0, s47, 17408
    s_nop 0
    buffer_load_dwordx4 v13, s[8:11], s60 offen lds
    s_add_u32 s60, s60, 32768
    s_add_u32 m0, s47, 18432
    s_nop 0
    buffer_load_dwordx4 v14, s[8:11], s60 offen lds
    s_add_u32 s60, s60, 32768
    s_add_u32 m0, s47, 19456
    s_nop 0
    buffer_load_dwordx4 v15, s[8:11], s60 offen lds
    s_waitcnt vmcnt(28)
    s_barrier
    ds_read_b64_tr_b16 a[80:81], v16 offset:20480
    ds_read_b64_tr_b16 a[82:83], v16 offset:20992
    ds_read_b64_tr_b16 a[84:85], v18 offset:20480
    ds_read_b64_tr_b16 a[86:87], v18 offset:20992
    ds_read_b64_tr_b16 a[88:89], v17 offset:20480
    ds_read_b64_tr_b16 a[90:91], v17 offset:20992
    ds_read_b64_tr_b16 a[92:93], v19 offset:20480
    ds_read_b64_tr_b16 a[94:95], v19 offset:20992
    s_waitcnt lgkmcnt(0)
    s_barrier
    s_waitcnt lgkmcnt(0)
    s_cmp_eq_u32 s16, 0
    s_cselect_b32 s60, 3, 8
    s_lshl_b32 s60, s60, 19
    s_add_u32 s60, s60, s58
    s_add_u32 m0, s47, 20480
    s_nop 0
    buffer_load_dwordx4 v12, s[8:11], s60 offen lds
    s_add_u32 s60, s60, 32768
    s_add_u32 m0, s47, 21504
    s_nop 0
    buffer_load_dwordx4 v13, s[8:11], s60 offen lds
    s_add_u32 s60, s60, 32768
    s_add_u32 m0, s47, 22528
    s_nop 0
    buffer_load_dwordx4 v14, s[8:11], s60 offen lds
    s_add_u32 s60, s60, 32768
    s_add_u32 m0, s47, 23552
    s_nop 0
    buffer_load_dwordx4 v15, s[8:11], s60 offen lds
    s_waitcnt vmcnt(28)
    s_barrier
    ds_read_b64_tr_b16 a[96:97], v16 offset:24576
    ds_read_b64_tr_b16 a[98:99], v16 offset:25088
    ds_read_b64_tr_b16 a[100:101], v18 offset:24576
    ds_read_b64_tr_b16 a[102:103], v18 offset:25088
    ds_read_b64_tr_b16 a[104:105], v17 offset:24576
    ds_read_b64_tr_b16 a[106:107], v17 offset:25088
    ds_read_b64_tr_b16 a[108:109], v19 offset:24576
    ds_read_b64_tr_b16 a[110:111], v19 offset:25088
    s_waitcnt lgkmcnt(0)
    s_barrier
    s_waitcnt lgkmcnt(0)
    s_cmp_eq_u32 s16, 0
    s_cselect_b32 s60, 4, 9
    s_lshl_b32 s60, s60, 19
    s_add_u32 s60, s60, s58
    s_add_u32 m0, s47, 24576
    s_nop 0
    buffer_load_dwordx4 v12, s[8:11], s60 offen lds
    s_add_u32 s60, s60, 32768
    s_add_u32 m0, s47, 25600
    s_nop 0
    buffer_load_dwordx4 v13, s[8:11], s60 offen lds
    s_add_u32 s60, s60, 32768
    s_add_u32 m0, s47, 26624
    s_nop 0
    buffer_load_dwordx4 v14, s[8:11], s60 offen lds
    s_add_u32 s60, s60, 32768
    s_add_u32 m0, s47, 27648
    s_nop 0
    buffer_load_dwordx4 v15, s[8:11], s60 offen lds
    s_waitcnt vmcnt(28)
    s_barrier
    ds_read_b64_tr_b16 a[112:113], v16 offset:28672
    ds_read_b64_tr_b16 a[114:115], v16 offset:29184
    ds_read_b64_tr_b16 a[116:117], v18 offset:28672
    ds_read_b64_tr_b16 a[118:119], v18 offset:29184
    ds_read_b64_tr_b16 a[120:121], v17 offset:28672
    ds_read_b64_tr_b16 a[122:123], v17 offset:29184
    ds_read_b64_tr_b16 a[124:125], v19 offset:28672
    ds_read_b64_tr_b16 a[126:127], v19 offset:29184
    s_waitcnt lgkmcnt(0)
    s_barrier
    s_waitcnt lgkmcnt(0)
    s_cmp_eq_u32 s16, 0
    s_cselect_b32 s60, 5, 0
    s_lshl_b32 s60, s60, 19
    s_add_u32 s60, s60, s58
    s_add_u32 m0, s47, 28672
    s_nop 0
    buffer_load_dwordx4 v12, s[8:11], s60 offen lds
    s_add_u32 s60, s60, 32768
    s_add_u32 m0, s47, 29696
    s_nop 0
    buffer_load_dwordx4 v13, s[8:11], s60 offen lds
    s_add_u32 s60, s60, 32768
    s_add_u32 m0, s47, 30720
    s_nop 0
    buffer_load_dwordx4 v14, s[8:11], s60 offen lds
    s_add_u32 s60, s60, 32768
    s_add_u32 m0, s47, 31744
    s_nop 0
    buffer_load_dwordx4 v15, s[8:11], s60 offen lds
    s_waitcnt vmcnt(28)
    s_barrier
    ds_read_b64_tr_b16 a[128:129], v16 offset:0
    ds_read_b64_tr_b16 a[130:131], v16 offset:512
    ds_read_b64_tr_b16 a[132:133], v18 offset:0
    ds_read_b64_tr_b16 a[134:135], v18 offset:512
    ds_read_b64_tr_b16 a[136:137], v17 offset:0
    ds_read_b64_tr_b16 a[138:139], v17 offset:512
    ds_read_b64_tr_b16 a[140:141], v19 offset:0
    ds_read_b64_tr_b16 a[142:143], v19 offset:512
    s_waitcnt lgkmcnt(0)
    s_barrier
    s_waitcnt lgkmcnt(0)
    s_cmp_eq_u32 s16, 0
    s_cselect_b32 s60, 6, 1
    s_lshl_b32 s60, s60, 19
    s_add_u32 s60, s60, s58
    s_add_u32 m0, s47, 0
    s_nop 0
    buffer_load_dwordx4 v12, s[8:11], s60 offen lds
    s_add_u32 s60, s60, 32768
    s_add_u32 m0, s47, 1024
    s_nop 0
    buffer_load_dwordx4 v13, s[8:11], s60 offen lds
    s_add_u32 s60, s60, 32768
    s_add_u32 m0, s47, 2048
    s_nop 0
    buffer_load_dwordx4 v14, s[8:11], s60 offen lds
    s_add_u32 s60, s60, 32768
    s_add_u32 m0, s47, 3072
    s_nop 0
    buffer_load_dwordx4 v15, s[8:11], s60 offen lds
    s_waitcnt vmcnt(28)
    s_barrier
    ds_read_b64_tr_b16 a[144:145], v16 offset:4096
    ds_read_b64_tr_b16 a[146:147], v16 offset:4608
    ds_read_b64_tr_b16 a[148:149], v18 offset:4096
    ds_read_b64_tr_b16 a[150:151], v18 offset:4608
    ds_read_b64_tr_b16 a[152:153], v17 offset:4096
    ds_read_b64_tr_b16 a[154:155], v17 offset:4608
    ds_read_b64_tr_b16 a[156:157], v19 offset:4096
    ds_read_b64_tr_b16 a[158:159], v19 offset:4608
    s_waitcnt lgkmcnt(0)
    s_barrier
    s_waitcnt lgkmcnt(0)
    s_cmp_eq_u32 s16, 0
    s_cselect_b32 s60, 7, 2
    s_lshl_b32 s60, s60, 19
    s_add_u32 s60, s60, s58
    s_add_u32 m0, s47, 4096
    s_nop 0
    buffer_load_dwordx4 v12, s[8:11], s60 offen lds
    s_add_u32 s60, s60, 32768
    s_add_u32 m0, s47, 5120
    s_nop 0
    buffer_load_dwordx4 v13, s[8:11], s60 offen lds
    s_add_u32 s60, s60, 32768
    s_add_u32 m0, s47, 6144
    s_nop 0
    buffer_load_dwordx4 v14, s[8:11], s60 offen lds
    s_add_u32 s60, s60, 32768
    s_add_u32 m0, s47, 7168
    s_nop 0
    buffer_load_dwordx4 v15, s[8:11], s60 offen lds
    s_waitcnt vmcnt(28)
    s_barrier
    ds_read_b64_tr_b16 a[160:161], v16 offset:8192
    ds_read_b64_tr_b16 a[162:163], v16 offset:8704
    ds_read_b64_tr_b16 a[164:165], v18 offset:8192
    ds_read_b64_tr_b16 a[166:167], v18 offset:8704
    ds_read_b64_tr_b16 v[32:33], v17 offset:8192
    ds_read_b64_tr_b16 v[34:35], v17 offset:8704
    ds_read_b64_tr_b16 v[36:37], v19 offset:8192
    ds_read_b64_tr_b16 v[38:39], v19 offset:8704
    s_waitcnt lgkmcnt(0)
    s_barrier
    s_waitcnt lgkmcnt(0)
    s_cmp_eq_u32 s16, 0
    s_cselect_b32 s60, 8, 3
    s_lshl_b32 s60, s60, 19
    s_add_u32 s60, s60, s58
    s_add_u32 m0, s47, 8192
    s_nop 0
    buffer_load_dwordx4 v12, s[8:11], s60 offen lds
    s_add_u32 s60, s60, 32768
    s_add_u32 m0, s47, 9216
    s_nop 0
    buffer_load_dwordx4 v13, s[8:11], s60 offen lds
    s_add_u32 s60, s60, 32768
    s_add_u32 m0, s47, 10240
    s_nop 0
    buffer_load_dwordx4 v14, s[8:11], s60 offen lds
    s_add_u32 s60, s60, 32768
    s_add_u32 m0, s47, 11264
    s_nop 0
    buffer_load_dwordx4 v15, s[8:11], s60 offen lds
    s_waitcnt vmcnt(28)
    s_barrier
    ds_read_b64_tr_b16 a[168:169], v16 offset:12288
    ds_read_b64_tr_b16 a[170:171], v16 offset:12800
    ds_read_b64_tr_b16 a[172:173], v18 offset:12288
    ds_read_b64_tr_b16 a[174:175], v18 offset:12800
    ds_read_b64_tr_b16 v[40:41], v17 offset:12288
    ds_read_b64_tr_b16 v[42:43], v17 offset:12800
    ds_read_b64_tr_b16 v[44:45], v19 offset:12288
    ds_read_b64_tr_b16 v[46:47], v19 offset:12800
    s_waitcnt lgkmcnt(0)
    s_barrier
    s_waitcnt lgkmcnt(0)
    s_cmp_eq_u32 s16, 0
    s_cselect_b32 s60, 9, 4
    s_lshl_b32 s60, s60, 19
    s_add_u32 s60, s60, s58
    s_add_u32 m0, s47, 12288
    s_nop 0
    buffer_load_dwordx4 v12, s[8:11], s60 offen lds
    s_add_u32 s60, s60, 32768
    s_add_u32 m0, s47, 13312
    s_nop 0
    buffer_load_dwordx4 v13, s[8:11], s60 offen lds
    s_add_u32 s60, s60, 32768
    s_add_u32 m0, s47, 14336
    s_nop 0
    buffer_load_dwordx4 v14, s[8:11], s60 offen lds
    s_add_u32 s60, s60, 32768
    s_add_u32 m0, s47, 15360
    s_nop 0
    buffer_load_dwordx4 v15, s[8:11], s60 offen lds
    s_waitcnt vmcnt(28)
    s_barrier
    ds_read_b64_tr_b16 a[176:177], v16 offset:16384
    ds_read_b64_tr_b16 a[178:179], v16 offset:16896
    ds_read_b64_tr_b16 a[180:181], v18 offset:16384
    ds_read_b64_tr_b16 a[182:183], v18 offset:16896
    ds_read_b64_tr_b16 v[48:49], v17 offset:16384
    ds_read_b64_tr_b16 v[50:51], v17 offset:16896
    ds_read_b64_tr_b16 v[52:53], v19 offset:16384
    ds_read_b64_tr_b16 v[54:55], v19 offset:16896
    s_waitcnt lgkmcnt(0)
    s_barrier
    s_waitcnt lgkmcnt(0)
    s_mov_b32 s8, s66
    s_mov_b32 s9, s67
    s_mov_b32 s10, 0x500000
    s_mov_b32 s11, 0x20000
    s_cmp_eq_u32 s16, 0
    s_cselect_b32 s60, 5, 0
    s_lshl_b32 s60, s60, 19
    s_add_u32 s60, s60, s58
    s_add_u32 m0, s47, 16384
    s_nop 0
    buffer_load_dwordx4 v12, s[8:11], s60 offen lds
    s_add_u32 s60, s60, 32768
    s_add_u32 m0, s47, 17408
    s_nop 0
    buffer_load_dwordx4 v13, s[8:11], s60 offen lds
    s_add_u32 s60, s60, 32768
    s_add_u32 m0, s47, 18432
    s_nop 0
    buffer_load_dwordx4 v14, s[8:11], s60 offen lds
    s_add_u32 s60, s60, 32768
    s_add_u32 m0, s47, 19456
    s_nop 0
    buffer_load_dwordx4 v15, s[8:11], s60 offen lds
    s_waitcnt vmcnt(28)
    s_barrier
    ds_read_b64_tr_b16 a[184:185], v16 offset:20480
    ds_read_b64_tr_b16 a[186:187], v16 offset:20992
    ds_read_b64_tr_b16 a[188:189], v18 offset:20480
    ds_read_b64_tr_b16 a[190:191], v18 offset:20992
    ds_read_b64_tr_b16 a[192:193], v17 offset:20480
    ds_read_b64_tr_b16 a[194:195], v17 offset:20992
    ds_read_b64_tr_b16 a[196:197], v19 offset:20480
    ds_read_b64_tr_b16 a[198:199], v19 offset:20992
    s_waitcnt lgkmcnt(0)
    s_barrier
    s_waitcnt lgkmcnt(0)
    s_cmp_eq_u32 s16, 0
    s_cselect_b32 s60, 6, 1
    s_lshl_b32 s60, s60, 19
    s_add_u32 s60, s60, s58
    s_add_u32 m0, s47, 20480
    s_nop 0
    buffer_load_dwordx4 v12, s[8:11], s60 offen lds
    s_add_u32 s60, s60, 32768
    s_add_u32 m0, s47, 21504
    s_nop 0
    buffer_load_dwordx4 v13, s[8:11], s60 offen lds
    s_add_u32 s60, s60, 32768
    s_add_u32 m0, s47, 22528
    s_nop 0
    buffer_load_dwordx4 v14, s[8:11], s60 offen lds
    s_add_u32 s60, s60, 32768
    s_add_u32 m0, s47, 23552
    s_nop 0
    buffer_load_dwordx4 v15, s[8:11], s60 offen lds
    s_waitcnt vmcnt(28)
    s_barrier
    ds_read_b64_tr_b16 a[200:201], v16 offset:24576
    ds_read_b64_tr_b16 a[202:203], v16 offset:25088
    ds_read_b64_tr_b16 a[204:205], v18 offset:24576
    ds_read_b64_tr_b16 a[206:207], v18 offset:25088
    ds_read_b64_tr_b16 a[208:209], v17 offset:24576
    ds_read_b64_tr_b16 a[210:211], v17 offset:25088
    ds_read_b64_tr_b16 a[212:213], v19 offset:24576
    ds_read_b64_tr_b16 a[214:215], v19 offset:25088
    s_waitcnt lgkmcnt(0)
    s_barrier
    s_waitcnt lgkmcnt(0)
    s_cmp_eq_u32 s16, 0
    s_cselect_b32 s60, 7, 2
    s_lshl_b32 s60, s60, 19
    s_add_u32 s60, s60, s58
    s_add_u32 m0, s47, 24576
    s_nop 0
    buffer_load_dwordx4 v12, s[8:11], s60 offen lds
    s_add_u32 s60, s60, 32768
    s_add_u32 m0, s47, 25600
    s_nop 0
    buffer_load_dwordx4 v13, s[8:11], s60 offen lds
    s_add_u32 s60, s60, 32768
    s_add_u32 m0, s47, 26624
    s_nop 0
    buffer_load_dwordx4 v14, s[8:11], s60 offen lds
    s_add_u32 s60, s60, 32768
    s_add_u32 m0, s47, 27648
    s_nop 0
    buffer_load_dwordx4 v15, s[8:11], s60 offen lds
    s_waitcnt vmcnt(28)
    s_barrier
    ds_read_b64_tr_b16 v[56:57], v16 offset:28672
    ds_read_b64_tr_b16 v[58:59], v16 offset:29184
    ds_read_b64_tr_b16 v[60:61], v18 offset:28672
    ds_read_b64_tr_b16 v[62:63], v18 offset:29184
    ds_read_b64_tr_b16 a[216:217], v17 offset:28672
    ds_read_b64_tr_b16 a[218:219], v17 offset:29184
    ds_read_b64_tr_b16 a[220:221], v19 offset:28672
    ds_read_b64_tr_b16 a[222:223], v19 offset:29184
    s_waitcnt lgkmcnt(0)
    s_barrier
    s_waitcnt lgkmcnt(0)
    s_cmp_eq_u32 s16, 0
    s_cselect_b32 s60, 8, 3
    s_lshl_b32 s60, s60, 19
    s_add_u32 s60, s60, s58
    s_add_u32 m0, s47, 28672
    s_nop 0
    buffer_load_dwordx4 v12, s[8:11], s60 offen lds
    s_add_u32 s60, s60, 32768
    s_add_u32 m0, s47, 29696
    s_nop 0
    buffer_load_dwordx4 v13, s[8:11], s60 offen lds
    s_add_u32 s60, s60, 32768
    s_add_u32 m0, s47, 30720
    s_nop 0
    buffer_load_dwordx4 v14, s[8:11], s60 offen lds
    s_add_u32 s60, s60, 32768
    s_add_u32 m0, s47, 31744
    s_nop 0
    buffer_load_dwordx4 v15, s[8:11], s60 offen lds
    s_waitcnt vmcnt(28)
    s_barrier
    ds_read_b64_tr_b16 v[64:65], v16 offset:0
    ds_read_b64_tr_b16 v[66:67], v16 offset:512
    ds_read_b64_tr_b16 v[68:69], v18 offset:0
    ds_read_b64_tr_b16 v[70:71], v18 offset:512
    ds_read_b64_tr_b16 a[224:225], v17 offset:0
    ds_read_b64_tr_b16 a[226:227], v17 offset:512
    ds_read_b64_tr_b16 a[228:229], v19 offset:0
    ds_read_b64_tr_b16 a[230:231], v19 offset:512
    s_waitcnt lgkmcnt(0)
    s_barrier
    s_waitcnt lgkmcnt(0)
    s_waitcnt vmcnt(24)
    s_barrier
    ds_read_b64_tr_b16 a[232:233], v16 offset:4096
    ds_read_b64_tr_b16 a[234:235], v16 offset:4608
    ds_read_b64_tr_b16 a[236:237], v18 offset:4096
    ds_read_b64_tr_b16 a[238:239], v18 offset:4608
    ds_read_b64_tr_b16 v[72:73], v17 offset:4096
    ds_read_b64_tr_b16 v[74:75], v17 offset:4608
    ds_read_b64_tr_b16 v[76:77], v19 offset:4096
    ds_read_b64_tr_b16 v[78:79], v19 offset:4608
    s_waitcnt lgkmcnt(0)
    s_barrier
    s_waitcnt lgkmcnt(0)
    s_waitcnt vmcnt(20)
    s_barrier
    ds_read_b64_tr_b16 a[240:241], v16 offset:8192
    ds_read_b64_tr_b16 a[242:243], v16 offset:8704
    ds_read_b64_tr_b16 a[244:245], v18 offset:8192
    ds_read_b64_tr_b16 a[246:247], v18 offset:8704
    ds_read_b64_tr_b16 a[248:249], v17 offset:8192
    ds_read_b64_tr_b16 a[250:251], v17 offset:8704
    ds_read_b64_tr_b16 a[252:253], v19 offset:8192
    ds_read_b64_tr_b16 a[254:255], v19 offset:8704
    s_waitcnt lgkmcnt(0)
    s_barrier
    s_waitcnt lgkmcnt(0)
    s_waitcnt vmcnt(16)
    s_barrier
    ds_read_b64_tr_b16 v[80:81], v16 offset:12288
    ds_read_b64_tr_b16 v[82:83], v16 offset:12800
    ds_read_b64_tr_b16 v[84:85], v18 offset:12288
    ds_read_b64_tr_b16 v[86:87], v18 offset:12800
    ds_read_b64_tr_b16 v[88:89], v17 offset:12288
    ds_read_b64_tr_b16 v[90:91], v17 offset:12800
    ds_read_b64_tr_b16 v[92:93], v19 offset:12288
    ds_read_b64_tr_b16 v[94:95], v19 offset:12800
    s_waitcnt lgkmcnt(0)
    s_barrier
    s_waitcnt lgkmcnt(0)
    s_waitcnt vmcnt(12)
    s_barrier
    ds_read_b64_tr_b16 v[96:97], v16 offset:16384
    ds_read_b64_tr_b16 v[98:99], v16 offset:16896
    ds_read_b64_tr_b16 v[100:101], v18 offset:16384
    ds_read_b64_tr_b16 v[102:103], v18 offset:16896
    ds_read_b64_tr_b16 v[104:105], v17 offset:16384
    ds_read_b64_tr_b16 v[106:107], v17 offset:16896
    ds_read_b64_tr_b16 v[108:109], v19 offset:16384
    ds_read_b64_tr_b16 v[110:111], v19 offset:16896
    s_waitcnt lgkmcnt(0)
    s_barrier
    s_waitcnt lgkmcnt(0)
    s_mov_b32 s8, s68
    s_mov_b32 s9, s69
    s_mov_b32 s10, 0x500000
    s_mov_b32 s11, 0x20000
    s_mul_i32 s60, s17, 163840
    s_mul_i32 s41, s16, 640
    s_add_u32 s60, s60, s41
    s_mul_i32 s41, s18, 160
    s_add_u32 s60, s60, s41
    s_add_u32 m0, s47, 0
    s_nop 0
    buffer_load_dwordx4 v27, s[8:11], s60 offen lds
    s_add_u32 m0, s47, 1024
    s_nop 0
    buffer_load_dwordx4 v28, s[8:11], s60 offen lds
    s_add_u32 m0, s47, 2048
    s_nop 0
    buffer_load_dwordx4 v29, s[8:11], s60 offen lds
    s_add_u32 m0, s47, 3072
    s_nop 0
    buffer_load_dwordx4 v30, s[8:11], s60 offen lds
    s_add_u32 m0, s47, 4096
    s_nop 0
    buffer_load_dwordx4 v31, s[8:11], s60 offen lds
    s_add_u32 s60, s60, 40960
    s_add_u32 m0, s47, 5120
    s_nop 0
    buffer_load_dwordx4 v27, s[8:11], s60 offen lds
    s_add_u32 m0, s47, 6144
    s_nop 0
    buffer_load_dwordx4 v28, s[8:11], s60 offen lds
    s_add_u32 m0, s47, 7168
    s_nop 0
    buffer_load_dwordx4 v29, s[8:11], s60 offen lds
    s_add_u32 m0, s47, 8192
    s_nop 0
    buffer_load_dwordx4 v30, s[8:11], s60 offen lds
    s_add_u32 m0, s47, 9216
    s_nop 0
    buffer_load_dwordx4 v31, s[8:11], s60 offen lds
    s_add_u32 s60, s60, 40960
    s_add_u32 m0, s47, 10240
    s_nop 0
    buffer_load_dwordx4 v27, s[8:11], s60 offen lds
    s_add_u32 m0, s47, 11264
    s_nop 0
    buffer_load_dwordx4 v28, s[8:11], s60 offen lds
    s_add_u32 m0, s47, 12288
    s_nop 0
    buffer_load_dwordx4 v29, s[8:11], s60 offen lds
    s_add_u32 m0, s47, 13312
    s_nop 0
    buffer_load_dwordx4 v30, s[8:11], s60 offen lds
    s_add_u32 m0, s47, 14336
    s_nop 0
    buffer_load_dwordx4 v31, s[8:11], s60 offen lds
    s_add_u32 s60, s60, 40960
    s_add_u32 m0, s47, 15360
    s_nop 0
    buffer_load_dwordx4 v27, s[8:11], s60 offen lds
    s_add_u32 m0, s47, 16384
    s_nop 0
    buffer_load_dwordx4 v28, s[8:11], s60 offen lds
    s_add_u32 m0, s47, 17408
    s_nop 0
    buffer_load_dwordx4 v29, s[8:11], s60 offen lds
    s_add_u32 m0, s47, 18432
    s_nop 0
    buffer_load_dwordx4 v30, s[8:11], s60 offen lds
    s_add_u32 m0, s47, 19456
    s_nop 0
    buffer_load_dwordx4 v31, s[8:11], s60 offen lds
    s_waitcnt vmcnt(28)
    s_barrier
    ds_read_b64_tr_b16 v[112:113], v16 offset:20480
    ds_read_b64_tr_b16 v[114:115], v16 offset:20992
    ds_read_b64_tr_b16 v[116:117], v18 offset:20480
    ds_read_b64_tr_b16 v[118:119], v18 offset:20992
    ds_read_b64_tr_b16 v[120:121], v17 offset:20480
    ds_read_b64_tr_b16 v[122:123], v17 offset:20992
    ds_read_b64_tr_b16 v[124:125], v19 offset:20480
    ds_read_b64_tr_b16 v[126:127], v19 offset:20992
    s_waitcnt lgkmcnt(0)
    s_barrier
    s_waitcnt lgkmcnt(0)
    s_mov_b32 s8, s66
    s_mov_b32 s9, s67
    s_mov_b32 s10, 0x500000
    s_mov_b32 s11, 0x20000
    s_cmp_eq_u32 s16, 0
    s_cselect_b32 s60, 9, 4
    s_lshl_b32 s60, s60, 19
    s_add_u32 s60, s60, s58
    s_add_u32 m0, s47, 20480
    s_nop 0
    buffer_load_dwordx4 v12, s[8:11], s60 offen lds
    s_add_u32 s60, s60, 32768
    s_add_u32 m0, s47, 21504
    s_nop 0
    buffer_load_dwordx4 v13, s[8:11], s60 offen lds
    s_add_u32 s60, s60, 32768
    s_add_u32 m0, s47, 22528
    s_nop 0
    buffer_load_dwordx4 v14, s[8:11], s60 offen lds
    s_add_u32 s60, s60, 32768
    s_add_u32 m0, s47, 23552
    s_nop 0
    buffer_load_dwordx4 v15, s[8:11], s60 offen lds
    s_waitcnt vmcnt(28)
    s_barrier
    ds_read_b64_tr_b16 v[128:129], v16 offset:24576
    ds_read_b64_tr_b16 v[130:131], v16 offset:25088
    ds_read_b64_tr_b16 v[132:133], v18 offset:24576
    ds_read_b64_tr_b16 v[134:135], v18 offset:25088
    ds_read_b64_tr_b16 v[136:137], v17 offset:24576
    ds_read_b64_tr_b16 v[138:139], v17 offset:25088
    ds_read_b64_tr_b16 v[140:141], v19 offset:24576
    ds_read_b64_tr_b16 v[142:143], v19 offset:25088
    s_waitcnt lgkmcnt(0)
    s_barrier
    s_waitcnt lgkmcnt(0)
    s_waitcnt vmcnt(24)
    s_barrier
    ds_read_b64_tr_b16 v[144:145], v16 offset:28672
    ds_read_b64_tr_b16 v[146:147], v16 offset:29184
    ds_read_b64_tr_b16 v[148:149], v18 offset:28672
    ds_read_b64_tr_b16 v[150:151], v18 offset:29184
    ds_read_b64_tr_b16 v[152:153], v17 offset:28672
    ds_read_b64_tr_b16 v[154:155], v17 offset:29184
    ds_read_b64_tr_b16 v[156:157], v19 offset:28672
    ds_read_b64_tr_b16 v[158:159], v19 offset:29184
    s_waitcnt lgkmcnt(0)
    s_barrier
    s_waitcnt lgkmcnt(0)
    s_waitcnt vmcnt(0)
    s_barrier
    ds_read_b64_tr_b16 v[160:161], v16 offset:20480
    ds_read_b64_tr_b16 v[162:163], v16 offset:20992
    ds_read_b64_tr_b16 v[164:165], v18 offset:20480
    ds_read_b64_tr_b16 v[166:167], v18 offset:20992
    ds_read_b64_tr_b16 v[168:169], v17 offset:20480
    ds_read_b64_tr_b16 v[170:171], v17 offset:20992
    ds_read_b64_tr_b16 v[172:173], v19 offset:20480
    ds_read_b64_tr_b16 v[174:175], v19 offset:20992
    s_waitcnt lgkmcnt(0)
    s_barrier
    s_waitcnt lgkmcnt(0)
    ds_read_b64_tr_b16 v[176:177], v26 offset:0
    ds_read_b64_tr_b16 v[178:179], v26 offset:320
    ds_read_b64_tr_b16 v[180:181], v26 offset:5120
    ds_read_b64_tr_b16 v[182:183], v26 offset:5440
    ds_read_b64_tr_b16 v[184:185], v26 offset:32
    ds_read_b64_tr_b16 v[186:187], v26 offset:352
    ds_read_b64_tr_b16 v[188:189], v26 offset:5152
    ds_read_b64_tr_b16 v[190:191], v26 offset:5472
    ds_read_b64_tr_b16 v[192:193], v26 offset:64
    ds_read_b64_tr_b16 v[194:195], v26 offset:384
    ds_read_b64_tr_b16 v[196:197], v26 offset:5184
    ds_read_b64_tr_b16 v[198:199], v26 offset:5504
    ds_read_b64_tr_b16 v[200:201], v26 offset:96
    ds_read_b64_tr_b16 v[202:203], v26 offset:416
    ds_read_b64_tr_b16 v[204:205], v26 offset:5216
    ds_read_b64_tr_b16 v[206:207], v26 offset:5536
    ds_read_b64_tr_b16 v[208:209], v26 offset:128
    ds_read_b64_tr_b16 v[210:211], v26 offset:448
    ds_read_b64_tr_b16 v[212:213], v26 offset:5248
    ds_read_b64_tr_b16 v[214:215], v26 offset:5568
    ds_read_b64_tr_b16 v[216:217], v26 offset:10240
    ds_read_b64_tr_b16 v[218:219], v26 offset:10560
    ds_read_b64_tr_b16 v[220:221], v26 offset:15360
    ds_read_b64_tr_b16 v[222:223], v26 offset:15680
    ds_read_b64_tr_b16 v[224:225], v26 offset:10272
    ds_read_b64_tr_b16 v[226:227], v26 offset:10592
    ds_read_b64_tr_b16 v[228:229], v26 offset:15392
    ds_read_b64_tr_b16 v[230:231], v26 offset:15712
    ds_read_b64_tr_b16 v[232:233], v26 offset:10304
    ds_read_b64_tr_b16 v[234:235], v26 offset:10624
    ds_read_b64_tr_b16 v[236:237], v26 offset:15424
    ds_read_b64_tr_b16 v[238:239], v26 offset:15744
    ds_read_b64_tr_b16 v[240:241], v26 offset:10336
    ds_read_b64_tr_b16 v[242:243], v26 offset:10656
    ds_read_b64_tr_b16 v[244:245], v26 offset:15456
    ds_read_b64_tr_b16 v[246:247], v26 offset:15776
    ds_read_b64_tr_b16 v[248:249], v26 offset:10368
    ds_read_b64_tr_b16 v[250:251], v26 offset:10688
    ds_read_b64_tr_b16 v[252:253], v26 offset:15488
    ds_read_b64_tr_b16 v[254:255], v26 offset:15808
    s_waitcnt lgkmcnt(0)
    s_cmp_eq_u32 s16, 0
    s_cselect_b32 s60, 0, 5
    s_lshl_b32 s60, s60, 19
    s_add_u32 s60, s60, s58
    s_add_u32 m0, s47, 0
    s_nop 0
    buffer_load_dwordx4 v12, s[8:11], s60 offen lds
    s_add_u32 s60, s60, 32768
    s_add_u32 m0, s47, 1024
    s_nop 0
    buffer_load_dwordx4 v13, s[8:11], s60 offen lds
    s_add_u32 s60, s60, 32768
    s_add_u32 m0, s47, 2048
    s_nop 0
    buffer_load_dwordx4 v14, s[8:11], s60 offen lds
    s_add_u32 s60, s60, 32768
    s_add_u32 m0, s47, 3072
    s_nop 0
    buffer_load_dwordx4 v15, s[8:11], s60 offen lds
    s_cmp_eq_u32 s16, 0
    s_cselect_b32 s60, 1, 6
    s_lshl_b32 s60, s60, 19
    s_add_u32 s60, s60, s58
    s_add_u32 m0, s47, 4096
    s_nop 0
    buffer_load_dwordx4 v12, s[8:11], s60 offen lds
    s_add_u32 s60, s60, 32768
    s_add_u32 m0, s47, 5120
    s_nop 0
    buffer_load_dwordx4 v13, s[8:11], s60 offen lds
    s_add_u32 s60, s60, 32768
    s_add_u32 m0, s47, 6144
    s_nop 0
    buffer_load_dwordx4 v14, s[8:11], s60 offen lds
    s_add_u32 s60, s60, 32768
    s_add_u32 m0, s47, 7168
    s_nop 0
    buffer_load_dwordx4 v15, s[8:11], s60 offen lds
    s_cmp_eq_u32 s16, 0
    s_cselect_b32 s60, 2, 7
    s_lshl_b32 s60, s60, 19
    s_add_u32 s60, s60, s58
    s_add_u32 m0, s47, 8192
    s_nop 0
    buffer_load_dwordx4 v12, s[8:11], s60 offen lds
    s_add_u32 s60, s60, 32768
    s_add_u32 m0, s47, 9216
    s_nop 0
    buffer_load_dwordx4 v13, s[8:11], s60 offen lds
    s_add_u32 s60, s60, 32768
    s_add_u32 m0, s47, 10240
    s_nop 0
    buffer_load_dwordx4 v14, s[8:11], s60 offen lds
    s_add_u32 s60, s60, 32768
    s_add_u32 m0, s47, 11264
    s_nop 0
    buffer_load_dwordx4 v15, s[8:11], s60 offen lds
    s_cmp_eq_u32 s16, 0
    s_cselect_b32 s60, 3, 8
    s_lshl_b32 s60, s60, 19
    s_add_u32 s60, s60, s58
    s_add_u32 m0, s47, 12288
    s_nop 0
    buffer_load_dwordx4 v12, s[8:11], s60 offen lds
    s_add_u32 s60, s60, 32768
    s_add_u32 m0, s47, 13312
    s_nop 0
    buffer_load_dwordx4 v13, s[8:11], s60 offen lds
    s_add_u32 s60, s60, 32768
    s_add_u32 m0, s47, 14336
    s_nop 0
    buffer_load_dwordx4 v14, s[8:11], s60 offen lds
    s_add_u32 s60, s60, 32768
    s_add_u32 m0, s47, 15360
    s_nop 0
    buffer_load_dwordx4 v15, s[8:11], s60 offen lds
    s_cmp_eq_u32 s16, 0
    s_cselect_b32 s60, 4, 9
    s_lshl_b32 s60, s60, 19
    s_add_u32 s60, s60, s58
    s_add_u32 m0, s47, 16384
    s_nop 0
    buffer_load_dwordx4 v12, s[8:11], s60 offen lds
    s_add_u32 s60, s60, 32768
    s_add_u32 m0, s47, 17408
    s_nop 0
    buffer_load_dwordx4 v13, s[8:11], s60 offen lds
    s_add_u32 s60, s60, 32768
    s_add_u32 m0, s47, 18432
    s_nop 0
    buffer_load_dwordx4 v14, s[8:11], s60 offen lds
    s_add_u32 s60, s60, 32768
    s_add_u32 m0, s47, 19456
    s_nop 0
    buffer_load_dwordx4 v15, s[8:11], s60 offen lds
    ds_write_b128 v2, v[32:35] offset:20480
    ds_write_b128 v2, v[36:39] offset:21504
    ds_write_b128 v2, v[40:43] offset:22528
    ds_write_b128 v2, v[44:47] offset:23552
    ds_write_b128 v2, v[48:51] offset:24576
    ds_write_b128 v2, v[52:55] offset:25600
    ds_write_b128 v2, v[56:59] offset:26624
    ds_write_b128 v2, v[60:63] offset:27648
    ds_write_b128 v2, v[64:67] offset:28672
    ds_write_b128 v2, v[68:71] offset:29696
    ds_write_b128 v2, v[72:75] offset:30720
    ds_write_b128 v2, v[76:79] offset:31744
    ds_write_b128 v2, v[80:83] offset:32768
    ds_write_b128 v2, v[84:87] offset:33792
    s_waitcnt lgkmcnt(0)
    s_waitcnt vmcnt(16)
    s_barrier
    ds_read_b64_tr_b16 v[32:33], v16 offset:0
    ds_read_b64_tr_b16 v[34:35], v16 offset:512
    ds_read_b64_tr_b16 v[36:37], v18 offset:0
    ds_read_b64_tr_b16 v[38:39], v18 offset:512
    ds_read_b64_tr_b16 v[40:41], v17 offset:0
    ds_read_b64_tr_b16 v[42:43], v17 offset:512
    ds_read_b64_tr_b16 v[44:45], v19 offset:0
    ds_read_b64_tr_b16 v[46:47], v19 offset:512
    s_waitcnt lgkmcnt(0)
    s_barrier
    s_waitcnt lgkmcnt(0)
    ds_write_b128 v2, v[32:35] offset:0
    ds_write_b128 v2, v[36:39] offset:1024
    ds_write_b128 v2, v[40:43] offset:2048
    ds_write_b128 v2, v[44:47] offset:3072
    s_waitcnt lgkmcnt(0)
    s_waitcnt vmcnt(12)
    s_barrier
    ds_read_b64_tr_b16 v[32:33], v16 offset:4096
    ds_read_b64_tr_b16 v[34:35], v16 offset:4608
    ds_read_b64_tr_b16 v[36:37], v18 offset:4096
    ds_read_b64_tr_b16 v[38:39], v18 offset:4608
    ds_read_b64_tr_b16 v[40:41], v17 offset:4096
    ds_read_b64_tr_b16 v[42:43], v17 offset:4608
    ds_read_b64_tr_b16 v[44:45], v19 offset:4096
    ds_read_b64_tr_b16 v[46:47], v19 offset:4608
    s_waitcnt lgkmcnt(0)
    s_barrier
    s_waitcnt lgkmcnt(0)
    ds_write_b128 v2, v[32:35] offset:4096
    ds_write_b128 v2, v[36:39] offset:5120
    ds_write_b128 v2, v[40:43] offset:6144
    ds_write_b128 v2, v[44:47] offset:7168
    s_waitcnt lgkmcnt(0)
    s_waitcnt vmcnt(8)
    s_barrier
    ds_read_b64_tr_b16 v[32:33], v16 offset:8192
    ds_read_b64_tr_b16 v[34:35], v16 offset:8704
    ds_read_b64_tr_b16 v[36:37], v18 offset:8192
    ds_read_b64_tr_b16 v[38:39], v18 offset:8704
    ds_read_b64_tr_b16 v[40:41], v17 offset:8192
    ds_read_b64_tr_b16 v[42:43], v17 offset:8704
    ds_read_b64_tr_b16 v[44:45], v19 offset:8192
    ds_read_b64_tr_b16 v[46:47], v19 offset:8704
    s_waitcnt lgkmcnt(0)
    s_barrier
    s_waitcnt lgkmcnt(0)
    ds_write_b128 v2, v[32:35] offset:8192
    ds_write_b128 v2, v[36:39] offset:9216
    ds_write_b128 v2, v[40:43] offset:10240
    ds_write_b128 v2, v[44:47] offset:11264
    s_waitcnt lgkmcnt(0)
    s_waitcnt vmcnt(4)
    s_barrier
    ds_read_b64_tr_b16 v[32:33], v16 offset:12288
    ds_read_b64_tr_b16 v[34:35], v16 offset:12800
    ds_read_b64_tr_b16 v[36:37], v18 offset:12288
    ds_read_b64_tr_b16 v[38:39], v18 offset:12800
    ds_read_b64_tr_b16 v[40:41], v17 offset:12288
    ds_read_b64_tr_b16 v[42:43], v17 offset:12800
    ds_read_b64_tr_b16 v[44:45], v19 offset:12288
    ds_read_b64_tr_b16 v[46:47], v19 offset:12800
    s_waitcnt lgkmcnt(0)
    s_barrier
    s_waitcnt lgkmcnt(0)
    ds_write_b128 v2, v[32:35] offset:12288
    ds_write_b128 v2, v[36:39] offset:13312
    ds_write_b128 v2, v[40:43] offset:14336
    ds_write_b128 v2, v[44:47] offset:15360
    s_waitcnt lgkmcnt(0)
    s_waitcnt vmcnt(0)
    s_barrier
    ds_read_b64_tr_b16 v[32:33], v16 offset:16384
    ds_read_b64_tr_b16 v[34:35], v16 offset:16896
    ds_read_b64_tr_b16 v[36:37], v18 offset:16384
    ds_read_b64_tr_b16 v[38:39], v18 offset:16896
    ds_read_b64_tr_b16 v[40:41], v17 offset:16384
    ds_read_b64_tr_b16 v[42:43], v17 offset:16896
    ds_read_b64_tr_b16 v[44:45], v19 offset:16384
    ds_read_b64_tr_b16 v[46:47], v19 offset:16896
    s_waitcnt lgkmcnt(0)
    s_barrier
    s_waitcnt lgkmcnt(0)
    ds_write_b128 v2, v[32:35] offset:16384
    ds_write_b128 v2, v[36:39] offset:17408
    ds_write_b128 v2, v[40:43] offset:18432
    ds_write_b128 v2, v[44:47] offset:19456
    s_waitcnt lgkmcnt(0)
    v_add_u32 v12, s73, v3
    v_lshl_add_u32 v13, v0, 2, s74
    v_lshlrev_b32 v11, 2, v0
    s_nop 1
L_mode_193:
    buffer_load_dword v24, v11, s[12:15], 0 offen sc1
    s_waitcnt vmcnt(0)
    v_readlane_b32 s48, v24, 32
    v_readlane_b32 s49, v24, 33
    s_and_b32 s41, s48, s49
    s_bfe_u32 s41, s41, 0x10005
    v_readlane_b32 s42, v24, 7
    s_lshr_b32 s42, s42, 7
    s_and_b32 s41, s41, s42
    v_readlane_b32 s42, v24, 40
    s_lshr_b32 s42, s42, 6
    s_and_b32 s41, s41, s42
    s_cmp_eq_u32 s41, 1
    s_nop 1
    s_cbranch_scc1 L_mode_done_194
    s_sleep 4
    s_add_u32 s46, s46, 1
    s_cmp_lt_u32 s46, 131072
    s_cbranch_scc1 L_mode_193
    s_branch L_end
L_mode_done_194:
    s_mov_b32 s20, 1
    s_bfe_u32 s41, s48, 0xa0006
    s_mul_i32 s41, s41, s41
    s_bfe_u32 s42, s48, 0xe0010
    s_lshl_b32 s42, s42, 5
    s_cmp_eq_u32 s41, s42
    s_cselect_b32 s20, s20, 0
    s_bfe_u32 s41, s49, 0xa0006
    s_mul_i32 s41, s41, s41
    s_bfe_u32 s42, s49, 0xe0010
    s_lshl_b32 s42, s42, 5
    s_cmp_eq_u32 s41, s42
    s_cselect_b32 s20, s20, 0
    s_bfe_u32 s41, s48, 0x1001e
    s_lshl_b32 s41, s41, 13
    s_add_u32 s22, s22, s41
    s_add_u32 s27, s27, s41
    v_readlane_b32 s48, v24, 36
    v_readlane_b32 s49, v24, 37
    v_readlane_b32 s50, v24, 38
    v_readlane_b32 s51, v24, 39
    s_cmp_eq_u32 s16, 0
    s_cselect_b64 s[36:37], s[48:49], s[50:51]
    s_cselect_b64 s[82:83], s[50:51], s[48:49]
    s_mov_b32 s39, s22
    s_mov_b32 s96, s27
    s_lshl_b32 s41, s17, 4
    s_add_u32 s97, s41, 0x518000
    s_mov_b32 s25, 0
    s_lshl_b32 s41, s17, 5
    s_lshl_b32 s42, s16, 2
    s_add_u32 s40, s41, s42
    s_add_u32 s40, s40, 0x503c00
    s_mov_b32 s19, 0
L_kv_195:
    s_add_u32 s41, s19, 0
    s_cmp_ge_u32 s41, s25
    s_cbranch_scc1 L_kvs_196
    s_cmp_eq_u32 s18, 2
    s_cselect_b32 s25, s25, 65
    s_lshl_b32 s41, s18, 11
    s_add_u32 m0, s41, 155648
    s_nop 0
    buffer_load_dwordx4 v2, s[4:7], s29 offen offset:0 sc1 lds
    buffer_load_dwordx4 v2, s[4:7], s29 offen offset:1024 sc1 lds
    s_add_u32 s29, s29, 262144
    s_add_u32 s32, s21, 149504
    s_bfe_u32 s41, s82, 0x10001
    s_lshl_b32 s41, s41, 13
    s_add_u32 s41, s41, s39
    s_add_u32 s41, s41, 172032
    s_cmp_eq_u32 s18, 1
    s_cselect_b32 s32, s41, s32
    s_add_u32 s41, s29, 65536
    s_cmp_eq_u32 s18, 2
    s_cselect_b32 s32, s41, s32
    s_add_u32 s41, s29, 0x1018000
    s_cmp_eq_u32 s18, 3
    s_cselect_b32 s32, s41, s32
    s_cmp_lt_u32 s18, 2
    s_cselect_b32 s41, 39, 63
    v_min_u32 v9, s41, v0
    v_lshlrev_b32 v9, 7, v9
    s_mov_b32 s19, 0
    s_waitcnt vmcnt(0) lgkmcnt(0)
L_step_197:
    v_mov_b64 v[20:21], 0
    v_mov_b64 v[22:23], 0
    v_mov_b64 v[24:25], 0
    v_mov_b64 v[26:27], 0
    v_mov_b64 v[28:29], 0
    v_mov_b64 v[30:31], 0
    v_mov_b64 v[32:33], 0
    v_mov_b64 v[34:35], 0
    v_mov_b64 v[36:37], 0
    v_mov_b64 v[38:39], 0
    v_mov_b64 v[40:41], 0
    v_mov_b64 v[42:43], 0
    ds_read_b128 v[64:67], v2 offset:0
    ds_read_b128 v[68:71], v2 offset:1024
    ds_read_b128 v[72:75], v2 offset:20480
    ds_read_b128 v[76:79], v2 offset:21504
    ds_read_b128 v[56:59], v2 offset:2048
    ds_read_b128 v[60:63], v2 offset:3072
    s_cmp_eq_u32 s19, 0
    s_cbranch_scc1 L_s0a_199
    buffer_load_dwordx4 v[16:19], v12, s[4:7], s21 offen sc1
    buffer_load_dword v15, v13, s[4:7], s21 offen sc1
    s_nop 15
    buffer_load_dwordx4 v[80:83], v12, s[4:7], s21 offen sc1
    buffer_load_dword v84, v13, s[4:7], s21 offen sc1
L_poll_200:
    s_waitcnt vmcnt(2)
    ds_write_b128 v12, v[16:19] offset:0
    ds_write_b32 v13, v15 offset:0
    v_max3_u32 v11, v16, v17, v18
    v_max3_u32 v11, v11, v19, v15
    v_cmp_eq_u32 vcc, -1, v11
    s_cbranch_vccz L_polld_201
    buffer_load_dwordx4 v[16:19], v12, s[4:7], s21 offen sc1
    buffer_load_dword v15, v13, s[4:7], s21 offen sc1
    s_waitcnt vmcnt(2)
    ds_write_b128 v12, v[80:83] offset:0
    ds_write_b32 v13, v84 offset:0
    v_max3_u32 v11, v80, v81, v82
    v_max3_u32 v11, v11, v83, v84
    v_cmp_eq_u32 vcc, -1, v11
    s_cbranch_vccz L_polld_201
    buffer_load_dwordx4 v[80:83], v12, s[4:7], s21 offen sc1
    buffer_load_dword v84, v13, s[4:7], s21 offen sc1
    s_add_u32 s46, s46, 1
    s_cmp_lt_u32 s46, 131072
    s_cbranch_scc1 L_poll_200
    s_branch L_end
L_polld_201:
L_s0a_199:
    s_waitcnt lgkmcnt(0)
    s_barrier
    ds_read_b128 v[44:47], v3 offset:0
    ds_read_b128 v[48:51], v3 offset:1024
    ds_read_b128 v[52:55], v3 offset:2048
    s_cmp_eq_u32 s19, 63
    s_cbranch_scc1 L_lastf_202
L_lastb_203:
    buffer_load_dwordx4 v[80:83], v12, s[4:7], s22 offen sc1
    buffer_load_dword v84, v13, s[4:7], s22 offen sc1
    s_waitcnt lgkmcnt(2)
    v_smfmac_f32_16x16x64_bf16 v[36:39], v[44:47], v[64:71], v1
    ds_read_b128 v[64:67], v2 offset:4096
    v_smfmac_f32_16x16x64_bf16 v[20:23], v[44:47], a[0:7], v1
    ds_read_b128 v[68:71], v2 offset:5120
    v_smfmac_f32_16x16x64_bf16 v[32:35], v[44:47], v[72:79], v1
    ds_read_b128 v[72:75], v2 offset:22528
    v_smfmac_f32_16x16x64_bf16 v[24:27], v[44:47], a[8:15], v1
    ds_read_b128 v[76:79], v2 offset:23552
    v_smfmac_f32_16x16x64_bf16 v[40:43], v[44:47], v[56:63], v1
    ds_read_b128 v[56:59], v2 offset:6144
    v_smfmac_f32_16x16x64_bf16 v[28:31], v[44:47], a[160:167], v1
    ds_read_b128 v[60:63], v2 offset:7168
    ds_read_b128 v[44:47], v3 offset:3072
    s_waitcnt lgkmcnt(5)
    v_smfmac_f32_16x16x64_bf16 v[36:39], v[48:51], v[64:71], v1
    ds_read_b128 v[64:67], v2 offset:8192
    v_smfmac_f32_16x16x64_bf16 v[20:23], v[48:51], a[16:23], v1
    ds_read_b128 v[68:71], v2 offset:9216
    s_waitcnt lgkmcnt(5)
    v_smfmac_f32_16x16x64_bf16 v[32:35], v[48:51], v[72:79], v1
    ds_read_b128 v[72:75], v2 offset:24576
    v_smfmac_f32_16x16x64_bf16 v[24:27], v[48:51], a[24:31], v1
    ds_read_b128 v[76:79], v2 offset:25600
    s_waitcnt lgkmcnt(5)
    v_smfmac_f32_16x16x64_bf16 v[40:43], v[48:51], v[56:63], v1
    ds_read_b128 v[56:59], v2 offset:10240
    v_smfmac_f32_16x16x64_bf16 v[28:31], v[48:51], a[168:175], v1
    ds_read_b128 v[60:63], v2 offset:11264
    ds_read_b128 v[48:51], v3 offset:4096
    buffer_load_dwordx4 v[16:19], v12, s[4:7], s22 offen sc1
    buffer_load_dword v15, v13, s[4:7], s22 offen sc1
    s_waitcnt lgkmcnt(5)
    v_smfmac_f32_16x16x64_bf16 v[36:39], v[52:55], v[64:71], v1
    ds_read_b128 v[64:67], v2 offset:12288
    v_smfmac_f32_16x16x64_bf16 v[20:23], v[52:55], a[32:39], v1
    ds_read_b128 v[68:71], v2 offset:13312
    s_waitcnt lgkmcnt(5)
    v_smfmac_f32_16x16x64_bf16 v[32:35], v[52:55], v[72:79], v1
    ds_read_b128 v[72:75], v2 offset:14336
    v_smfmac_f32_16x16x64_bf16 v[24:27], v[52:55], a[40:47], v1
    ds_read_b128 v[76:79], v2 offset:15360
    s_waitcnt lgkmcnt(5)
    v_smfmac_f32_16x16x64_bf16 v[40:43], v[52:55], v[56:63], v1
    v_smfmac_f32_16x16x64_bf16 v[28:31], v[52:55], a[176:183], v1
    s_waitcnt lgkmcnt(2)
    v_smfmac_f32_16x16x64_bf16 v[36:39], v[44:47], v[64:71], v1
    ds_read_b128 v[64:67], v2 offset:16384
    v_smfmac_f32_16x16x64_bf16 v[20:23], v[44:47], a[48:55], v1
    ds_read_b128 v[68:71], v2 offset:17408
    v_smfmac_f32_16x16x64_bf16 v[32:35], v[44:47], a[192:199], v1
    v_smfmac_f32_16x16x64_bf16 v[24:27], v[44:47], a[56:63], v1
    s_waitcnt lgkmcnt(2)
    v_smfmac_f32_16x16x64_bf16 v[40:43], v[44:47], v[72:79], v1
    ds_read_b128 v[72:75], v2 offset:18432
    v_smfmac_f32_16x16x64_bf16 v[28:31], v[44:47], a[184:191], v1
    ds_read_b128 v[76:79], v2 offset:19456
    s_cmp_eq_u32 s19, 0
    s_cbranch_scc1 L_rs0_204
L_poll_205:
    s_waitcnt vmcnt(2)
    ds_write_b128 v12, v[80:83] offset:5120
    ds_write_b32 v13, v84 offset:5120
    v_max3_u32 v11, v80, v81, v82
    v_max3_u32 v11, v11, v83, v84
    v_cmp_eq_u32 vcc, -1, v11
    s_cbranch_vccz L_polld_206
    buffer_load_dwordx4 v[80:83], v12, s[4:7], s22 offen sc1
    buffer_load_dword v84, v13, s[4:7], s22 offen sc1
    s_waitcnt vmcnt(2)
    ds_write_b128 v12, v[16:19] offset:5120
    ds_write_b32 v13, v15 offset:5120
    v_max3_u32 v11, v16, v17, v18
    v_max3_u32 v11, v11, v19, v15
    v_cmp_eq_u32 vcc, -1, v11
    s_cbranch_vccz L_polld_206
    buffer_load_dwordx4 v[16:19], v12, s[4:7], s22 offen sc1
    buffer_load_dword v15, v13, s[4:7], s22 offen sc1
    s_add_u32 s46, s46, 1
    s_cmp_lt_u32 s46, 131072
    s_cbranch_scc1 L_poll_205
    s_branch L_end
L_polld_206:
L_rs0_204:
    s_waitcnt lgkmcnt(0)
    s_barrier
    ds_read_b128 v[44:47], v3 offset:5120
    v_smfmac_f32_16x16x64_bf16 v[36:39], v[48:51], v[64:71], v1
    ds_read_b128 v[52:55], v3 offset:6144
    v_smfmac_f32_16x16x64_bf16 v[20:23], v[48:51], a[64:71], v1
    ds_read_b128 v[56:59], v3 offset:7168
    v_smfmac_f32_16x16x64_bf16 v[32:35], v[48:51], a[208:215], v1
    ds_read_b128 v[60:63], v3 offset:8192
    v_smfmac_f32_16x16x64_bf16 v[24:27], v[48:51], a[72:79], v1
    buffer_load_dwordx4 v[12:15], v2, s[4:7], s30 offen sc1
    v_smfmac_f32_16x16x64_bf16 v[40:43], v[48:51], v[72:79], v1
    buffer_load_dwordx4 v[16:19], v2, s[4:7], s30 offen offset:1024 sc1
    v_smfmac_f32_16x16x64_bf16 v[28:31], v[48:51], a[200:207], v1
    ds_read_b128 v[48:51], v3 offset:9216
    s_waitcnt lgkmcnt(1)
    v_smfmac_f32_16x16x64_bf16 v[20:23], v[44:47], a[80:87], v1
    ds_read_b128 v[72:75], v3 offset:16384
    v_smfmac_f32_16x16x64_bf16 v[24:27], v[44:47], a[88:95], v1
    ds_read_b128 v[76:79], v3 offset:20480
    v_smfmac_f32_16x16x64_bf16 v[20:23], v[52:55], a[96:103], v1
    buffer_load_dword v9, v9, s[4:7], s32 offen sc1
    v_smfmac_f32_16x16x64_bf16 v[24:27], v[52:55], a[104:111], v1
    v_smfmac_f32_16x16x64_bf16 v[20:23], v[56:59], a[112:119], v1
    ds_read_b128 v[64:67], v2 offset:26624
    v_smfmac_f32_16x16x64_bf16 v[24:27], v[56:59], a[120:127], v1
    ds_read_b128 v[68:71], v2 offset:27648
    v_smfmac_f32_16x16x64_bf16 v[20:23], v[60:63], a[128:135], v1
    s_waitcnt vmcnt(3)
    ds_read_b128 v[80:83], v2 offset:28672
    v_smfmac_f32_16x16x64_bf16 v[24:27], v[60:63], a[136:143], v1
    ds_read_b128 v[84:87], v2 offset:29696
    s_waitcnt lgkmcnt(6)
    v_smfmac_f32_16x16x64_bf16 v[20:23], v[48:51], a[144:151], v1
    v_smfmac_f32_16x16x64_bf16 v[24:27], v[48:51], a[152:159], v1
    s_waitcnt lgkmcnt(2)
    v_smfmac_f32_16x16x64_bf16 v[28:31], v[44:47], v[64:71], v1
    ds_read_b128 v[64:67], v2 offset:30720
    v_smfmac_f32_16x16x64_bf16 v[32:35], v[44:47], a[216:223], v1
    ds_read_b128 v[68:71], v2 offset:31744
    s_waitcnt lgkmcnt(2)
    v_smfmac_f32_16x16x64_bf16 v[28:31], v[52:55], v[80:87], v1
    ds_read_b128 v[80:83], v2 offset:32768
    v_smfmac_f32_16x16x64_bf16 v[32:35], v[52:55], a[224:231], v1
    ds_read_b128 v[84:87], v2 offset:33792
    v_permlane32_swap_b32 v20, v24
    v_smfmac_f32_16x16x64_bf16 v[28:31], v[56:59], a[232:239], v1
    v_permlane32_swap_b32 v21, v25
    s_waitcnt lgkmcnt(2)
    v_smfmac_f32_16x16x64_bf16 v[32:35], v[56:59], v[64:71], v1
    v_permlane32_swap_b32 v22, v26
    v_smfmac_f32_16x16x64_bf16 v[28:31], v[60:63], a[240:247], v1
    v_permlane32_swap_b32 v23, v27
    v_smfmac_f32_16x16x64_bf16 v[32:35], v[60:63], a[248:255], v1
    v_pk_add_f32 v[20:21], v[20:21], v[24:25]
    v_pk_add_f32 v[22:23], v[22:23], v[26:27]
    v_cvt_pk_bf16_f32 v24, v20, v21
    s_waitcnt lgkmcnt(0)
    v_smfmac_f32_16x16x64_bf16 v[28:31], v[48:51], v[80:87], v1
    v_cvt_pk_bf16_f32 v25, v22, v23
    ds_write_b64 v4, v[24:25] offset:0
    v_smfmac_f32_16x16x64_bf16 v[32:35], v[48:51], v[88:95], v1
    v_smfmac_f32_16x16x64_bf16 v[36:39], v[44:47], v[96:103], v1
    v_smfmac_f32_16x16x64_bf16 v[40:43], v[44:47], v[104:111], v1
    ds_read_b128 v[44:47], v3 offset:17408
    v_smfmac_f32_16x16x64_bf16 v[36:39], v[52:55], v[112:119], v1
    s_waitcnt lgkmcnt(1)
    s_barrier
    ds_read_b64_tr_b16 v[20:21], v5 offset:0
    ds_read_b64_tr_b16 v[22:23], v5 offset:256
    v_smfmac_f32_16x16x64_bf16 v[40:43], v[52:55], v[120:127], v1
    v_permlane32_swap_b32 v28, v32
    v_permlane32_swap_b32 v29, v33
    ds_read_b128 v[52:55], v3 offset:21504
    v_smfmac_f32_16x16x64_bf16 v[36:39], v[56:59], v[128:135], v1
    v_permlane32_swap_b32 v30, v34
    v_permlane32_swap_b32 v31, v35
    v_smfmac_f32_16x16x64_bf16 v[40:43], v[56:59], v[136:143], v1
    v_pk_add_f32 v[28:29], v[28:29], v[32:33]
    v_pk_add_f32 v[30:31], v[30:31], v[34:35]
    v_cvt_pk_bf16_f32 v32, v28, v29
    s_waitcnt lgkmcnt(1)
    v_mfma_f32_16x16x32_bf16 v[80:83], v[72:75], v[20:23], 0
    v_cvt_pk_bf16_f32 v33, v30, v31
    ds_write_b64 v4, v[32:33] offset:2048
    ds_read_b64_tr_b16 v[24:25], v5 offset:512
    ds_read_b64_tr_b16 v[26:27], v5 offset:768
    v_mfma_f32_16x16x32_bf16 v[84:87], v[76:79], v[20:23], 0
    ds_read_b128 v[72:75], v3 offset:18432
    v_smfmac_f32_16x16x64_bf16 v[36:39], v[60:63], v[144:151], v1
    ds_read_b128 v[76:79], v3 offset:22528
    ds_read_b64_tr_b16 v[64:65], v5 offset:1024
    ds_read_b64_tr_b16 v[66:67], v5 offset:1280
    v_smfmac_f32_16x16x64_bf16 v[40:43], v[60:63], v[152:159], v1
    ds_read_b64_tr_b16 v[68:69], v5 offset:1536
    ds_read_b64_tr_b16 v[70:71], v5 offset:1792
    s_waitcnt lgkmcnt(6)
    v_mfma_f32_16x16x32_bf16 v[80:83], v[44:47], v[24:27], v[80:83]
    ds_read_b128 v[44:47], v3 offset:19456
    v_mfma_f32_16x16x32_bf16 v[84:87], v[52:55], v[24:27], v[84:87]
    ds_read_b128 v[52:55], v3 offset:23552
    s_waitcnt lgkmcnt(4)
    v_mfma_f32_16x16x32_bf16 v[80:83], v[72:75], v[64:67], v[80:83]
    s_barrier
    ds_read_b64_tr_b16 v[28:29], v5 offset:2048
    ds_read_b64_tr_b16 v[30:31], v5 offset:2304
    ds_read_b64_tr_b16 v[32:33], v5 offset:2560
    ds_read_b64_tr_b16 v[34:35], v5 offset:2816
    v_mfma_f32_16x16x32_bf16 v[84:87], v[76:79], v[64:67], v[84:87]
    ds_read_b64_tr_b16 v[56:57], v5 offset:3072
    ds_read_b64_tr_b16 v[58:59], v5 offset:3328
    s_waitcnt lgkmcnt(7)
    v_mfma_f32_16x16x32_bf16 v[80:83], v[44:47], v[68:71], v[80:83]
    ds_read_b64_tr_b16 v[60:61], v5 offset:3584
    ds_read_b64_tr_b16 v[62:63], v5 offset:3840
    s_waitcnt lgkmcnt(8)
    v_mfma_f32_16x16x32_bf16 v[84:87], v[52:55], v[68:71], v[84:87]
    v_add_u32 v75, s75, v5
    ds_read_b64_tr_b16 v[72:73], v75 offset:2048
    ds_read_b64_tr_b16 v[74:75], v75 offset:2304
    v_smfmac_f32_16x16x64_bf16 v[36:39], v[48:51], v[160:167], v1
L_kv_207:
    s_add_u32 s41, s19, 1
    s_cmp_ge_u32 s41, s25
    s_cbranch_scc1 L_kvs_208
    v_smfmac_f32_16x16x64_bf16 v[40:43], v[48:51], v[168:175], v1
    s_waitcnt lgkmcnt(8)
    v_mfma_f32_16x16x32_bf16 v[44:47], v[28:31], v[20:23], 0
    s_nop 1
    v_max3_f32 v10, v80, v81, v82
    v_max3_f32 v11, v83, v84, v85
    s_waitcnt vmcnt(1)
    s_waitcnt lgkmcnt(6)
    v_mfma_f32_16x16x32_bf16 v[44:47], v[32:35], v[24:27], v[44:47]
    v_max3_f32 v10, v10, v86, v87
    v_max_f32 v10, v10, v11
    v_mov_b32 v11, v10
    s_waitcnt lgkmcnt(4)
    v_mfma_f32_16x16x32_bf16 v[44:47], v[56:59], v[64:67], v[44:47]
    v_permlane32_swap_b32 v36, v40
    s_waitcnt lgkmcnt(2)
    v_mfma_f32_16x16x32_bf16 v[44:47], v[60:63], v[68:71], v[44:47]
    v_permlane32_swap_b32 v10, v11
    v_max_f32 v10, v10, v11
    s_waitcnt lgkmcnt(0)
    v_permlane32_swap_b32 v37, v41
    v_permlane32_swap_b32 v38, v42
    v_permlane32_swap_b32 v39, v43
    v_pk_add_f32 v[36:37], v[36:37], v[40:41]
    v_pk_add_f32 v[38:39], v[38:39], v[42:43]
    v_cvt_pk_bf16_f32 v40, v36, v37
    v_cvt_pk_bf16_f32 v41, v38, v39
    v_cndmask_b32 v72, v72, v40, s[94:95]
    v_cndmask_b32 v73, v73, v41, s[94:95]
    s_cmp_eq_u32 s19, 63
    s_cbranch_scc1 L_rec_done_198
    v_max3_f32 v10, v10, v44, v45
    v_max3_f32 v10, v10, v46, v47
    v_mov_b32 v11, v10
    v_cndmask_b32 v36, 0, v40, s[34:35]
    v_cndmask_b32 v38, v40, 0, s[34:35]
    v_permlane16_swap_b32 v10, v11
    v_max_f32 v10, v10, v11
    v_mul_f32 v10, s33, v10
    v_pk_fma_f32 v[80:81], v[80:81], s[32:33], v[10:11] op_sel:[0,1,0] op_sel_hi:[1,1,0] neg_lo:[0,0,1] neg_hi:[0,0,1]
    v_pk_fma_f32 v[82:83], v[82:83], s[32:33], v[10:11] op_sel:[0,1,0] op_sel_hi:[1,1,0] neg_lo:[0,0,1] neg_hi:[0,0,1]
    v_pk_fma_f32 v[84:85], v[84:85], s[32:33], v[10:11] op_sel:[0,1,0] op_sel_hi:[1,1,0] neg_lo:[0,0,1] neg_hi:[0,0,1]
    v_pk_fma_f32 v[86:87], v[86:87], s[32:33], v[10:11] op_sel:[0,1,0] op_sel_hi:[1,1,0] neg_lo:[0,0,1] neg_hi:[0,0,1]
    v_exp_f32 v80, v80
    v_exp_f32 v81, v81
    v_exp_f32 v82, v82
    v_exp_f32 v83, v83
    v_exp_f32 v84, v84
    v_exp_f32 v85, v85
    v_exp_f32 v86, v86
    v_exp_f32 v87, v87
    v_pk_fma_f32 v[44:45], v[44:45], s[32:33], v[10:11] op_sel:[0,1,0] op_sel_hi:[1,1,0] neg_lo:[0,0,1] neg_hi:[0,0,1]
    v_pk_fma_f32 v[46:47], v[46:47], s[32:33], v[10:11] op_sel:[0,1,0] op_sel_hi:[1,1,0] neg_lo:[0,0,1] neg_hi:[0,0,1]
    v_cvt_pk_bf16_f32 v28, v80, v81
    v_cvt_pk_bf16_f32 v29, v82, v83
    v_cvt_pk_bf16_f32 v30, v84, v85
    v_cvt_pk_bf16_f32 v31, v86, v87
    v_exp_f32 v44, v44
    v_exp_f32 v45, v45
    v_mfma_f32_16x16x32_bf16 v[20:23], v[12:15], v[28:31], 0
    buffer_store_dwordx4 v[72:75], v2, s[4:7], s38 offen sc1
    v_exp_f32 v46, v46
    v_mov_b64 v[48:49], s[76:77]
    v_mfma_f32_16x16x32_bf16 v[24:27], v[16:19], v[28:31], 0
    v_exp_f32 v47, v47
    v_mov_b64 v[50:51], s[76:77]
    v_cvt_pk_bf16_f32 v32, v44, v45
    v_cvt_pk_bf16_f32 v33, v46, v47
    v_mfma_f32_16x16x32_bf16 v[52:55], v[48:51], v[28:31], 0
    v_cndmask_b32 v37, 0, v41, s[34:35]
    v_cndmask_b32 v39, v41, 0, s[34:35]
    v_mov_b64 v[34:35], s[78:79]
    v_xor_b32 v11, 32, v6
    s_nop 0
    v_mfma_f32_16x16x16_bf16 v[52:55], v[34:35], v[32:33], v[52:55]
    v_mov_b64 v[56:57], 0
    v_mov_b64 v[58:59], 0
    v_mfma_f32_16x16x16_bf16 v[20:23], v[36:37], v[32:33], v[20:23]
    v_mov_b64 v[60:61], 0
    v_mov_b64 v[62:63], 0
    v_mfma_f32_16x16x16_bf16 v[24:27], v[38:39], v[32:33], v[24:27]
    v_mov_b64 v[64:65], 0
    v_mov_b64 v[66:67], 0
    v_rcp_f32 v10, v52
    v_mov_b64 v[68:69], 0
    v_mov_b64 v[70:71], 0
    v_mov_b64 v[76:77], 0
    v_mov_b64 v[78:79], 0
    v_pk_mul_f32 v[20:21], v[20:21], v[10:11] op_sel_hi:[1,0]
    v_pk_mul_f32 v[22:23], v[22:23], v[10:11] op_sel_hi:[1,0]
    v_cvt_pk_bf16_f32 v20, v20, v21
    v_cvt_pk_bf16_f32 v21, v22, v23
    ds_write_b64 v6, v[20:21]
    v_pk_mul_f32 v[24:25], v[24:25], v[10:11] op_sel_hi:[1,0]
    v_pk_mul_f32 v[26:27], v[26:27], v[10:11] op_sel_hi:[1,0]
    v_cvt_pk_bf16_f32 v24, v24, v25
    v_cvt_pk_bf16_f32 v25, v26, v27
    ds_write_b64 v11, v[24:25]
    s_cmp_lg_u32 s18, 3
    s_cbranch_scc1 L_mf_209
    v_mov_b32 v52, 1
    s_mov_b64 exec, 1
    buffer_store_dword v52, off, s[4:7], s40 sc1
    s_mov_b64 exec, -1
L_mf_209:
    s_add_u32 s40, s40, 1024
    s_waitcnt lgkmcnt(0)
    s_barrier
    ds_read_b128 v[20:23], v7 offset:0
    ds_read_b128 v[24:27], v7 offset:128
    s_cmp_eq_u32 s20, 0
    s_cbranch_scc1 L_psafe_210
    s_waitcnt lgkmcnt(1)
    v_smfmac_f32_16x16x64_bf16 v[76:79], v[20:23], v[208:215], v1
    s_waitcnt lgkmcnt(0)
    v_smfmac_f32_16x16x64_bf16 v[76:79], v[24:27], v[248:255], v1
    buffer_load_dwordx4 v2, s[4:7], s29 offen offset:0 sc1 lds
    v_smfmac_f32_16x16x64_bf16 v[56:59], v[20:23], v[176:183], v1
    v_and_b32 v11, 0x1fff, v8
    v_smfmac_f32_16x16x64_bf16 v[60:63], v[20:23], v[184:191], v1
    v_add_u32 v12, s73, v3
    v_smfmac_f32_16x16x64_bf16 v[56:59], v[24:27], v[216:223], v1
    v_lshl_add_u32 v13, v0, 2, s74
    v_smfmac_f32_16x16x64_bf16 v[60:63], v[24:27], v[224:231], v1
    buffer_load_dwordx4 v2, s[4:7], s29 offen offset:1024 sc1 lds
    v_smfmac_f32_16x16x64_bf16 v[64:67], v[20:23], v[192:199], v1
    v_mov_b64 v[48:49], v[76:77]
    v_mov_b64 v[50:51], v[78:79]
    v_smfmac_f32_16x16x64_bf16 v[68:71], v[20:23], v[200:207], v1
    v_permlane32_swap_b32 v76, v48
    v_smfmac_f32_16x16x64_bf16 v[64:67], v[24:27], v[232:239], v1
    v_permlane32_swap_b32 v77, v49
    v_smfmac_f32_16x16x64_bf16 v[68:71], v[24:27], v[240:247], v1
    v_permlane32_swap_b32 v78, v50
    v_permlane32_swap_b32 v79, v51
    v_pk_add_f32 v[76:77], v[76:77], v[48:49]
    v_pk_add_f32 v[78:79], v[78:79], v[50:51]
    v_cvt_pk_bf16_f32 v32, v76, v77
    v_cvt_pk_bf16_f32 v33, v78, v79
    v_mov_b64 v[34:35], v[32:33]
    v_permlane32_swap_b32 v56, v60
    v_permlane32_swap_b32 v57, v61
    v_permlane32_swap_b32 v58, v62
    v_permlane32_swap_b32 v59, v63
    v_pk_add_f32 v[56:57], v[56:57], v[60:61]
    v_pk_add_f32 v[58:59], v[58:59], v[62:63]
    v_cvt_pk_bf16_f32 v28, v56, v57
    v_cvt_pk_bf16_f32 v29, v58, v59
    v_permlane16_swap_b32 v32, v34
    v_permlane16_swap_b32 v33, v35
    v_and_or_b32 v32, v32, -2, s72
    v_permlane32_swap_b32 v64, v68
    buffer_store_dwordx4 v[32:35], v11, s[4:7], s24 offen
    v_permlane32_swap_b32 v65, v69
    v_permlane32_swap_b32 v66, v70
    v_permlane32_swap_b32 v67, v71
    v_pk_add_f32 v[64:65], v[64:65], v[68:69]
    v_pk_add_f32 v[66:67], v[66:67], v[70:71]
    v_cvt_pk_bf16_f32 v30, v64, v65
    v_cvt_pk_bf16_f32 v31, v66, v67
    s_nop 0
    v_permlane16_swap_b32 v28, v30
    v_permlane16_swap_b32 v29, v31
    v_and_or_b32 v28, v28, -2, s72
    buffer_store_dwordx4 v[28:31], v8, s[4:7], s23 offen
    s_nop 1
L_pend_211:
    s_waitcnt vmcnt(5)
    s_add_u32 s21, s21, 10240
    s_add_u32 s30, s30, 262144
    s_add_u32 s29, s29, 262144
    s_add_u32 s38, s38, 131072
    s_lshr_b64 s[36:37], s[36:37], 1
    s_lshr_b64 s[82:83], s[82:83], 1
    s_add_u32 s39, s39, 32768
    s_and_b32 s41, s82, 1
    s_lshl_b32 s41, s41, 13
    s_add_u32 s22, s39, s41
    s_and_b32 s41, s36, 1
    s_lshl_b32 s41, s41, 13
    s_add_u32 s27, s96, s41
    s_add_u32 s96, s96, 32768
    s_add_u32 s32, s21, 149504
    s_bfe_u32 s41, s82, 0x10001
    s_lshl_b32 s41, s41, 13
    s_add_u32 s41, s41, s39
    s_add_u32 s41, s41, 172032
    s_cmp_eq_u32 s18, 1
    s_cselect_b32 s32, s41, s32
    s_add_u32 s41, s29, 65536
    s_cmp_eq_u32 s18, 2
    s_cselect_b32 s32, s41, s32
    s_add_u32 s41, s29, 0x1018000
    s_cmp_eq_u32 s18, 3
    s_cselect_b32 s32, s41, s32
    s_cmp_lt_u32 s18, 2
    s_cselect_b32 s41, 39, 63
    v_min_u32 v9, s41, v0
    v_lshlrev_b32 v9, 7, v9
    s_cmp_ge_u32 s31, 40
    s_cbranch_scc1 L_nored2_213
    v_and_b32 v11, 7, v0
    v_bfe_u32 v10, v0, 4, 1
    v_lshlrev_b32 v10, 3, v10
    v_lshl_add_u32 v11, v11, 4, v10
    v_lshrrev_b32 v10, 5, v0
    v_lshl_add_u32 v14, v10, 2, v11
    v_and_b32 v11, 1, v0
    v_lshlrev_b32 v11, 4, v11
    v_mov_b32 v10, 0x3f80
    v_lshlrev_b32 v11, v11, v10
    v_bfe_u32 v10, v0, 1, 2
    v_cmp_eq_u32 vcc, 0, v10
    s_nop 1
    v_cndmask_b32 v36, 0, v11, vcc
    v_cmp_eq_u32 vcc, 1, v10
    s_nop 1
    v_cndmask_b32 v37, 0, v11, vcc
    v_cmp_eq_u32 vcc, 2, v10
    s_nop 1
    v_cndmask_b32 v38, 0, v11, vcc
    v_cmp_eq_u32 vcc, 3, v10
    s_nop 1
    v_cndmask_b32 v39, 0, v11, vcc
    s_nop 15
    buffer_load_dwordx4 v[20:23], v2, s[4:7], s26 offen offset:0 sc1
    buffer_load_dwordx4 v[24:27], v2, s[4:7], s26 offen offset:1024 sc1
    buffer_load_dwordx4 v[28:31], v2, s[4:7], s26 offen offset:2048 sc1
    buffer_load_dwordx4 v[32:35], v2, s[4:7], s26 offen offset:3072 sc1
    s_nop 15
    s_nop 15
    buffer_load_dwordx4 v[44:47], v2, s[4:7], s26 offen offset:0 sc1
    buffer_load_dwordx4 v[48:51], v2, s[4:7], s26 offen offset:1024 sc1
    buffer_load_dwordx4 v[52:55], v2, s[4:7], s26 offen offset:2048 sc1
    buffer_load_dwordx4 v[56:59], v2, s[4:7], s26 offen offset:3072 sc1
L_pa_214:
    s_waitcnt vmcnt(4)
    v_mfma_f32_16x16x32_bf16 v[80:83], v[20:23], v[36:39], 0
    v_bitop3_b32 v11, v20, v24, s72 bitop3:0x7e
    v_mfma_f32_16x16x32_bf16 v[80:83], v[24:27], v[36:39], v[80:83]
    v_bitop3_b32 v10, v28, v32, s72 bitop3:0x7e
    v_mfma_f32_16x16x32_bf16 v[80:83], v[28:31], v[36:39], v[80:83]
    v_bitop3_b32 v11, v11, v10, 1 bitop3:0xa8
    v_mfma_f32_16x16x32_bf16 v[80:83], v[32:35], v[36:39], v[80:83]
    v_cmp_ne_u32 vcc, 0, v11
    s_cbranch_vccz L_paw_215
    buffer_load_dwordx4 v[20:23], v2, s[4:7], s26 offen offset:0 sc1
    buffer_load_dwordx4 v[24:27], v2, s[4:7], s26 offen offset:1024 sc1
    buffer_load_dwordx4 v[28:31], v2, s[4:7], s26 offen offset:2048 sc1
    buffer_load_dwordx4 v[32:35], v2, s[4:7], s26 offen offset:3072 sc1
    s_waitcnt vmcnt(4)
    s_nop 0
    v_mfma_f32_16x16x32_bf16 v[80:83], v[44:47], v[36:39], 0
    v_bitop3_b32 v11, v44, v48, s72 bitop3:0x7e
    v_mfma_f32_16x16x32_bf16 v[80:83], v[48:51], v[36:39], v[80:83]
    v_bitop3_b32 v10, v52, v56, s72 bitop3:0x7e
    v_mfma_f32_16x16x32_bf16 v[80:83], v[52:55], v[36:39], v[80:83]
    v_bitop3_b32 v11, v11, v10, 1 bitop3:0xa8
    v_mfma_f32_16x16x32_bf16 v[80:83], v[56:59], v[36:39], v[80:83]
    v_cmp_ne_u32 vcc, 0, v11
    s_cbranch_vccz L_paw_215
    buffer_load_dwordx4 v[44:47], v2, s[4:7], s26 offen offset:0 sc1
    buffer_load_dwordx4 v[48:51], v2, s[4:7], s26 offen offset:1024 sc1
    buffer_load_dwordx4 v[52:55], v2, s[4:7], s26 offen offset:2048 sc1
    buffer_load_dwordx4 v[56:59], v2, s[4:7], s26 offen offset:3072 sc1
    s_add_u32 s46, s46, 1
    s_cmp_lt_u32 s46, 131072
    s_cbranch_scc1 L_pa_214
    s_branch L_end
L_paw_215:
    s_cmp_eq_u32 s20, 0
    s_nop 4
    v_permlane32_swap_b32 v80, v82
    v_permlane32_swap_b32 v81, v83
    s_mov_b64 exec, s[44:45]
    v_pk_add_f32 v[80:81], v[80:81], v[82:83]
    v_cvt_pk_bf16_f32 v80, v80, v81
    v_min_u32 v80, -2, v80
    buffer_store_dword v80, v14, s[4:7], s27 offen sc1
    s_cbranch_scc1 L_pubs_216
    buffer_store_dword v80, v14, s[4:7], s28 offen
L_pubd_217:
    s_mov_b64 exec, -1
    s_waitcnt vmcnt(2)
    s_branch L_nored_212
L_nored2_213:
    s_add_u32 s41, s19, 6
    s_min_u32 s41, s41, 65
    s_cmp_ge_u32 s25, s41
    s_cbranch_scc1 L_kr_218
    v_lshlrev_b32 v11, 9, v0
    buffer_load_dwordx2 v[10:11], v11, s[4:7], s97 offen sc1
    s_waitcnt vmcnt(0)
    v_and_b32 v10, v10, v11
    v_cmp_eq_u32 vcc, 1, v10
    s_ff0_i32_b64 s25, vcc
    s_min_u32 s25, s25, 65
    s_branch L_nored_212
L_kr_218:
    s_sleep 13
L_nored_212:
    s_add_u32 s28, s28, 10240
    s_xor_b32 s72, s72, 1
    s_add_u32 s19, s19, 1
    s_branch L_step_197
L_kvs_196:
    v_lshlrev_b32 v11, 9, v0
    buffer_load_dwordx2 v[10:11], v11, s[4:7], s97 offen sc1
    s_waitcnt vmcnt(0)
    v_and_b32 v10, v10, v11
    v_cmp_eq_u32 vcc, 1, v10
    s_ff0_i32_b64 s25, vcc
    s_min_u32 s25, s25, 65
    s_add_u32 s46, s46, 1
    s_cmp_lt_u32 s46, 131072
    s_cbranch_scc1 L_kv_195
    s_branch L_end
L_lastf_202:
    s_cmp_lg_u32 s18, 3
    s_cbranch_scc1 L_mf_219
    v_mov_b32 v11, 1
    s_mov_b64 exec, 1
    buffer_store_dword v11, off, s[4:7], s40 sc1
    s_mov_b64 exec, -1
L_mf_219:
    s_add_u32 s40, s40, 1024
    s_branch L_lastb_203
L_kvs_208:
    v_lshlrev_b32 v11, 9, v0
    buffer_load_dwordx2 v[10:11], v11, s[4:7], s97 offen sc1
    s_waitcnt vmcnt(0)
    v_and_b32 v10, v10, v11
    v_cmp_eq_u32 vcc, 1, v10
    s_ff0_i32_b64 s25, vcc
    s_min_u32 s25, s25, 65
    s_add_u32 s46, s46, 1
    s_cmp_lt_u32 s46, 131072
    s_cbranch_scc1 L_kv_207
    s_branch L_end
L_psafe_210:
    s_waitcnt lgkmcnt(1)
    v_smfmac_f32_16x16x64_bf16 v[76:79], v[20:23], v[208:215], v1
    s_waitcnt lgkmcnt(0)
    v_smfmac_f32_16x16x64_bf16 v[76:79], v[24:27], v[248:255], v1
    buffer_load_dwordx4 v2, s[4:7], s29 offen offset:0 sc1 lds
    v_smfmac_f32_16x16x64_bf16 v[56:59], v[20:23], v[176:183], v1
    v_and_b32 v11, 0x1fff, v8
    v_smfmac_f32_16x16x64_bf16 v[60:63], v[20:23], v[184:191], v1
    v_add_u32 v12, s73, v3
    v_smfmac_f32_16x16x64_bf16 v[56:59], v[24:27], v[216:223], v1
    v_lshl_add_u32 v13, v0, 2, s74
    v_smfmac_f32_16x16x64_bf16 v[60:63], v[24:27], v[224:231], v1
    buffer_load_dwordx4 v2, s[4:7], s29 offen offset:1024 sc1 lds
    v_smfmac_f32_16x16x64_bf16 v[64:67], v[20:23], v[192:199], v1
    v_mov_b64 v[48:49], v[76:77]
    v_mov_b64 v[50:51], v[78:79]
    v_smfmac_f32_16x16x64_bf16 v[68:71], v[20:23], v[200:207], v1
    v_permlane32_swap_b32 v76, v48
    v_smfmac_f32_16x16x64_bf16 v[64:67], v[24:27], v[232:239], v1
    v_permlane32_swap_b32 v77, v49
    v_smfmac_f32_16x16x64_bf16 v[68:71], v[24:27], v[240:247], v1
    v_permlane32_swap_b32 v78, v50
    v_permlane32_swap_b32 v79, v51
    v_pk_add_f32 v[76:77], v[76:77], v[48:49]
    v_pk_add_f32 v[78:79], v[78:79], v[50:51]
    v_cvt_pk_bf16_f32 v32, v76, v77
    v_cvt_pk_bf16_f32 v33, v78, v79
    v_mov_b64 v[34:35], v[32:33]
    v_permlane32_swap_b32 v56, v60
    v_permlane32_swap_b32 v57, v61
    v_permlane32_swap_b32 v58, v62
    v_permlane32_swap_b32 v59, v63
    v_pk_add_f32 v[56:57], v[56:57], v[60:61]
    v_pk_add_f32 v[58:59], v[58:59], v[62:63]
    v_cvt_pk_bf16_f32 v28, v56, v57
    v_cvt_pk_bf16_f32 v29, v58, v59
    v_permlane16_swap_b32 v32, v34
    v_permlane16_swap_b32 v33, v35
    v_and_or_b32 v32, v32, -2, s72
    v_permlane32_swap_b32 v64, v68
    buffer_store_dwordx4 v[32:35], v11, s[4:7], s24 offen sc1
    v_permlane32_swap_b32 v65, v69
    v_permlane32_swap_b32 v66, v70
    v_permlane32_swap_b32 v67, v71
    v_pk_add_f32 v[64:65], v[64:65], v[68:69]
    v_pk_add_f32 v[66:67], v[66:67], v[70:71]
    v_cvt_pk_bf16_f32 v30, v64, v65
    v_cvt_pk_bf16_f32 v31, v66, v67
    s_nop 0
    v_permlane16_swap_b32 v28, v30
    v_permlane16_swap_b32 v29, v31
    v_and_or_b32 v28, v28, -2, s72
    buffer_store_dwordx4 v[28:31], v8, s[4:7], s23 offen sc1
    s_nop 1
    s_branch L_pend_211
L_pubs_216:
    buffer_store_dword v80, v14, s[4:7], s28 offen sc1
    s_branch L_pubd_217
L_rec_done_198:
    buffer_store_dwordx4 v[72:75], v2, s[4:7], s38 offen sc1
    s_waitcnt vmcnt(0) lgkmcnt(0)
    s_barrier
    s_cmp_lg_u32 s18, 3
    s_cbranch_scc1 L_mf_220
    v_mov_b32 v11, 1
    s_mov_b64 exec, 1
    buffer_store_dword v11, off, s[4:7], s40 sc1
    s_mov_b64 exec, -1
L_mf_220:
    s_add_u32 s40, s40, 1024
L_end:
L_end0:
    s_endpgm
.section .rodata,"a"
.p2align 6
.amdhsa_kernel adaLN_cond__memory_aug_recurrent_mem_tr__swiglu_ffn__prompt_kernel
  .amdhsa_next_free_vgpr 512
  .amdhsa_next_free_sgpr 102
  .amdhsa_accum_offset 256
  .amdhsa_group_segment_fixed_size 0
  .amdhsa_kernarg_size 128
  .amdhsa_user_sgpr_count 2
  .amdhsa_user_sgpr_kernarg_segment_ptr 1
  .amdhsa_system_sgpr_workgroup_id_x 1
.end_amdhsa_kernel
```
